```python
import torch

def _softmax(x, axis=-1):
    return torch.softmax(x, dim=axis)
def _gelu(x):
    return torch.nn.functional.gelu(x, approximate="tanh")
def _silu(x):
    return torch.nn.functional.silu(x)
def _sigmoid(x):
    return torch.sigmoid(x)
def _layernorm(x, axis=-1, eps=1e-5):
    m = x.mean(dim=axis, keepdim=True)
    v = x.var(dim=axis, keepdim=True, unbiased=False)
    return (x - m) / torch.sqrt(v + eps)
def _scatter_add(tgt, idx, src, axis=0):
    return tgt.clone().index_add_(axis, idx, src)
def _segment_sum(src, seg, n):
    out = torch.zeros((n,) + src.shape[1:], dtype=src.dtype)
    return out.index_add_(0, seg, src)
def _pad(x, pw):
    flat = tuple(v for pair in reversed(pw) for v in pair)
    return torch.nn.functional.pad(x, flat)

kernel_name = 'parallel_sum__spectral_gfnet__glu_gated_reglu__prompt'

def setup_inputs():

    _w = (lambda a: (lambda t: t.to(torch.bfloat16) if t.is_floating_point() else t)(torch.as_tensor(a)))
    def _A_setup():
        B, S, D = 1, 2048, 512
        Df = D // 2 + 1
        return {
            "x": _w((lambda *s: torch.randn(*s, dtype=torch.bfloat16) * 0.05)(B, S, D)),
            "w_r": _w((lambda *s: torch.randn(*s, dtype=torch.bfloat16) * 0.4)(S, Df) * 0.02),
            "w_i": _w((lambda *s: torch.randn(*s, dtype=torch.bfloat16) * 0.4)(S, Df) * 0.02),
        }
    _A_in = _A_setup()

    def _B_setup():
        B, S, D, F = 1, 2048, 512, 1792
        return {
            "x": _w((lambda *s: torch.randn(*s, dtype=torch.bfloat16) * 0.05)(B, S, D)),
            "W_gate": _w((lambda *s: torch.randn(*s, dtype=torch.bfloat16) * 0.2)(D, F) * (2.0 / D) ** 0.5),
            "W_up": _w((lambda *s: torch.randn(*s, dtype=torch.bfloat16) * 0.2)(D, F) * (2.0 / D) ** 0.5),
            "W_down": _w((lambda *s: torch.randn(*s, dtype=torch.bfloat16) * 0.2)(F, D) * (1.0 / F) ** 0.5),
        }
    _B_in = _B_setup()

    return {
        "A_x": _A_in["x"],
        "A_w_r": _A_in["w_r"],
        "A_w_i": _A_in["w_i"],
        "B_x": _B_in["x"],
        "B_W_gate": _B_in["W_gate"],
        "B_W_up": _B_in["W_up"],
        "B_W_down": _B_in["W_down"],
    }

def reference(A_x, A_w_r, A_w_i, B_x, B_W_gate, B_W_up, B_W_down):
    def _A_ref(x, w_r, w_i):
        B, S, D = x.shape
        X = (lambda x, axes=(-2,-1): torch.fft.rfft2(x.float(), dim=axes))(x, axes=(-2, -1))
        W = w_r + 1j * w_i
        X = X * W
        y = (lambda x, s, axes=(-2,-1): torch.fft.irfft2(x, s=s, dim=axes).to(torch.bfloat16))(X, (S, D), axes=(-2, -1))
        return y

    def _B_ref(x, W_gate, W_up, W_down):
        gate = torch.einsum("bsd,df->bsf", x, W_gate)
        up = torch.einsum("bsd,df->bsf", x, W_up)
        gate = gate * (lambda x, dt: x.to(dt))(gate > 0, gate.dtype)
        h = gate * up
        return torch.einsum("bsf,fd->bsd", h, W_down)

    x = A_x
    xn = _layernorm(x, axis=-1)
    return x + _A_ref(xn, A_w_r, A_w_i) + _B_ref(xn, B_W_gate, B_W_up, B_W_down)
```

```asm
; @launch grid=(256,1,1) block=(512,1,1) lds=163840
.amdgcn_target "amdgcn-amd-amdhsa--gfx950"
.text
.p2align 12
.type CTAB,@object
CTAB:
.set P0, 0x3f80
.set P1, 0xbc493f80
.set P2, 0xbcc93f80
.set P3, 0xbd173f80
.set P4, 0xbd493f80
.set P5, 0xbd7b3f80
.set P6, 0xbd973f7f
.set P7, 0xbdb03f7f
.set P8, 0xbdc93f7f
.set P9, 0xbde23f7e
.set P10, 0xbdfb3f7e
.set P11, 0xbe0a3f7e
.set P12, 0xbe163f7d
.set P13, 0xbe233f7d
.set P14, 0xbe2f3f7c
.set P15, 0xbe3b3f7c
.set P16, 0xbe483f7b
.set P17, 0xbe543f7a
.set P18, 0xbe603f7a
.set P19, 0xbe6d3f79
.set P20, 0xbe793f78
.set P21, 0xbe823f78
.set P22, 0xbe893f77
.set P23, 0xbe8f3f76
.set P24, 0xbe953f75
.set P25, 0xbe9b3f74
.set P26, 0xbea13f73
.set P27, 0xbea73f72
.set P28, 0xbeac3f71
.set P29, 0xbeb23f70
.set P30, 0xbeb83f6f
.set P31, 0xbebe3f6e
.set P32, 0xbec43f6d
.set P33, 0xbeca3f6b
.set P34, 0xbecf3f6a
.set P35, 0xbed53f69
.set P36, 0xbedb3f67
.set P37, 0xbee13f66
.set P38, 0xbee63f65
.set P39, 0xbeec3f63
.set P40, 0xbef13f62
.set P41, 0xbef73f60
.set P42, 0xbefc3f5f
.set P43, 0xbf013f5d
.set P44, 0xbf043f5c
.set P45, 0xbf063f5a
.set P46, 0xbf093f58
.set P47, 0xbf0c3f57
.set P48, 0xbf0e3f55
.set P49, 0xbf113f53
.set P50, 0xbf133f51
.set P51, 0xbf163f4f
.set P52, 0xbf183f4e
.set P53, 0xbf1b3f4c
.set P54, 0xbf1d3f4a
.set P55, 0xbf203f48
.set P56, 0xbf223f46
.set P57, 0xbf253f44
.set P58, 0xbf273f42
.set P59, 0xbf2a3f40
.set P60, 0xbf2c3f3e
.set P61, 0xbf2e3f3c
.set P62, 0xbf313f39
.set P63, 0xbf333f37
.set P64, 0xbf353f35
.set P65, 0xbf373f33
.set P66, 0xbf393f31
.set P67, 0xbf3c3f2e
.set P68, 0xbf3e3f2c
.set P69, 0xbf403f2a
.set P70, 0xbf423f27
.set P71, 0xbf443f25
.set P72, 0xbf463f22
.set P73, 0xbf483f20
.set P74, 0xbf4a3f1d
.set P75, 0xbf4c3f1b
.set P76, 0xbf4e3f18
.set P77, 0xbf4f3f16
.set P78, 0xbf513f13
.set P79, 0xbf533f11
.set P80, 0xbf553f0e
.set P81, 0xbf573f0c
.set P82, 0xbf583f09
.set P83, 0xbf5a3f06
.set P84, 0xbf5c3f04
.set P85, 0xbf5d3f01
.set P86, 0xbf5f3efc
.set P87, 0xbf603ef7
.set P88, 0xbf623ef1
.set P89, 0xbf633eec
.set P90, 0xbf653ee6
.set P91, 0xbf663ee1
.set P92, 0xbf673edb
.set P93, 0xbf693ed5
.set P94, 0xbf6a3ecf
.set P95, 0xbf6b3eca
.set P96, 0xbf6d3ec4
.set P97, 0xbf6e3ebe
.set P98, 0xbf6f3eb8
.set P99, 0xbf703eb2
.set P100, 0xbf713eac
.set P101, 0xbf723ea7
.set P102, 0xbf733ea1
.set P103, 0xbf743e9b
.set P104, 0xbf753e95
.set P105, 0xbf763e8f
.set P106, 0xbf773e89
.set P107, 0xbf783e82
.set P108, 0xbf783e79
.set P109, 0xbf793e6d
.set P110, 0xbf7a3e60
.set P111, 0xbf7a3e54
.set P112, 0xbf7b3e48
.set P113, 0xbf7c3e3b
.set P114, 0xbf7c3e2f
.set P115, 0xbf7d3e23
.set P116, 0xbf7d3e16
.set P117, 0xbf7e3e0a
.set P118, 0xbf7e3dfb
.set P119, 0xbf7e3de2
.set P120, 0xbf7f3dc9
.set P121, 0xbf7f3db0
.set P122, 0xbf7f3d97
.set P123, 0xbf803d7b
.set P124, 0xbf803d49
.set P125, 0xbf803d17
.set P126, 0xbf803cc9
.set P127, 0xbf803c49
.set P128, 0xbf800000
.set P129, 0xbf80bc49
.set P130, 0xbf80bcc9
.set P131, 0xbf80bd17
.set P132, 0xbf80bd49
.set P133, 0xbf80bd7b
.set P134, 0xbf7fbd97
.set P135, 0xbf7fbdb0
.set P136, 0xbf7fbdc9
.set P137, 0xbf7ebde2
.set P138, 0xbf7ebdfb
.set P139, 0xbf7ebe0a
.set P140, 0xbf7dbe16
.set P141, 0xbf7dbe23
.set P142, 0xbf7cbe2f
.set P143, 0xbf7cbe3b
.set P144, 0xbf7bbe48
.set P145, 0xbf7abe54
.set P146, 0xbf7abe60
.set P147, 0xbf79be6d
.set P148, 0xbf78be79
.set P149, 0xbf78be82
.set P150, 0xbf77be89
.set P151, 0xbf76be8f
.set P152, 0xbf75be95
.set P153, 0xbf74be9b
.set P154, 0xbf73bea1
.set P155, 0xbf72bea7
.set P156, 0xbf71beac
.set P157, 0xbf70beb2
.set P158, 0xbf6fbeb8
.set P159, 0xbf6ebebe
.set P160, 0xbf6dbec4
.set P161, 0xbf6bbeca
.set P162, 0xbf6abecf
.set P163, 0xbf69bed5
.set P164, 0xbf67bedb
.set P165, 0xbf66bee1
.set P166, 0xbf65bee6
.set P167, 0xbf63beec
.set P168, 0xbf62bef1
.set P169, 0xbf60bef7
.set P170, 0xbf5fbefc
.set P171, 0xbf5dbf01
.set P172, 0xbf5cbf04
.set P173, 0xbf5abf06
.set P174, 0xbf58bf09
.set P175, 0xbf57bf0c
.set P176, 0xbf55bf0e
.set P177, 0xbf53bf11
.set P178, 0xbf51bf13
.set P179, 0xbf4fbf16
.set P180, 0xbf4ebf18
.set P181, 0xbf4cbf1b
.set P182, 0xbf4abf1d
.set P183, 0xbf48bf20
.set P184, 0xbf46bf22
.set P185, 0xbf44bf25
.set P186, 0xbf42bf27
.set P187, 0xbf40bf2a
.set P188, 0xbf3ebf2c
.set P189, 0xbf3cbf2e
.set P190, 0xbf39bf31
.set P191, 0xbf37bf33
.set P192, 0xbf35bf35
.set P193, 0xbf33bf37
.set P194, 0xbf31bf39
.set P195, 0xbf2ebf3c
.set P196, 0xbf2cbf3e
.set P197, 0xbf2abf40
.set P198, 0xbf27bf42
.set P199, 0xbf25bf44
.set P200, 0xbf22bf46
.set P201, 0xbf20bf48
.set P202, 0xbf1dbf4a
.set P203, 0xbf1bbf4c
.set P204, 0xbf18bf4e
.set P205, 0xbf16bf4f
.set P206, 0xbf13bf51
.set P207, 0xbf11bf53
.set P208, 0xbf0ebf55
.set P209, 0xbf0cbf57
.set P210, 0xbf09bf58
.set P211, 0xbf06bf5a
.set P212, 0xbf04bf5c
.set P213, 0xbf01bf5d
.set P214, 0xbefcbf5f
.set P215, 0xbef7bf60
.set P216, 0xbef1bf62
.set P217, 0xbeecbf63
.set P218, 0xbee6bf65
.set P219, 0xbee1bf66
.set P220, 0xbedbbf67
.set P221, 0xbed5bf69
.set P222, 0xbecfbf6a
.set P223, 0xbecabf6b
.set P224, 0xbec4bf6d
.set P225, 0xbebebf6e
.set P226, 0xbeb8bf6f
.set P227, 0xbeb2bf70
.set P228, 0xbeacbf71
.set P229, 0xbea7bf72
.set P230, 0xbea1bf73
.set P231, 0xbe9bbf74
.set P232, 0xbe95bf75
.set P233, 0xbe8fbf76
.set P234, 0xbe89bf77
.set P235, 0xbe82bf78
.set P236, 0xbe79bf78
.set P237, 0xbe6dbf79
.set P238, 0xbe60bf7a
.set P239, 0xbe54bf7a
.set P240, 0xbe48bf7b
.set P241, 0xbe3bbf7c
.set P242, 0xbe2fbf7c
.set P243, 0xbe23bf7d
.set P244, 0xbe16bf7d
.set P245, 0xbe0abf7e
.set P246, 0xbdfbbf7e
.set P247, 0xbde2bf7e
.set P248, 0xbdc9bf7f
.set P249, 0xbdb0bf7f
.set P250, 0xbd97bf7f
.set P251, 0xbd7bbf80
.set P252, 0xbd49bf80
.set P253, 0xbd17bf80
.set P254, 0xbcc9bf80
.set P255, 0xbc49bf80
.set P256, 0xbf80
.set P257, 0x3c49bf80
.set P258, 0x3cc9bf80
.set P259, 0x3d17bf80
.set P260, 0x3d49bf80
.set P261, 0x3d7bbf80
.set P262, 0x3d97bf7f
.set P263, 0x3db0bf7f
.set P264, 0x3dc9bf7f
.set P265, 0x3de2bf7e
.set P266, 0x3dfbbf7e
.set P267, 0x3e0abf7e
.set P268, 0x3e16bf7d
.set P269, 0x3e23bf7d
.set P270, 0x3e2fbf7c
.set P271, 0x3e3bbf7c
.set P272, 0x3e48bf7b
.set P273, 0x3e54bf7a
.set P274, 0x3e60bf7a
.set P275, 0x3e6dbf79
.set P276, 0x3e79bf78
.set P277, 0x3e82bf78
.set P278, 0x3e89bf77
.set P279, 0x3e8fbf76
.set P280, 0x3e95bf75
.set P281, 0x3e9bbf74
.set P282, 0x3ea1bf73
.set P283, 0x3ea7bf72
.set P284, 0x3eacbf71
.set P285, 0x3eb2bf70
.set P286, 0x3eb8bf6f
.set P287, 0x3ebebf6e
.set P288, 0x3ec4bf6d
.set P289, 0x3ecabf6b
.set P290, 0x3ecfbf6a
.set P291, 0x3ed5bf69
.set P292, 0x3edbbf67
.set P293, 0x3ee1bf66
.set P294, 0x3ee6bf65
.set P295, 0x3eecbf63
.set P296, 0x3ef1bf62
.set P297, 0x3ef7bf60
.set P298, 0x3efcbf5f
.set P299, 0x3f01bf5d
.set P300, 0x3f04bf5c
.set P301, 0x3f06bf5a
.set P302, 0x3f09bf58
.set P303, 0x3f0cbf57
.set P304, 0x3f0ebf55
.set P305, 0x3f11bf53
.set P306, 0x3f13bf51
.set P307, 0x3f16bf4f
.set P308, 0x3f18bf4e
.set P309, 0x3f1bbf4c
.set P310, 0x3f1dbf4a
.set P311, 0x3f20bf48
.set P312, 0x3f22bf46
.set P313, 0x3f25bf44
.set P314, 0x3f27bf42
.set P315, 0x3f2abf40
.set P316, 0x3f2cbf3e
.set P317, 0x3f2ebf3c
.set P318, 0x3f31bf39
.set P319, 0x3f33bf37
.set P320, 0x3f35bf35
.set P321, 0x3f37bf33
.set P322, 0x3f39bf31
.set P323, 0x3f3cbf2e
.set P324, 0x3f3ebf2c
.set P325, 0x3f40bf2a
.set P326, 0x3f42bf27
.set P327, 0x3f44bf25
.set P328, 0x3f46bf22
.set P329, 0x3f48bf20
.set P330, 0x3f4abf1d
.set P331, 0x3f4cbf1b
.set P332, 0x3f4ebf18
.set P333, 0x3f4fbf16
.set P334, 0x3f51bf13
.set P335, 0x3f53bf11
.set P336, 0x3f55bf0e
.set P337, 0x3f57bf0c
.set P338, 0x3f58bf09
.set P339, 0x3f5abf06
.set P340, 0x3f5cbf04
.set P341, 0x3f5dbf01
.set P342, 0x3f5fbefc
.set P343, 0x3f60bef7
.set P344, 0x3f62bef1
.set P345, 0x3f63beec
.set P346, 0x3f65bee6
.set P347, 0x3f66bee1
.set P348, 0x3f67bedb
.set P349, 0x3f69bed5
.set P350, 0x3f6abecf
.set P351, 0x3f6bbeca
.set P352, 0x3f6dbec4
.set P353, 0x3f6ebebe
.set P354, 0x3f6fbeb8
.set P355, 0x3f70beb2
.set P356, 0x3f71beac
.set P357, 0x3f72bea7
.set P358, 0x3f73bea1
.set P359, 0x3f74be9b
.set P360, 0x3f75be95
.set P361, 0x3f76be8f
.set P362, 0x3f77be89
.set P363, 0x3f78be82
.set P364, 0x3f78be79
.set P365, 0x3f79be6d
.set P366, 0x3f7abe60
.set P367, 0x3f7abe54
.set P368, 0x3f7bbe48
.set P369, 0x3f7cbe3b
.set P370, 0x3f7cbe2f
.set P371, 0x3f7dbe23
.set P372, 0x3f7dbe16
.set P373, 0x3f7ebe0a
.set P374, 0x3f7ebdfb
.set P375, 0x3f7ebde2
.set P376, 0x3f7fbdc9
.set P377, 0x3f7fbdb0
.set P378, 0x3f7fbd97
.set P379, 0x3f80bd7b
.set P380, 0x3f80bd49
.set P381, 0x3f80bd17
.set P382, 0x3f80bcc9
.set P383, 0x3f80bc49
.set P384, 0x3f800000
.set P385, 0x3f803c49
.set P386, 0x3f803cc9
.set P387, 0x3f803d17
.set P388, 0x3f803d49
.set P389, 0x3f803d7b
.set P390, 0x3f7f3d97
.set P391, 0x3f7f3db0
.set P392, 0x3f7f3dc9
.set P393, 0x3f7e3de2
.set P394, 0x3f7e3dfb
.set P395, 0x3f7e3e0a
.set P396, 0x3f7d3e16
.set P397, 0x3f7d3e23
.set P398, 0x3f7c3e2f
.set P399, 0x3f7c3e3b
.set P400, 0x3f7b3e48
.set P401, 0x3f7a3e54
.set P402, 0x3f7a3e60
.set P403, 0x3f793e6d
.set P404, 0x3f783e79
.set P405, 0x3f783e82
.set P406, 0x3f773e89
.set P407, 0x3f763e8f
.set P408, 0x3f753e95
.set P409, 0x3f743e9b
.set P410, 0x3f733ea1
.set P411, 0x3f723ea7
.set P412, 0x3f713eac
.set P413, 0x3f703eb2
.set P414, 0x3f6f3eb8
.set P415, 0x3f6e3ebe
.set P416, 0x3f6d3ec4
.set P417, 0x3f6b3eca
.set P418, 0x3f6a3ecf
.set P419, 0x3f693ed5
.set P420, 0x3f673edb
.set P421, 0x3f663ee1
.set P422, 0x3f653ee6
.set P423, 0x3f633eec
.set P424, 0x3f623ef1
.set P425, 0x3f603ef7
.set P426, 0x3f5f3efc
.set P427, 0x3f5d3f01
.set P428, 0x3f5c3f04
.set P429, 0x3f5a3f06
.set P430, 0x3f583f09
.set P431, 0x3f573f0c
.set P432, 0x3f553f0e
.set P433, 0x3f533f11
.set P434, 0x3f513f13
.set P435, 0x3f4f3f16
.set P436, 0x3f4e3f18
.set P437, 0x3f4c3f1b
.set P438, 0x3f4a3f1d
.set P439, 0x3f483f20
.set P440, 0x3f463f22
.set P441, 0x3f443f25
.set P442, 0x3f423f27
.set P443, 0x3f403f2a
.set P444, 0x3f3e3f2c
.set P445, 0x3f3c3f2e
.set P446, 0x3f393f31
.set P447, 0x3f373f33
.set P448, 0x3f353f35
.set P449, 0x3f333f37
.set P450, 0x3f313f39
.set P451, 0x3f2e3f3c
.set P452, 0x3f2c3f3e
.set P453, 0x3f2a3f40
.set P454, 0x3f273f42
.set P455, 0x3f253f44
.set P456, 0x3f223f46
.set P457, 0x3f203f48
.set P458, 0x3f1d3f4a
.set P459, 0x3f1b3f4c
.set P460, 0x3f183f4e
.set P461, 0x3f163f4f
.set P462, 0x3f133f51
.set P463, 0x3f113f53
.set P464, 0x3f0e3f55
.set P465, 0x3f0c3f57
.set P466, 0x3f093f58
.set P467, 0x3f063f5a
.set P468, 0x3f043f5c
.set P469, 0x3f013f5d
.set P470, 0x3efc3f5f
.set P471, 0x3ef73f60
.set P472, 0x3ef13f62
.set P473, 0x3eec3f63
.set P474, 0x3ee63f65
.set P475, 0x3ee13f66
.set P476, 0x3edb3f67
.set P477, 0x3ed53f69
.set P478, 0x3ecf3f6a
.set P479, 0x3eca3f6b
.set P480, 0x3ec43f6d
.set P481, 0x3ebe3f6e
.set P482, 0x3eb83f6f
.set P483, 0x3eb23f70
.set P484, 0x3eac3f71
.set P485, 0x3ea73f72
.set P486, 0x3ea13f73
.set P487, 0x3e9b3f74
.set P488, 0x3e953f75
.set P489, 0x3e8f3f76
.set P490, 0x3e893f77
.set P491, 0x3e823f78
.set P492, 0x3e793f78
.set P493, 0x3e6d3f79
.set P494, 0x3e603f7a
.set P495, 0x3e543f7a
.set P496, 0x3e483f7b
.set P497, 0x3e3b3f7c
.set P498, 0x3e2f3f7c
.set P499, 0x3e233f7d
.set P500, 0x3e163f7d
.set P501, 0x3e0a3f7e
.set P502, 0x3dfb3f7e
.set P503, 0x3de23f7e
.set P504, 0x3dc93f7f
.set P505, 0x3db03f7f
.set P506, 0x3d973f7f
.set P507, 0x3d7b3f80
.set P508, 0x3d493f80
.set P509, 0x3d173f80
.set P510, 0x3cc93f80
.set P511, 0x3c493f80
.altmacro
.macro ent4 a, b, c, d
.long P\a, P\b, P\c, P\d
.endm
.set dd, 0
.rept 512
.set cc, 1
.rept 64
ent4 %((dd*cc)&511), %((dd*(cc+1))&511), %((dd*(cc+2))&511), %((dd*(cc+3))&511)
.set cc, cc+4
.endr
.set dd, dd+1
.endr
.noaltmacro
.long 0x3f803f80, 0x3f803f80, 0x3f803f80, 0x3f803f80
.long 0x3f7f3f80, 0x3f753f7b, 0x3f623f6d, 0x3f463f55
.long 0x3f7b3f80, 0x3f553f6d, 0x3f0e3f35, 0x3e483ec4
.long 0x3f753f80, 0x3f223f55, 0x3dc93ec4, 0xbef1be48
.long 0x3f6d3f80, 0x3ec43f35, 0xbec40000, 0xbf6dbf35
.long 0x3f623f80, 0x3dc93f0e, 0xbf46bec4, 0xbf75bf7b
.long 0x3f553f80, 0xbe483ec4, 0xbf7bbf35, 0xbf0ebf6d
.long 0x3f463f80, 0xbef13e48, 0xbf75bf6d, 0x3dc9bf0e
.long 0x3f353f80, 0xbf350000, 0xbf35bf80, 0x3f350000
.long 0x3f223f80, 0xbf62be48, 0xbe95bf6d, 0x3f7f3f0e
.long 0x3f0e3f80, 0xbf7bbec4, 0x3e48bf35, 0x3f553f6d
.long 0x3ef13f80, 0xbf7fbf0e, 0x3f22bec4, 0x3e953f7b
.long 0x3ec43f80, 0xbf6dbf35, 0x3f6d0000, 0xbec43f35
.long 0x3e953f80, 0xbf46bf55, 0x3f7f3ec4, 0xbf623e48
.long 0x3e483f80, 0xbf0ebf6d, 0x3f553f35, 0xbf7bbec4
.long 0x3dc93f80, 0xbe95bf7b, 0x3ef13f6d, 0xbf22bf55
.long 0x3f803f80, 0x3f803f80, 0x3f803f80, 0x3f803f80
.long 0x3f223f35, 0x3ef13f0e, 0x3e953ec4, 0x3dc93e48
.long 0xbe480000, 0xbf0ebec4, 0xbf55bf35, 0xbf7bbf6d
.long 0xbf62bf35, 0xbf7fbf7b, 0xbf46bf6d, 0xbe95bf0e
.long 0xbf6dbf80, 0xbec4bf35, 0x3ec40000, 0x3f6d3f35
.long 0xbe95bf35, 0x3f223e48, 0x3f7f3f6d, 0x3ef13f55
.long 0x3f0e0000, 0x3f7b3f6d, 0x3e483f35, 0xbf55bec4
.long 0x3f7f3f35, 0x3e953f55, 0xbf62bec4, 0xbf22bf7b
.long 0x3f353f80, 0xbf350000, 0xbf35bf80, 0x3f350000
.long 0xbdc93f35, 0xbf75bf55, 0x3ef1bec4, 0x3f463f7b
.long 0xbf550000, 0xbe48bf6d, 0x3f7b3f35, 0xbf0e3ec4
.long 0xbf75bf35, 0x3f46be48, 0x3dc93f6d, 0xbf62bf55
.long 0xbec4bf80, 0x3f6d3f35, 0xbf6d0000, 0x3ec4bf35
.long 0x3ef1bf35, 0x3dc93f7b, 0xbf22bf6d, 0x3f753f0e
.long 0x3f7b0000, 0xbf553ec4, 0x3f0ebf35, 0xbe483f6d
.long 0x3f463f35, 0xbf62bf0e, 0x3f753ec4, 0xbf7fbe48
.long 0x3f803f80, 0x3f803f80, 0x3f803f80, 0x3f803f80
.long 0xbdc90000, 0xbe95be48, 0xbef1bec4, 0xbf22bf0e
.long 0xbf7bbf80, 0xbf55bf6d, 0xbf0ebf35, 0xbe48bec4
.long 0x3e950000, 0x3f463f0e, 0x3f7f3f6d, 0x3f623f7b
.long 0x3f6d3f80, 0x3ec43f35, 0xbec40000, 0xbf6dbf35
.long 0xbef10000, 0xbf7fbf55, 0xbf22bf6d, 0x3e95be48
.long 0xbf55bf80, 0x3e48bec4, 0x3f7b3f35, 0x3f0e3f6d
.long 0x3f220000, 0x3f623f7b, 0xbe953ec4, 0xbf7fbf55
.long 0x3f353f80, 0xbf350000, 0xbf35bf80, 0x3f350000
.long 0xbf460000, 0xbef1bf7b, 0x3f753ec4, 0x3dc93f55
.long 0xbf0ebf80, 0x3f7b3ec4, 0xbe483f35, 0xbf55bf6d
.long 0x3f620000, 0xbdc93f55, 0xbf46bf6d, 0x3f753e48
.long 0x3ec43f80, 0xbf6dbf35, 0x3f6d0000, 0xbec43f35
.long 0xbf750000, 0x3f22bf0e, 0xbdc93f6d, 0xbef1bf7b
.long 0xbe48bf80, 0x3f0e3f6d, 0xbf55bf35, 0x3f7b3ec4
.long 0x3f7f0000, 0xbf753e48, 0x3f62bec4, 0xbf463f0e
.long 0x3f803f80, 0x3f803f80, 0x3f803f80, 0x3f803f80
.long 0xbf46bf35, 0xbf62bf55, 0xbf75bf6d, 0xbf7fbf7b
.long 0x3e480000, 0x3f0e3ec4, 0x3f553f35, 0x3f7b3f6d
.long 0x3ef13f35, 0xbdc93e48, 0xbf22bec4, 0xbf75bf55
.long 0xbf6dbf80, 0xbec4bf35, 0x3ec40000, 0x3f6d3f35
.long 0x3f753f35, 0x3f463f7b, 0xbdc93ec4, 0xbf62bf0e
.long 0xbf0e0000, 0xbf7bbf6d, 0xbe48bf35, 0x3f553ec4
.long 0xbdc9bf35, 0x3f753f0e, 0x3ef13f6d, 0xbf46be48
.long 0x3f353f80, 0xbf350000, 0xbf35bf80, 0x3f350000
.long 0xbf7fbf35, 0x3e95bf0e, 0x3f623f6d, 0xbf223e48
.long 0x3f550000, 0x3e483f6d, 0xbf7bbf35, 0x3f0ebec4
.long 0xbe953f35, 0xbf22bf7b, 0x3f7f3ec4, 0xbef13f0e
.long 0xbec4bf80, 0x3f6d3f35, 0xbf6d0000, 0x3ec4bf35
.long 0x3f623f35, 0xbf7fbe48, 0x3f46bec4, 0xbe953f55
.long 0xbf7b0000, 0x3f55bec4, 0xbf0e3f35, 0x3e48bf6d
.long 0x3f22bf35, 0xbef13f55, 0x3e95bf6d, 0xbdc93f7b
.long 0x3f803f80, 0x3f803f80, 0x3f803f80, 0x3f803f80
.long 0xbf7fbf80, 0xbf75bf7b, 0xbf62bf6d, 0xbf46bf55
.long 0x3f7b3f80, 0x3f553f6d, 0x3f0e3f35, 0x3e483ec4
.long 0xbf75bf80, 0xbf22bf55, 0xbdc9bec4, 0x3ef13e48
.long 0x3f6d3f80, 0x3ec43f35, 0xbec40000, 0xbf6dbf35
.long 0xbf62bf80, 0xbdc9bf0e, 0x3f463ec4, 0x3f753f7b
.long 0x3f553f80, 0xbe483ec4, 0xbf7bbf35, 0xbf0ebf6d
.long 0xbf46bf80, 0x3ef1be48, 0x3f753f6d, 0xbdc93f0e
.long 0x3f353f80, 0xbf350000, 0xbf35bf80, 0x3f350000
.long 0xbf22bf80, 0x3f623e48, 0x3e953f6d, 0xbf7fbf0e
.long 0x3f0e3f80, 0xbf7bbec4, 0x3e48bf35, 0x3f553f6d
.long 0xbef1bf80, 0x3f7f3f0e, 0xbf223ec4, 0xbe95bf7b
.long 0x3ec43f80, 0xbf6dbf35, 0x3f6d0000, 0xbec43f35
.long 0xbe95bf80, 0x3f463f55, 0xbf7fbec4, 0x3f62be48
.long 0x3e483f80, 0xbf0ebf6d, 0x3f553f35, 0xbf7bbec4
.long 0xbdc9bf80, 0x3e953f7b, 0xbef1bf6d, 0x3f223f55
.long 0x3f803f80, 0x3f803f80, 0x3f803f80, 0x3f803f80
.long 0xbf22bf35, 0xbef1bf0e, 0xbe95bec4, 0xbdc9be48
.long 0xbe480000, 0xbf0ebec4, 0xbf55bf35, 0xbf7bbf6d
.long 0x3f623f35, 0x3f7f3f7b, 0x3f463f6d, 0x3e953f0e
.long 0xbf6dbf80, 0xbec4bf35, 0x3ec40000, 0x3f6d3f35
.long 0x3e953f35, 0xbf22be48, 0xbf7fbf6d, 0xbef1bf55
.long 0x3f0e0000, 0x3f7b3f6d, 0x3e483f35, 0xbf55bec4
.long 0xbf7fbf35, 0xbe95bf55, 0x3f623ec4, 0x3f223f7b
.long 0x3f353f80, 0xbf350000, 0xbf35bf80, 0x3f350000
.long 0x3dc9bf35, 0x3f753f55, 0xbef13ec4, 0xbf46bf7b
.long 0xbf550000, 0xbe48bf6d, 0x3f7b3f35, 0xbf0e3ec4
.long 0x3f753f35, 0xbf463e48, 0xbdc9bf6d, 0x3f623f55
.long 0xbec4bf80, 0x3f6d3f35, 0xbf6d0000, 0x3ec4bf35
.long 0xbef13f35, 0xbdc9bf7b, 0x3f223f6d, 0xbf75bf0e
.long 0x3f7b0000, 0xbf553ec4, 0x3f0ebf35, 0xbe483f6d
.long 0xbf46bf35, 0x3f623f0e, 0xbf75bec4, 0x3f7f3e48
.long 0x3f803f80, 0x3f803f80, 0x3f803f80, 0x3f803f80
.long 0x3dc90000, 0x3e953e48, 0x3ef13ec4, 0x3f223f0e
.long 0xbf7bbf80, 0xbf55bf6d, 0xbf0ebf35, 0xbe48bec4
.long 0xbe950000, 0xbf46bf0e, 0xbf7fbf6d, 0xbf62bf7b
.long 0x3f6d3f80, 0x3ec43f35, 0xbec40000, 0xbf6dbf35
.long 0x3ef10000, 0x3f7f3f55, 0x3f223f6d, 0xbe953e48
.long 0xbf55bf80, 0x3e48bec4, 0x3f7b3f35, 0x3f0e3f6d
.long 0xbf220000, 0xbf62bf7b, 0x3e95bec4, 0x3f7f3f55
.long 0x3f353f80, 0xbf350000, 0xbf35bf80, 0x3f350000
.long 0x3f460000, 0x3ef13f7b, 0xbf75bec4, 0xbdc9bf55
.long 0xbf0ebf80, 0x3f7b3ec4, 0xbe483f35, 0xbf55bf6d
.long 0xbf620000, 0x3dc9bf55, 0x3f463f6d, 0xbf75be48
.long 0x3ec43f80, 0xbf6dbf35, 0x3f6d0000, 0xbec43f35
.long 0x3f750000, 0xbf223f0e, 0x3dc9bf6d, 0x3ef13f7b
.long 0xbe48bf80, 0x3f0e3f6d, 0xbf55bf35, 0x3f7b3ec4
.long 0xbf7f0000, 0x3f75be48, 0xbf623ec4, 0x3f46bf0e
.long 0x3f803f80, 0x3f803f80, 0x3f803f80, 0x3f803f80
.long 0x3f463f35, 0x3f623f55, 0x3f753f6d, 0x3f7f3f7b
.long 0x3e480000, 0x3f0e3ec4, 0x3f553f35, 0x3f7b3f6d
.long 0xbef1bf35, 0x3dc9be48, 0x3f223ec4, 0x3f753f55
.long 0xbf6dbf80, 0xbec4bf35, 0x3ec40000, 0x3f6d3f35
.long 0xbf75bf35, 0xbf46bf7b, 0x3dc9bec4, 0x3f623f0e
.long 0xbf0e0000, 0xbf7bbf6d, 0xbe48bf35, 0x3f553ec4
.long 0x3dc93f35, 0xbf75bf0e, 0xbef1bf6d, 0x3f463e48
.long 0x3f353f80, 0xbf350000, 0xbf35bf80, 0x3f350000
.long 0x3f7f3f35, 0xbe953f0e, 0xbf62bf6d, 0x3f22be48
.long 0x3f550000, 0x3e483f6d, 0xbf7bbf35, 0x3f0ebec4
.long 0x3e95bf35, 0x3f223f7b, 0xbf7fbec4, 0x3ef1bf0e
.long 0xbec4bf80, 0x3f6d3f35, 0xbf6d0000, 0x3ec4bf35
.long 0xbf62bf35, 0x3f7f3e48, 0xbf463ec4, 0x3e95bf55
.long 0xbf7b0000, 0x3f55bec4, 0xbf0e3f35, 0x3e48bf6d
.long 0xbf223f35, 0x3ef1bf55, 0xbe953f6d, 0x3dc9bf7b
.long 0x0, 0x0, 0x0, 0x0
.long 0x3dc90000, 0x3e953e48, 0x3ef13ec4, 0x3f223f0e
.long 0x3e480000, 0x3f0e3ec4, 0x3f553f35, 0x3f7b3f6d
.long 0x3e950000, 0x3f463f0e, 0x3f7f3f6d, 0x3f623f7b
.long 0x3ec40000, 0x3f6d3f35, 0x3f6d3f80, 0x3ec43f35
.long 0x3ef10000, 0x3f7f3f55, 0x3f223f6d, 0xbe953e48
.long 0x3f0e0000, 0x3f7b3f6d, 0x3e483f35, 0xbf55bec4
.long 0x3f220000, 0x3f623f7b, 0xbe953ec4, 0xbf7fbf55
.long 0x3f350000, 0x3f353f80, 0xbf350000, 0xbf35bf80
.long 0x3f460000, 0x3ef13f7b, 0xbf75bec4, 0xbdc9bf55
.long 0x3f550000, 0x3e483f6d, 0xbf7bbf35, 0x3f0ebec4
.long 0x3f620000, 0xbdc93f55, 0xbf46bf6d, 0x3f753e48
.long 0x3f6d0000, 0xbec43f35, 0xbec4bf80, 0x3f6d3f35
.long 0x3f750000, 0xbf223f0e, 0x3dc9bf6d, 0x3ef13f7b
.long 0x3f7b0000, 0xbf553ec4, 0x3f0ebf35, 0xbe483f6d
.long 0x3f7f0000, 0xbf753e48, 0x3f62bec4, 0xbf463f0e
.long 0x0, 0x0, 0x0, 0x0
.long 0x3f463f35, 0x3f623f55, 0x3f753f6d, 0x3f7f3f7b
.long 0x3f7b3f80, 0x3f553f6d, 0x3f0e3f35, 0x3e483ec4
.long 0x3ef13f35, 0xbdc93e48, 0xbf22bec4, 0xbf75bf55
.long 0xbec40000, 0xbf6dbf35, 0xbf6dbf80, 0xbec4bf35
.long 0xbf75bf35, 0xbf46bf7b, 0x3dc9bec4, 0x3f623f0e
.long 0xbf55bf80, 0x3e48bec4, 0x3f7b3f35, 0x3f0e3f6d
.long 0xbdc9bf35, 0x3f753f0e, 0x3ef13f6d, 0xbf46be48
.long 0x3f350000, 0x3f353f80, 0xbf350000, 0xbf35bf80
.long 0x3f7f3f35, 0xbe953f0e, 0xbf62bf6d, 0x3f22be48
.long 0x3f0e3f80, 0xbf7bbec4, 0x3e48bf35, 0x3f553f6d
.long 0xbe953f35, 0xbf22bf7b, 0x3f7f3ec4, 0xbef13f0e
.long 0xbf6d0000, 0x3ec4bf35, 0x3ec43f80, 0xbf6dbf35
.long 0xbf62bf35, 0x3f7f3e48, 0xbf463ec4, 0x3e95bf55
.long 0xbe48bf80, 0x3f0e3f6d, 0xbf55bf35, 0x3f7b3ec4
.long 0x3f22bf35, 0xbef13f55, 0x3e95bf6d, 0xbdc93f7b
.long 0x0, 0x0, 0x0, 0x0
.long 0x3f7f3f80, 0x3f753f7b, 0x3f623f6d, 0x3f463f55
.long 0xbe480000, 0xbf0ebec4, 0xbf55bf35, 0xbf7bbf6d
.long 0xbf75bf80, 0xbf22bf55, 0xbdc9bec4, 0x3ef13e48
.long 0x3ec40000, 0x3f6d3f35, 0x3f6d3f80, 0x3ec43f35
.long 0x3f623f80, 0x3dc93f0e, 0xbf46bec4, 0xbf75bf7b
.long 0xbf0e0000, 0xbf7bbf6d, 0xbe48bf35, 0x3f553ec4
.long 0xbf46bf80, 0x3ef1be48, 0x3f753f6d, 0xbdc93f0e
.long 0x3f350000, 0x3f353f80, 0xbf350000, 0xbf35bf80
.long 0x3f223f80, 0xbf62be48, 0xbe95bf6d, 0x3f7f3f0e
.long 0xbf550000, 0xbe48bf6d, 0x3f7b3f35, 0xbf0e3ec4
.long 0xbef1bf80, 0x3f7f3f0e, 0xbf223ec4, 0xbe95bf7b
.long 0x3f6d0000, 0xbec43f35, 0xbec4bf80, 0x3f6d3f35
.long 0x3e953f80, 0xbf46bf55, 0x3f7f3ec4, 0xbf623e48
.long 0xbf7b0000, 0x3f55bec4, 0xbf0e3f35, 0x3e48bf6d
.long 0xbdc9bf80, 0x3e953f7b, 0xbef1bf6d, 0x3f223f55
.long 0x0, 0x0, 0x0, 0x0
.long 0x3f223f35, 0x3ef13f0e, 0x3e953ec4, 0x3dc93e48
.long 0xbf7bbf80, 0xbf55bf6d, 0xbf0ebf35, 0xbe48bec4
.long 0x3f623f35, 0x3f7f3f7b, 0x3f463f6d, 0x3e953f0e
.long 0xbec40000, 0xbf6dbf35, 0xbf6dbf80, 0xbec4bf35
.long 0xbe95bf35, 0x3f223e48, 0x3f7f3f6d, 0x3ef13f55
.long 0x3f553f80, 0xbe483ec4, 0xbf7bbf35, 0xbf0ebf6d
.long 0xbf7fbf35, 0xbe95bf55, 0x3f623ec4, 0x3f223f7b
.long 0x3f350000, 0x3f353f80, 0xbf350000, 0xbf35bf80
.long 0xbdc93f35, 0xbf75bf55, 0x3ef1bec4, 0x3f463f7b
.long 0xbf0ebf80, 0x3f7b3ec4, 0xbe483f35, 0xbf55bf6d
.long 0x3f753f35, 0xbf463e48, 0xbdc9bf6d, 0x3f623f55
.long 0xbf6d0000, 0x3ec4bf35, 0x3ec43f80, 0xbf6dbf35
.long 0x3ef1bf35, 0x3dc93f7b, 0xbf22bf6d, 0x3f753f0e
.long 0x3e483f80, 0xbf0ebf6d, 0x3f553f35, 0xbf7bbec4
.long 0xbf46bf35, 0x3f623f0e, 0xbf75bec4, 0x3f7f3e48
.long 0x0, 0x0, 0x0, 0x0
.long 0xbdc90000, 0xbe95be48, 0xbef1bec4, 0xbf22bf0e
.long 0x3e480000, 0x3f0e3ec4, 0x3f553f35, 0x3f7b3f6d
.long 0xbe950000, 0xbf46bf0e, 0xbf7fbf6d, 0xbf62bf7b
.long 0x3ec40000, 0x3f6d3f35, 0x3f6d3f80, 0x3ec43f35
.long 0xbef10000, 0xbf7fbf55, 0xbf22bf6d, 0x3e95be48
.long 0x3f0e0000, 0x3f7b3f6d, 0x3e483f35, 0xbf55bec4
.long 0xbf220000, 0xbf62bf7b, 0x3e95bec4, 0x3f7f3f55
.long 0x3f350000, 0x3f353f80, 0xbf350000, 0xbf35bf80
.long 0xbf460000, 0xbef1bf7b, 0x3f753ec4, 0x3dc93f55
.long 0x3f550000, 0x3e483f6d, 0xbf7bbf35, 0x3f0ebec4
.long 0xbf620000, 0x3dc9bf55, 0x3f463f6d, 0xbf75be48
.long 0x3f6d0000, 0xbec43f35, 0xbec4bf80, 0x3f6d3f35
.long 0xbf750000, 0x3f22bf0e, 0xbdc93f6d, 0xbef1bf7b
.long 0x3f7b0000, 0xbf553ec4, 0x3f0ebf35, 0xbe483f6d
.long 0xbf7f0000, 0x3f75be48, 0xbf623ec4, 0x3f46bf0e
.long 0x0, 0x0, 0x0, 0x0
.long 0xbf46bf35, 0xbf62bf55, 0xbf75bf6d, 0xbf7fbf7b
.long 0x3f7b3f80, 0x3f553f6d, 0x3f0e3f35, 0x3e483ec4
.long 0xbef1bf35, 0x3dc9be48, 0x3f223ec4, 0x3f753f55
.long 0xbec40000, 0xbf6dbf35, 0xbf6dbf80, 0xbec4bf35
.long 0x3f753f35, 0x3f463f7b, 0xbdc93ec4, 0xbf62bf0e
.long 0xbf55bf80, 0x3e48bec4, 0x3f7b3f35, 0x3f0e3f6d
.long 0x3dc93f35, 0xbf75bf0e, 0xbef1bf6d, 0x3f463e48
.long 0x3f350000, 0x3f353f80, 0xbf350000, 0xbf35bf80
.long 0xbf7fbf35, 0x3e95bf0e, 0x3f623f6d, 0xbf223e48
.long 0x3f0e3f80, 0xbf7bbec4, 0x3e48bf35, 0x3f553f6d
.long 0x3e95bf35, 0x3f223f7b, 0xbf7fbec4, 0x3ef1bf0e
.long 0xbf6d0000, 0x3ec4bf35, 0x3ec43f80, 0xbf6dbf35
.long 0x3f623f35, 0xbf7fbe48, 0x3f46bec4, 0xbe953f55
.long 0xbe48bf80, 0x3f0e3f6d, 0xbf55bf35, 0x3f7b3ec4
.long 0xbf223f35, 0x3ef1bf55, 0xbe953f6d, 0x3dc9bf7b
.long 0x0, 0x0, 0x0, 0x0
.long 0xbf7fbf80, 0xbf75bf7b, 0xbf62bf6d, 0xbf46bf55
.long 0xbe480000, 0xbf0ebec4, 0xbf55bf35, 0xbf7bbf6d
.long 0x3f753f80, 0x3f223f55, 0x3dc93ec4, 0xbef1be48
.long 0x3ec40000, 0x3f6d3f35, 0x3f6d3f80, 0x3ec43f35
.long 0xbf62bf80, 0xbdc9bf0e, 0x3f463ec4, 0x3f753f7b
.long 0xbf0e0000, 0xbf7bbf6d, 0xbe48bf35, 0x3f553ec4
.long 0x3f463f80, 0xbef13e48, 0xbf75bf6d, 0x3dc9bf0e
.long 0x3f350000, 0x3f353f80, 0xbf350000, 0xbf35bf80
.long 0xbf22bf80, 0x3f623e48, 0x3e953f6d, 0xbf7fbf0e
.long 0xbf550000, 0xbe48bf6d, 0x3f7b3f35, 0xbf0e3ec4
.long 0x3ef13f80, 0xbf7fbf0e, 0x3f22bec4, 0x3e953f7b
.long 0x3f6d0000, 0xbec43f35, 0xbec4bf80, 0x3f6d3f35
.long 0xbe95bf80, 0x3f463f55, 0xbf7fbec4, 0x3f62be48
.long 0xbf7b0000, 0x3f55bec4, 0xbf0e3f35, 0x3e48bf6d
.long 0x3dc93f80, 0xbe95bf7b, 0x3ef13f6d, 0xbf22bf55
.long 0x0, 0x0, 0x0, 0x0
.long 0xbf22bf35, 0xbef1bf0e, 0xbe95bec4, 0xbdc9be48
.long 0xbf7bbf80, 0xbf55bf6d, 0xbf0ebf35, 0xbe48bec4
.long 0xbf62bf35, 0xbf7fbf7b, 0xbf46bf6d, 0xbe95bf0e
.long 0xbec40000, 0xbf6dbf35, 0xbf6dbf80, 0xbec4bf35
.long 0x3e953f35, 0xbf22be48, 0xbf7fbf6d, 0xbef1bf55
.long 0x3f553f80, 0xbe483ec4, 0xbf7bbf35, 0xbf0ebf6d
.long 0x3f7f3f35, 0x3e953f55, 0xbf62bec4, 0xbf22bf7b
.long 0x3f350000, 0x3f353f80, 0xbf350000, 0xbf35bf80
.long 0x3dc9bf35, 0x3f753f55, 0xbef13ec4, 0xbf46bf7b
.long 0xbf0ebf80, 0x3f7b3ec4, 0xbe483f35, 0xbf55bf6d
.long 0xbf75bf35, 0x3f46be48, 0x3dc93f6d, 0xbf62bf55
.long 0xbf6d0000, 0x3ec4bf35, 0x3ec43f80, 0xbf6dbf35
.long 0xbef13f35, 0xbdc9bf7b, 0x3f223f6d, 0xbf75bf0e
.long 0x3e483f80, 0xbf0ebf6d, 0x3f553f35, 0xbf7bbec4
.long 0x3f463f35, 0xbf62bf0e, 0x3f753ec4, 0xbf7fbe48
.long 0x3f80, 0xbf80, 0x3f80, 0xbf80
.long 0xbdc93f80, 0x3e95bf7b, 0xbef13f6d, 0x3f22bf55
.long 0xbe483f80, 0x3f0ebf6d, 0xbf553f35, 0x3f7bbec4
.long 0xbe953f80, 0x3f46bf55, 0xbf7f3ec4, 0x3f623e48
.long 0xbec43f80, 0x3f6dbf35, 0xbf6d0000, 0x3ec43f35
.long 0xbef13f80, 0x3f7fbf0e, 0xbf22bec4, 0xbe953f7b
.long 0xbf0e3f80, 0x3f7bbec4, 0xbe48bf35, 0xbf553f6d
.long 0xbf223f80, 0x3f62be48, 0x3e95bf6d, 0xbf7f3f0e
.long 0xbf353f80, 0x3f350000, 0x3f35bf80, 0xbf350000
.long 0xbf463f80, 0x3ef13e48, 0x3f75bf6d, 0xbdc9bf0e
.long 0xbf553f80, 0x3e483ec4, 0x3f7bbf35, 0x3f0ebf6d
.long 0xbf623f80, 0xbdc93f0e, 0x3f46bec4, 0x3f75bf7b
.long 0xbf6d3f80, 0xbec43f35, 0x3ec40000, 0x3f6dbf35
.long 0xbf753f80, 0xbf223f55, 0xbdc93ec4, 0x3ef1be48
.long 0xbf7b3f80, 0xbf553f6d, 0xbf0e3f35, 0xbe483ec4
.long 0xbf7f3f80, 0xbf753f7b, 0xbf623f6d, 0xbf463f55
.long 0x3f80, 0xbf80, 0x3f80, 0xbf80
.long 0xbf463f35, 0x3f62bf0e, 0xbf753ec4, 0x3f7fbe48
.long 0xbf7b0000, 0x3f553ec4, 0xbf0ebf35, 0x3e483f6d
.long 0xbef1bf35, 0xbdc93f7b, 0x3f22bf6d, 0xbf753f0e
.long 0x3ec4bf80, 0xbf6d3f35, 0x3f6d0000, 0xbec4bf35
.long 0x3f75bf35, 0xbf46be48, 0xbdc93f6d, 0x3f62bf55
.long 0x3f550000, 0x3e48bf6d, 0xbf7b3f35, 0x3f0e3ec4
.long 0x3dc93f35, 0x3f75bf55, 0xbef1bec4, 0xbf463f7b
.long 0xbf353f80, 0x3f350000, 0x3f35bf80, 0xbf350000
.long 0xbf7f3f35, 0xbe953f55, 0x3f62bec4, 0x3f22bf7b
.long 0xbf0e0000, 0xbf7b3f6d, 0xbe483f35, 0x3f55bec4
.long 0x3e95bf35, 0xbf223e48, 0xbf7f3f6d, 0xbef13f55
.long 0x3f6dbf80, 0x3ec4bf35, 0xbec40000, 0xbf6d3f35
.long 0x3f62bf35, 0x3f7fbf7b, 0x3f46bf6d, 0x3e95bf0e
.long 0x3e480000, 0x3f0ebec4, 0x3f55bf35, 0x3f7bbf6d
.long 0xbf223f35, 0xbef13f0e, 0xbe953ec4, 0xbdc93e48
.long 0x3f80, 0xbf80, 0x3f80, 0xbf80
.long 0xbf7f0000, 0x3f753e48, 0xbf62bec4, 0x3f463f0e
.long 0x3e48bf80, 0xbf0e3f6d, 0x3f55bf35, 0xbf7b3ec4
.long 0x3f750000, 0xbf22bf0e, 0x3dc93f6d, 0x3ef1bf7b
.long 0xbec43f80, 0x3f6dbf35, 0xbf6d0000, 0x3ec43f35
.long 0xbf620000, 0x3dc93f55, 0x3f46bf6d, 0xbf753e48
.long 0x3f0ebf80, 0xbf7b3ec4, 0x3e483f35, 0x3f55bf6d
.long 0x3f460000, 0x3ef1bf7b, 0xbf753ec4, 0xbdc93f55
.long 0xbf353f80, 0x3f350000, 0x3f35bf80, 0xbf350000
.long 0xbf220000, 0xbf623f7b, 0x3e953ec4, 0x3f7fbf55
.long 0x3f55bf80, 0xbe48bec4, 0xbf7b3f35, 0xbf0e3f6d
.long 0x3ef10000, 0x3f7fbf55, 0x3f22bf6d, 0xbe95be48
.long 0xbf6d3f80, 0xbec43f35, 0x3ec40000, 0x3f6dbf35
.long 0xbe950000, 0xbf463f0e, 0xbf7f3f6d, 0xbf623f7b
.long 0x3f7bbf80, 0x3f55bf6d, 0x3f0ebf35, 0x3e48bec4
.long 0x3dc90000, 0x3e95be48, 0x3ef1bec4, 0x3f22bf0e
.long 0x3f80, 0xbf80, 0x3f80, 0xbf80
.long 0xbf22bf35, 0x3ef13f55, 0xbe95bf6d, 0x3dc93f7b
.long 0x3f7b0000, 0xbf55bec4, 0x3f0e3f35, 0xbe48bf6d
.long 0xbf623f35, 0x3f7fbe48, 0xbf46bec4, 0x3e953f55
.long 0x3ec4bf80, 0xbf6d3f35, 0x3f6d0000, 0xbec4bf35
.long 0x3e953f35, 0x3f22bf7b, 0xbf7f3ec4, 0x3ef13f0e
.long 0xbf550000, 0xbe483f6d, 0x3f7bbf35, 0xbf0ebec4
.long 0x3f7fbf35, 0xbe95bf0e, 0xbf623f6d, 0x3f223e48
.long 0xbf353f80, 0x3f350000, 0x3f35bf80, 0xbf350000
.long 0x3dc9bf35, 0xbf753f0e, 0xbef13f6d, 0x3f46be48
.long 0x3f0e0000, 0x3f7bbf6d, 0x3e48bf35, 0xbf553ec4
.long 0xbf753f35, 0xbf463f7b, 0x3dc93ec4, 0x3f62bf0e
.long 0x3f6dbf80, 0x3ec4bf35, 0xbec40000, 0xbf6d3f35
.long 0xbef13f35, 0x3dc93e48, 0x3f22bec4, 0x3f75bf55
.long 0xbe480000, 0xbf0e3ec4, 0xbf553f35, 0xbf7b3f6d
.long 0x3f46bf35, 0x3f62bf55, 0x3f75bf6d, 0x3f7fbf7b
.long 0x3f80, 0xbf80, 0x3f80, 0xbf80
.long 0x3dc9bf80, 0xbe953f7b, 0x3ef1bf6d, 0xbf223f55
.long 0xbe483f80, 0x3f0ebf6d, 0xbf553f35, 0x3f7bbec4
.long 0x3e95bf80, 0xbf463f55, 0x3f7fbec4, 0xbf62be48
.long 0xbec43f80, 0x3f6dbf35, 0xbf6d0000, 0x3ec43f35
.long 0x3ef1bf80, 0xbf7f3f0e, 0x3f223ec4, 0x3e95bf7b
.long 0xbf0e3f80, 0x3f7bbec4, 0xbe48bf35, 0xbf553f6d
.long 0x3f22bf80, 0xbf623e48, 0xbe953f6d, 0x3f7fbf0e
.long 0xbf353f80, 0x3f350000, 0x3f35bf80, 0xbf350000
.long 0x3f46bf80, 0xbef1be48, 0xbf753f6d, 0x3dc93f0e
.long 0xbf553f80, 0x3e483ec4, 0x3f7bbf35, 0x3f0ebf6d
.long 0x3f62bf80, 0x3dc9bf0e, 0xbf463ec4, 0xbf753f7b
.long 0xbf6d3f80, 0xbec43f35, 0x3ec40000, 0x3f6dbf35
.long 0x3f75bf80, 0x3f22bf55, 0x3dc9bec4, 0xbef13e48
.long 0xbf7b3f80, 0xbf553f6d, 0xbf0e3f35, 0xbe483ec4
.long 0x3f7fbf80, 0x3f75bf7b, 0x3f62bf6d, 0x3f46bf55
.long 0x3f80, 0xbf80, 0x3f80, 0xbf80
.long 0x3f46bf35, 0xbf623f0e, 0x3f75bec4, 0xbf7f3e48
.long 0xbf7b0000, 0x3f553ec4, 0xbf0ebf35, 0x3e483f6d
.long 0x3ef13f35, 0x3dc9bf7b, 0xbf223f6d, 0x3f75bf0e
.long 0x3ec4bf80, 0xbf6d3f35, 0x3f6d0000, 0xbec4bf35
.long 0xbf753f35, 0x3f463e48, 0x3dc9bf6d, 0xbf623f55
.long 0x3f550000, 0x3e48bf6d, 0xbf7b3f35, 0x3f0e3ec4
.long 0xbdc9bf35, 0xbf753f55, 0x3ef13ec4, 0x3f46bf7b
.long 0xbf353f80, 0x3f350000, 0x3f35bf80, 0xbf350000
.long 0x3f7fbf35, 0x3e95bf55, 0xbf623ec4, 0xbf223f7b
.long 0xbf0e0000, 0xbf7b3f6d, 0xbe483f35, 0x3f55bec4
.long 0xbe953f35, 0x3f22be48, 0x3f7fbf6d, 0x3ef1bf55
.long 0x3f6dbf80, 0x3ec4bf35, 0xbec40000, 0xbf6d3f35
.long 0xbf623f35, 0xbf7f3f7b, 0xbf463f6d, 0xbe953f0e
.long 0x3e480000, 0x3f0ebec4, 0x3f55bf35, 0x3f7bbf6d
.long 0x3f22bf35, 0x3ef1bf0e, 0x3e95bec4, 0x3dc9be48
.long 0x3f80, 0xbf80, 0x3f80, 0xbf80
.long 0x3f7f0000, 0xbf75be48, 0x3f623ec4, 0xbf46bf0e
.long 0x3e48bf80, 0xbf0e3f6d, 0x3f55bf35, 0xbf7b3ec4
.long 0xbf750000, 0x3f223f0e, 0xbdc9bf6d, 0xbef13f7b
.long 0xbec43f80, 0x3f6dbf35, 0xbf6d0000, 0x3ec43f35
.long 0x3f620000, 0xbdc9bf55, 0xbf463f6d, 0x3f75be48
.long 0x3f0ebf80, 0xbf7b3ec4, 0x3e483f35, 0x3f55bf6d
.long 0xbf460000, 0xbef13f7b, 0x3f75bec4, 0x3dc9bf55
.long 0xbf353f80, 0x3f350000, 0x3f35bf80, 0xbf350000
.long 0x3f220000, 0x3f62bf7b, 0xbe95bec4, 0xbf7f3f55
.long 0x3f55bf80, 0xbe48bec4, 0xbf7b3f35, 0xbf0e3f6d
.long 0xbef10000, 0xbf7f3f55, 0xbf223f6d, 0x3e953e48
.long 0xbf6d3f80, 0xbec43f35, 0x3ec40000, 0x3f6dbf35
.long 0x3e950000, 0x3f46bf0e, 0x3f7fbf6d, 0x3f62bf7b
.long 0x3f7bbf80, 0x3f55bf6d, 0x3f0ebf35, 0x3e48bec4
.long 0xbdc90000, 0xbe953e48, 0xbef13ec4, 0xbf223f0e
.long 0x3f80, 0xbf80, 0x3f80, 0xbf80
.long 0x3f223f35, 0xbef1bf55, 0x3e953f6d, 0xbdc9bf7b
.long 0x3f7b0000, 0xbf55bec4, 0x3f0e3f35, 0xbe48bf6d
.long 0x3f62bf35, 0xbf7f3e48, 0x3f463ec4, 0xbe95bf55
.long 0x3ec4bf80, 0xbf6d3f35, 0x3f6d0000, 0xbec4bf35
.long 0xbe95bf35, 0xbf223f7b, 0x3f7fbec4, 0xbef1bf0e
.long 0xbf550000, 0xbe483f6d, 0x3f7bbf35, 0xbf0ebec4
.long 0xbf7f3f35, 0x3e953f0e, 0x3f62bf6d, 0xbf22be48
.long 0xbf353f80, 0x3f350000, 0x3f35bf80, 0xbf350000
.long 0xbdc93f35, 0x3f75bf0e, 0x3ef1bf6d, 0xbf463e48
.long 0x3f0e0000, 0x3f7bbf6d, 0x3e48bf35, 0xbf553ec4
.long 0x3f75bf35, 0x3f46bf7b, 0xbdc9bec4, 0xbf623f0e
.long 0x3f6dbf80, 0x3ec4bf35, 0xbec40000, 0xbf6d3f35
.long 0x3ef1bf35, 0xbdc9be48, 0xbf223ec4, 0xbf753f55
.long 0xbe480000, 0xbf0e3ec4, 0xbf553f35, 0xbf7b3f6d
.long 0xbf463f35, 0xbf623f55, 0xbf753f6d, 0xbf7f3f7b
.long 0x3f800000, 0xbf800000, 0x3f800000, 0xbf800000
.long 0x3f7f0000, 0xbf75be48, 0x3f623ec4, 0xbf46bf0e
.long 0x3f7b0000, 0xbf55bec4, 0x3f0e3f35, 0xbe48bf6d
.long 0x3f750000, 0xbf22bf0e, 0x3dc93f6d, 0x3ef1bf7b
.long 0x3f6d0000, 0xbec4bf35, 0xbec43f80, 0x3f6dbf35
.long 0x3f620000, 0xbdc9bf55, 0xbf463f6d, 0x3f75be48
.long 0x3f550000, 0x3e48bf6d, 0xbf7b3f35, 0x3f0e3ec4
.long 0x3f460000, 0x3ef1bf7b, 0xbf753ec4, 0xbdc93f55
.long 0x3f350000, 0x3f35bf80, 0xbf350000, 0xbf353f80
.long 0x3f220000, 0x3f62bf7b, 0xbe95bec4, 0xbf7f3f55
.long 0x3f0e0000, 0x3f7bbf6d, 0x3e48bf35, 0xbf553ec4
.long 0x3ef10000, 0x3f7fbf55, 0x3f22bf6d, 0xbe95be48
.long 0x3ec40000, 0x3f6dbf35, 0x3f6dbf80, 0x3ec4bf35
.long 0x3e950000, 0x3f46bf0e, 0x3f7fbf6d, 0x3f62bf7b
.long 0x3e480000, 0x3f0ebec4, 0x3f55bf35, 0x3f7bbf6d
.long 0x3dc90000, 0x3e95be48, 0x3ef1bec4, 0x3f22bf0e
.long 0x3f800000, 0xbf800000, 0x3f800000, 0xbf800000
.long 0x3f223f35, 0xbef1bf55, 0x3e953f6d, 0xbdc9bf7b
.long 0xbe483f80, 0x3f0ebf6d, 0xbf553f35, 0x3f7bbec4
.long 0xbf623f35, 0x3f7fbe48, 0xbf46bec4, 0x3e953f55
.long 0xbf6d0000, 0x3ec43f35, 0x3ec4bf80, 0xbf6d3f35
.long 0xbe95bf35, 0xbf223f7b, 0x3f7fbec4, 0xbef1bf0e
.long 0x3f0ebf80, 0xbf7b3ec4, 0x3e483f35, 0x3f55bf6d
.long 0x3f7fbf35, 0xbe95bf0e, 0xbf623f6d, 0x3f223e48
.long 0x3f350000, 0x3f35bf80, 0xbf350000, 0xbf353f80
.long 0xbdc93f35, 0x3f75bf0e, 0x3ef1bf6d, 0xbf463e48
.long 0xbf553f80, 0x3e483ec4, 0x3f7bbf35, 0x3f0ebf6d
.long 0xbf753f35, 0xbf463f7b, 0x3dc93ec4, 0x3f62bf0e
.long 0xbec40000, 0xbf6d3f35, 0xbf6d3f80, 0xbec43f35
.long 0x3ef1bf35, 0xbdc9be48, 0xbf223ec4, 0xbf753f55
.long 0x3f7bbf80, 0x3f55bf6d, 0x3f0ebf35, 0x3e48bec4
.long 0x3f46bf35, 0x3f62bf55, 0x3f75bf6d, 0x3f7fbf7b
.long 0x3f800000, 0xbf800000, 0x3f800000, 0xbf800000
.long 0xbdc93f80, 0x3e95bf7b, 0xbef13f6d, 0x3f22bf55
.long 0xbf7b0000, 0x3f553ec4, 0xbf0ebf35, 0x3e483f6d
.long 0x3e95bf80, 0xbf463f55, 0x3f7fbec4, 0xbf62be48
.long 0x3f6d0000, 0xbec4bf35, 0xbec43f80, 0x3f6dbf35
.long 0xbef13f80, 0x3f7fbf0e, 0xbf22bec4, 0xbe953f7b
.long 0xbf550000, 0xbe483f6d, 0x3f7bbf35, 0xbf0ebec4
.long 0x3f22bf80, 0xbf623e48, 0xbe953f6d, 0x3f7fbf0e
.long 0x3f350000, 0x3f35bf80, 0xbf350000, 0xbf353f80
.long 0xbf463f80, 0x3ef13e48, 0x3f75bf6d, 0xbdc9bf0e
.long 0xbf0e0000, 0xbf7b3f6d, 0xbe483f35, 0x3f55bec4
.long 0x3f62bf80, 0x3dc9bf0e, 0xbf463ec4, 0xbf753f7b
.long 0x3ec40000, 0x3f6dbf35, 0x3f6dbf80, 0x3ec4bf35
.long 0xbf753f80, 0xbf223f55, 0xbdc93ec4, 0x3ef1be48
.long 0xbe480000, 0xbf0e3ec4, 0xbf553f35, 0xbf7b3f6d
.long 0x3f7fbf80, 0x3f75bf7b, 0x3f62bf6d, 0x3f46bf55
.long 0x3f800000, 0xbf800000, 0x3f800000, 0xbf800000
.long 0xbf463f35, 0x3f62bf0e, 0xbf753ec4, 0x3f7fbe48
.long 0x3e48bf80, 0xbf0e3f6d, 0x3f55bf35, 0xbf7b3ec4
.long 0x3ef13f35, 0x3dc9bf7b, 0xbf223f6d, 0x3f75bf0e
.long 0xbf6d0000, 0x3ec43f35, 0x3ec4bf80, 0xbf6d3f35
.long 0x3f75bf35, 0xbf46be48, 0xbdc93f6d, 0x3f62bf55
.long 0xbf0e3f80, 0x3f7bbec4, 0xbe48bf35, 0xbf553f6d
.long 0xbdc9bf35, 0xbf753f55, 0x3ef13ec4, 0x3f46bf7b
.long 0x3f350000, 0x3f35bf80, 0xbf350000, 0xbf353f80
.long 0xbf7f3f35, 0xbe953f55, 0x3f62bec4, 0x3f22bf7b
.long 0x3f55bf80, 0xbe48bec4, 0xbf7b3f35, 0xbf0e3f6d
.long 0xbe953f35, 0x3f22be48, 0x3f7fbf6d, 0x3ef1bf55
.long 0xbec40000, 0xbf6d3f35, 0xbf6d3f80, 0xbec43f35
.long 0x3f62bf35, 0x3f7fbf7b, 0x3f46bf6d, 0x3e95bf0e
.long 0xbf7b3f80, 0xbf553f6d, 0xbf0e3f35, 0xbe483ec4
.long 0x3f22bf35, 0x3ef1bf0e, 0x3e95bec4, 0x3dc9be48
.long 0x3f800000, 0xbf800000, 0x3f800000, 0xbf800000
.long 0xbf7f0000, 0x3f753e48, 0xbf62bec4, 0x3f463f0e
.long 0x3f7b0000, 0xbf55bec4, 0x3f0e3f35, 0xbe48bf6d
.long 0xbf750000, 0x3f223f0e, 0xbdc9bf6d, 0xbef13f7b
.long 0x3f6d0000, 0xbec4bf35, 0xbec43f80, 0x3f6dbf35
.long 0xbf620000, 0x3dc93f55, 0x3f46bf6d, 0xbf753e48
.long 0x3f550000, 0x3e48bf6d, 0xbf7b3f35, 0x3f0e3ec4
.long 0xbf460000, 0xbef13f7b, 0x3f75bec4, 0x3dc9bf55
.long 0x3f350000, 0x3f35bf80, 0xbf350000, 0xbf353f80
.long 0xbf220000, 0xbf623f7b, 0x3e953ec4, 0x3f7fbf55
.long 0x3f0e0000, 0x3f7bbf6d, 0x3e48bf35, 0xbf553ec4
.long 0xbef10000, 0xbf7f3f55, 0xbf223f6d, 0x3e953e48
.long 0x3ec40000, 0x3f6dbf35, 0x3f6dbf80, 0x3ec4bf35
.long 0xbe950000, 0xbf463f0e, 0xbf7f3f6d, 0xbf623f7b
.long 0x3e480000, 0x3f0ebec4, 0x3f55bf35, 0x3f7bbf6d
.long 0xbdc90000, 0xbe953e48, 0xbef13ec4, 0xbf223f0e
.long 0x3f800000, 0xbf800000, 0x3f800000, 0xbf800000
.long 0xbf22bf35, 0x3ef13f55, 0xbe95bf6d, 0x3dc93f7b
.long 0xbe483f80, 0x3f0ebf6d, 0xbf553f35, 0x3f7bbec4
.long 0x3f62bf35, 0xbf7f3e48, 0x3f463ec4, 0xbe95bf55
.long 0xbf6d0000, 0x3ec43f35, 0x3ec4bf80, 0xbf6d3f35
.long 0x3e953f35, 0x3f22bf7b, 0xbf7f3ec4, 0x3ef13f0e
.long 0x3f0ebf80, 0xbf7b3ec4, 0x3e483f35, 0x3f55bf6d
.long 0xbf7f3f35, 0x3e953f0e, 0x3f62bf6d, 0xbf22be48
.long 0x3f350000, 0x3f35bf80, 0xbf350000, 0xbf353f80
.long 0x3dc9bf35, 0xbf753f0e, 0xbef13f6d, 0x3f46be48
.long 0xbf553f80, 0x3e483ec4, 0x3f7bbf35, 0x3f0ebf6d
.long 0x3f75bf35, 0x3f46bf7b, 0xbdc9bec4, 0xbf623f0e
.long 0xbec40000, 0xbf6d3f35, 0xbf6d3f80, 0xbec43f35
.long 0xbef13f35, 0x3dc93e48, 0x3f22bec4, 0x3f75bf55
.long 0x3f7bbf80, 0x3f55bf6d, 0x3f0ebf35, 0x3e48bec4
.long 0xbf463f35, 0xbf623f55, 0xbf753f6d, 0xbf7f3f7b
.long 0x3f800000, 0xbf800000, 0x3f800000, 0xbf800000
.long 0x3dc9bf80, 0xbe953f7b, 0x3ef1bf6d, 0xbf223f55
.long 0xbf7b0000, 0x3f553ec4, 0xbf0ebf35, 0x3e483f6d
.long 0xbe953f80, 0x3f46bf55, 0xbf7f3ec4, 0x3f623e48
.long 0x3f6d0000, 0xbec4bf35, 0xbec43f80, 0x3f6dbf35
.long 0x3ef1bf80, 0xbf7f3f0e, 0x3f223ec4, 0x3e95bf7b
.long 0xbf550000, 0xbe483f6d, 0x3f7bbf35, 0xbf0ebec4
.long 0xbf223f80, 0x3f62be48, 0x3e95bf6d, 0xbf7f3f0e
.long 0x3f350000, 0x3f35bf80, 0xbf350000, 0xbf353f80
.long 0x3f46bf80, 0xbef1be48, 0xbf753f6d, 0x3dc93f0e
.long 0xbf0e0000, 0xbf7b3f6d, 0xbe483f35, 0x3f55bec4
.long 0xbf623f80, 0xbdc93f0e, 0x3f46bec4, 0x3f75bf7b
.long 0x3ec40000, 0x3f6dbf35, 0x3f6dbf80, 0x3ec4bf35
.long 0x3f75bf80, 0x3f22bf55, 0x3dc9bec4, 0xbef13e48
.long 0xbe480000, 0xbf0e3ec4, 0xbf553f35, 0xbf7b3f6d
.long 0xbf7f3f80, 0xbf753f7b, 0xbf623f6d, 0xbf463f55
.long 0x3f800000, 0xbf800000, 0x3f800000, 0xbf800000
.long 0x3f46bf35, 0xbf623f0e, 0x3f75bec4, 0xbf7f3e48
.long 0x3e48bf80, 0xbf0e3f6d, 0x3f55bf35, 0xbf7b3ec4
.long 0xbef1bf35, 0xbdc93f7b, 0x3f22bf6d, 0xbf753f0e
.long 0xbf6d0000, 0x3ec43f35, 0x3ec4bf80, 0xbf6d3f35
.long 0xbf753f35, 0x3f463e48, 0x3dc9bf6d, 0xbf623f55
.long 0xbf0e3f80, 0x3f7bbec4, 0xbe48bf35, 0xbf553f6d
.long 0x3dc93f35, 0x3f75bf55, 0xbef1bec4, 0xbf463f7b
.long 0x3f350000, 0x3f35bf80, 0xbf350000, 0xbf353f80
.long 0x3f7fbf35, 0x3e95bf55, 0xbf623ec4, 0xbf223f7b
.long 0x3f55bf80, 0xbe48bec4, 0xbf7b3f35, 0xbf0e3f6d
.long 0x3e95bf35, 0xbf223e48, 0xbf7f3f6d, 0xbef13f55
.long 0xbec40000, 0xbf6d3f35, 0xbf6d3f80, 0xbec43f35
.long 0xbf623f35, 0xbf7f3f7b, 0xbf463f6d, 0xbe953f0e
.long 0xbf7b3f80, 0xbf553f6d, 0xbf0e3f35, 0xbe483ec4
.long 0xbf223f35, 0xbef13f0e, 0xbe953ec4, 0xbdc93e48
.long 0xbf803f80, 0xbf803f80, 0xbf803f80, 0xbf803f80
.long 0xbf7f3f80, 0xbf753f7b, 0xbf623f6d, 0xbf463f55
.long 0xbf7b3f80, 0xbf553f6d, 0xbf0e3f35, 0xbe483ec4
.long 0xbf753f80, 0xbf223f55, 0xbdc93ec4, 0x3ef1be48
.long 0xbf6d3f80, 0xbec43f35, 0x3ec40000, 0x3f6dbf35
.long 0xbf623f80, 0xbdc93f0e, 0x3f46bec4, 0x3f75bf7b
.long 0xbf553f80, 0x3e483ec4, 0x3f7bbf35, 0x3f0ebf6d
.long 0xbf463f80, 0x3ef13e48, 0x3f75bf6d, 0xbdc9bf0e
.long 0xbf353f80, 0x3f350000, 0x3f35bf80, 0xbf350000
.long 0xbf223f80, 0x3f62be48, 0x3e95bf6d, 0xbf7f3f0e
.long 0xbf0e3f80, 0x3f7bbec4, 0xbe48bf35, 0xbf553f6d
.long 0xbef13f80, 0x3f7fbf0e, 0xbf22bec4, 0xbe953f7b
.long 0xbec43f80, 0x3f6dbf35, 0xbf6d0000, 0x3ec43f35
.long 0xbe953f80, 0x3f46bf55, 0xbf7f3ec4, 0x3f623e48
.long 0xbe483f80, 0x3f0ebf6d, 0xbf553f35, 0x3f7bbec4
.long 0xbdc93f80, 0x3e95bf7b, 0xbef13f6d, 0x3f22bf55
.long 0xbf803f80, 0xbf803f80, 0xbf803f80, 0xbf803f80
.long 0xbf223f35, 0xbef13f0e, 0xbe953ec4, 0xbdc93e48
.long 0x3e480000, 0x3f0ebec4, 0x3f55bf35, 0x3f7bbf6d
.long 0x3f62bf35, 0x3f7fbf7b, 0x3f46bf6d, 0x3e95bf0e
.long 0x3f6dbf80, 0x3ec4bf35, 0xbec40000, 0xbf6d3f35
.long 0x3e95bf35, 0xbf223e48, 0xbf7f3f6d, 0xbef13f55
.long 0xbf0e0000, 0xbf7b3f6d, 0xbe483f35, 0x3f55bec4
.long 0xbf7f3f35, 0xbe953f55, 0x3f62bec4, 0x3f22bf7b
.long 0xbf353f80, 0x3f350000, 0x3f35bf80, 0xbf350000
.long 0x3dc93f35, 0x3f75bf55, 0xbef1bec4, 0xbf463f7b
.long 0x3f550000, 0x3e48bf6d, 0xbf7b3f35, 0x3f0e3ec4
.long 0x3f75bf35, 0xbf46be48, 0xbdc93f6d, 0x3f62bf55
.long 0x3ec4bf80, 0xbf6d3f35, 0x3f6d0000, 0xbec4bf35
.long 0xbef1bf35, 0xbdc93f7b, 0x3f22bf6d, 0xbf753f0e
.long 0xbf7b0000, 0x3f553ec4, 0xbf0ebf35, 0x3e483f6d
.long 0xbf463f35, 0x3f62bf0e, 0xbf753ec4, 0x3f7fbe48
.long 0xbf803f80, 0xbf803f80, 0xbf803f80, 0xbf803f80
.long 0x3dc90000, 0x3e95be48, 0x3ef1bec4, 0x3f22bf0e
.long 0x3f7bbf80, 0x3f55bf6d, 0x3f0ebf35, 0x3e48bec4
.long 0xbe950000, 0xbf463f0e, 0xbf7f3f6d, 0xbf623f7b
.long 0xbf6d3f80, 0xbec43f35, 0x3ec40000, 0x3f6dbf35
.long 0x3ef10000, 0x3f7fbf55, 0x3f22bf6d, 0xbe95be48
.long 0x3f55bf80, 0xbe48bec4, 0xbf7b3f35, 0xbf0e3f6d
.long 0xbf220000, 0xbf623f7b, 0x3e953ec4, 0x3f7fbf55
.long 0xbf353f80, 0x3f350000, 0x3f35bf80, 0xbf350000
.long 0x3f460000, 0x3ef1bf7b, 0xbf753ec4, 0xbdc93f55
.long 0x3f0ebf80, 0xbf7b3ec4, 0x3e483f35, 0x3f55bf6d
.long 0xbf620000, 0x3dc93f55, 0x3f46bf6d, 0xbf753e48
.long 0xbec43f80, 0x3f6dbf35, 0xbf6d0000, 0x3ec43f35
.long 0x3f750000, 0xbf22bf0e, 0x3dc93f6d, 0x3ef1bf7b
.long 0x3e48bf80, 0xbf0e3f6d, 0x3f55bf35, 0xbf7b3ec4
.long 0xbf7f0000, 0x3f753e48, 0xbf62bec4, 0x3f463f0e
.long 0xbf803f80, 0xbf803f80, 0xbf803f80, 0xbf803f80
.long 0x3f46bf35, 0x3f62bf55, 0x3f75bf6d, 0x3f7fbf7b
.long 0xbe480000, 0xbf0e3ec4, 0xbf553f35, 0xbf7b3f6d
.long 0xbef13f35, 0x3dc93e48, 0x3f22bec4, 0x3f75bf55
.long 0x3f6dbf80, 0x3ec4bf35, 0xbec40000, 0xbf6d3f35
.long 0xbf753f35, 0xbf463f7b, 0x3dc93ec4, 0x3f62bf0e
.long 0x3f0e0000, 0x3f7bbf6d, 0x3e48bf35, 0xbf553ec4
.long 0x3dc9bf35, 0xbf753f0e, 0xbef13f6d, 0x3f46be48
.long 0xbf353f80, 0x3f350000, 0x3f35bf80, 0xbf350000
.long 0x3f7fbf35, 0xbe95bf0e, 0xbf623f6d, 0x3f223e48
.long 0xbf550000, 0xbe483f6d, 0x3f7bbf35, 0xbf0ebec4
.long 0x3e953f35, 0x3f22bf7b, 0xbf7f3ec4, 0x3ef13f0e
.long 0x3ec4bf80, 0xbf6d3f35, 0x3f6d0000, 0xbec4bf35
.long 0xbf623f35, 0x3f7fbe48, 0xbf46bec4, 0x3e953f55
.long 0x3f7b0000, 0xbf55bec4, 0x3f0e3f35, 0xbe48bf6d
.long 0xbf22bf35, 0x3ef13f55, 0xbe95bf6d, 0x3dc93f7b
.long 0xbf803f80, 0xbf803f80, 0xbf803f80, 0xbf803f80
.long 0x3f7fbf80, 0x3f75bf7b, 0x3f62bf6d, 0x3f46bf55
.long 0xbf7b3f80, 0xbf553f6d, 0xbf0e3f35, 0xbe483ec4
.long 0x3f75bf80, 0x3f22bf55, 0x3dc9bec4, 0xbef13e48
.long 0xbf6d3f80, 0xbec43f35, 0x3ec40000, 0x3f6dbf35
.long 0x3f62bf80, 0x3dc9bf0e, 0xbf463ec4, 0xbf753f7b
.long 0xbf553f80, 0x3e483ec4, 0x3f7bbf35, 0x3f0ebf6d
.long 0x3f46bf80, 0xbef1be48, 0xbf753f6d, 0x3dc93f0e
.long 0xbf353f80, 0x3f350000, 0x3f35bf80, 0xbf350000
.long 0x3f22bf80, 0xbf623e48, 0xbe953f6d, 0x3f7fbf0e
.long 0xbf0e3f80, 0x3f7bbec4, 0xbe48bf35, 0xbf553f6d
.long 0x3ef1bf80, 0xbf7f3f0e, 0x3f223ec4, 0x3e95bf7b
.long 0xbec43f80, 0x3f6dbf35, 0xbf6d0000, 0x3ec43f35
.long 0x3e95bf80, 0xbf463f55, 0x3f7fbec4, 0xbf62be48
.long 0xbe483f80, 0x3f0ebf6d, 0xbf553f35, 0x3f7bbec4
.long 0x3dc9bf80, 0xbe953f7b, 0x3ef1bf6d, 0xbf223f55
.long 0xbf803f80, 0xbf803f80, 0xbf803f80, 0xbf803f80
.long 0x3f22bf35, 0x3ef1bf0e, 0x3e95bec4, 0x3dc9be48
.long 0x3e480000, 0x3f0ebec4, 0x3f55bf35, 0x3f7bbf6d
.long 0xbf623f35, 0xbf7f3f7b, 0xbf463f6d, 0xbe953f0e
.long 0x3f6dbf80, 0x3ec4bf35, 0xbec40000, 0xbf6d3f35
.long 0xbe953f35, 0x3f22be48, 0x3f7fbf6d, 0x3ef1bf55
.long 0xbf0e0000, 0xbf7b3f6d, 0xbe483f35, 0x3f55bec4
.long 0x3f7fbf35, 0x3e95bf55, 0xbf623ec4, 0xbf223f7b
.long 0xbf353f80, 0x3f350000, 0x3f35bf80, 0xbf350000
.long 0xbdc9bf35, 0xbf753f55, 0x3ef13ec4, 0x3f46bf7b
.long 0x3f550000, 0x3e48bf6d, 0xbf7b3f35, 0x3f0e3ec4
.long 0xbf753f35, 0x3f463e48, 0x3dc9bf6d, 0xbf623f55
.long 0x3ec4bf80, 0xbf6d3f35, 0x3f6d0000, 0xbec4bf35
.long 0x3ef13f35, 0x3dc9bf7b, 0xbf223f6d, 0x3f75bf0e
.long 0xbf7b0000, 0x3f553ec4, 0xbf0ebf35, 0x3e483f6d
.long 0x3f46bf35, 0xbf623f0e, 0x3f75bec4, 0xbf7f3e48
.long 0xbf803f80, 0xbf803f80, 0xbf803f80, 0xbf803f80
.long 0xbdc90000, 0xbe953e48, 0xbef13ec4, 0xbf223f0e
.long 0x3f7bbf80, 0x3f55bf6d, 0x3f0ebf35, 0x3e48bec4
.long 0x3e950000, 0x3f46bf0e, 0x3f7fbf6d, 0x3f62bf7b
.long 0xbf6d3f80, 0xbec43f35, 0x3ec40000, 0x3f6dbf35
.long 0xbef10000, 0xbf7f3f55, 0xbf223f6d, 0x3e953e48
.long 0x3f55bf80, 0xbe48bec4, 0xbf7b3f35, 0xbf0e3f6d
.long 0x3f220000, 0x3f62bf7b, 0xbe95bec4, 0xbf7f3f55
.long 0xbf353f80, 0x3f350000, 0x3f35bf80, 0xbf350000
.long 0xbf460000, 0xbef13f7b, 0x3f75bec4, 0x3dc9bf55
.long 0x3f0ebf80, 0xbf7b3ec4, 0x3e483f35, 0x3f55bf6d
.long 0x3f620000, 0xbdc9bf55, 0xbf463f6d, 0x3f75be48
.long 0xbec43f80, 0x3f6dbf35, 0xbf6d0000, 0x3ec43f35
.long 0xbf750000, 0x3f223f0e, 0xbdc9bf6d, 0xbef13f7b
.long 0x3e48bf80, 0xbf0e3f6d, 0x3f55bf35, 0xbf7b3ec4
.long 0x3f7f0000, 0xbf75be48, 0x3f623ec4, 0xbf46bf0e
.long 0xbf803f80, 0xbf803f80, 0xbf803f80, 0xbf803f80
.long 0xbf463f35, 0xbf623f55, 0xbf753f6d, 0xbf7f3f7b
.long 0xbe480000, 0xbf0e3ec4, 0xbf553f35, 0xbf7b3f6d
.long 0x3ef1bf35, 0xbdc9be48, 0xbf223ec4, 0xbf753f55
.long 0x3f6dbf80, 0x3ec4bf35, 0xbec40000, 0xbf6d3f35
.long 0x3f75bf35, 0x3f46bf7b, 0xbdc9bec4, 0xbf623f0e
.long 0x3f0e0000, 0x3f7bbf6d, 0x3e48bf35, 0xbf553ec4
.long 0xbdc93f35, 0x3f75bf0e, 0x3ef1bf6d, 0xbf463e48
.long 0xbf353f80, 0x3f350000, 0x3f35bf80, 0xbf350000
.long 0xbf7f3f35, 0x3e953f0e, 0x3f62bf6d, 0xbf22be48
.long 0xbf550000, 0xbe483f6d, 0x3f7bbf35, 0xbf0ebec4
.long 0xbe95bf35, 0xbf223f7b, 0x3f7fbec4, 0xbef1bf0e
.long 0x3ec4bf80, 0xbf6d3f35, 0x3f6d0000, 0xbec4bf35
.long 0x3f62bf35, 0xbf7f3e48, 0x3f463ec4, 0xbe95bf55
.long 0x3f7b0000, 0xbf55bec4, 0x3f0e3f35, 0xbe48bf6d
.long 0x3f223f35, 0xbef1bf55, 0x3e953f6d, 0xbdc9bf7b
.long 0x0, 0x0, 0x0, 0x0
.long 0xbdc90000, 0xbe953e48, 0xbef13ec4, 0xbf223f0e
.long 0xbe480000, 0xbf0e3ec4, 0xbf553f35, 0xbf7b3f6d
.long 0xbe950000, 0xbf463f0e, 0xbf7f3f6d, 0xbf623f7b
.long 0xbec40000, 0xbf6d3f35, 0xbf6d3f80, 0xbec43f35
.long 0xbef10000, 0xbf7f3f55, 0xbf223f6d, 0x3e953e48
.long 0xbf0e0000, 0xbf7b3f6d, 0xbe483f35, 0x3f55bec4
.long 0xbf220000, 0xbf623f7b, 0x3e953ec4, 0x3f7fbf55
.long 0xbf350000, 0xbf353f80, 0x3f350000, 0x3f35bf80
.long 0xbf460000, 0xbef13f7b, 0x3f75bec4, 0x3dc9bf55
.long 0xbf550000, 0xbe483f6d, 0x3f7bbf35, 0xbf0ebec4
.long 0xbf620000, 0x3dc93f55, 0x3f46bf6d, 0xbf753e48
.long 0xbf6d0000, 0x3ec43f35, 0x3ec4bf80, 0xbf6d3f35
.long 0xbf750000, 0x3f223f0e, 0xbdc9bf6d, 0xbef13f7b
.long 0xbf7b0000, 0x3f553ec4, 0xbf0ebf35, 0x3e483f6d
.long 0xbf7f0000, 0x3f753e48, 0xbf62bec4, 0x3f463f0e
.long 0x0, 0x0, 0x0, 0x0
.long 0xbf463f35, 0xbf623f55, 0xbf753f6d, 0xbf7f3f7b
.long 0xbf7b3f80, 0xbf553f6d, 0xbf0e3f35, 0xbe483ec4
.long 0xbef13f35, 0x3dc93e48, 0x3f22bec4, 0x3f75bf55
.long 0x3ec40000, 0x3f6dbf35, 0x3f6dbf80, 0x3ec4bf35
.long 0x3f75bf35, 0x3f46bf7b, 0xbdc9bec4, 0xbf623f0e
.long 0x3f55bf80, 0xbe48bec4, 0xbf7b3f35, 0xbf0e3f6d
.long 0x3dc9bf35, 0xbf753f0e, 0xbef13f6d, 0x3f46be48
.long 0xbf350000, 0xbf353f80, 0x3f350000, 0x3f35bf80
.long 0xbf7f3f35, 0x3e953f0e, 0x3f62bf6d, 0xbf22be48
.long 0xbf0e3f80, 0x3f7bbec4, 0xbe48bf35, 0xbf553f6d
.long 0x3e953f35, 0x3f22bf7b, 0xbf7f3ec4, 0x3ef13f0e
.long 0x3f6d0000, 0xbec4bf35, 0xbec43f80, 0x3f6dbf35
.long 0x3f62bf35, 0xbf7f3e48, 0x3f463ec4, 0xbe95bf55
.long 0x3e48bf80, 0xbf0e3f6d, 0x3f55bf35, 0xbf7b3ec4
.long 0xbf22bf35, 0x3ef13f55, 0xbe95bf6d, 0x3dc93f7b
.long 0x0, 0x0, 0x0, 0x0
.long 0xbf7f3f80, 0xbf753f7b, 0xbf623f6d, 0xbf463f55
.long 0x3e480000, 0x3f0ebec4, 0x3f55bf35, 0x3f7bbf6d
.long 0x3f75bf80, 0x3f22bf55, 0x3dc9bec4, 0xbef13e48
.long 0xbec40000, 0xbf6d3f35, 0xbf6d3f80, 0xbec43f35
.long 0xbf623f80, 0xbdc93f0e, 0x3f46bec4, 0x3f75bf7b
.long 0x3f0e0000, 0x3f7bbf6d, 0x3e48bf35, 0xbf553ec4
.long 0x3f46bf80, 0xbef1be48, 0xbf753f6d, 0x3dc93f0e
.long 0xbf350000, 0xbf353f80, 0x3f350000, 0x3f35bf80
.long 0xbf223f80, 0x3f62be48, 0x3e95bf6d, 0xbf7f3f0e
.long 0x3f550000, 0x3e48bf6d, 0xbf7b3f35, 0x3f0e3ec4
.long 0x3ef1bf80, 0xbf7f3f0e, 0x3f223ec4, 0x3e95bf7b
.long 0xbf6d0000, 0x3ec43f35, 0x3ec4bf80, 0xbf6d3f35
.long 0xbe953f80, 0x3f46bf55, 0xbf7f3ec4, 0x3f623e48
.long 0x3f7b0000, 0xbf55bec4, 0x3f0e3f35, 0xbe48bf6d
.long 0x3dc9bf80, 0xbe953f7b, 0x3ef1bf6d, 0xbf223f55
.long 0x0, 0x0, 0x0, 0x0
.long 0xbf223f35, 0xbef13f0e, 0xbe953ec4, 0xbdc93e48
.long 0x3f7bbf80, 0x3f55bf6d, 0x3f0ebf35, 0x3e48bec4
.long 0xbf623f35, 0xbf7f3f7b, 0xbf463f6d, 0xbe953f0e
.long 0x3ec40000, 0x3f6dbf35, 0x3f6dbf80, 0x3ec4bf35
.long 0x3e95bf35, 0xbf223e48, 0xbf7f3f6d, 0xbef13f55
.long 0xbf553f80, 0x3e483ec4, 0x3f7bbf35, 0x3f0ebf6d
.long 0x3f7fbf35, 0x3e95bf55, 0xbf623ec4, 0xbf223f7b
.long 0xbf350000, 0xbf353f80, 0x3f350000, 0x3f35bf80
.long 0x3dc93f35, 0x3f75bf55, 0xbef1bec4, 0xbf463f7b
.long 0x3f0ebf80, 0xbf7b3ec4, 0x3e483f35, 0x3f55bf6d
.long 0xbf753f35, 0x3f463e48, 0x3dc9bf6d, 0xbf623f55
.long 0x3f6d0000, 0xbec4bf35, 0xbec43f80, 0x3f6dbf35
.long 0xbef1bf35, 0xbdc93f7b, 0x3f22bf6d, 0xbf753f0e
.long 0xbe483f80, 0x3f0ebf6d, 0xbf553f35, 0x3f7bbec4
.long 0x3f46bf35, 0xbf623f0e, 0x3f75bec4, 0xbf7f3e48
.long 0x0, 0x0, 0x0, 0x0
.long 0x3dc90000, 0x3e95be48, 0x3ef1bec4, 0x3f22bf0e
.long 0xbe480000, 0xbf0e3ec4, 0xbf553f35, 0xbf7b3f6d
.long 0x3e950000, 0x3f46bf0e, 0x3f7fbf6d, 0x3f62bf7b
.long 0xbec40000, 0xbf6d3f35, 0xbf6d3f80, 0xbec43f35
.long 0x3ef10000, 0x3f7fbf55, 0x3f22bf6d, 0xbe95be48
.long 0xbf0e0000, 0xbf7b3f6d, 0xbe483f35, 0x3f55bec4
.long 0x3f220000, 0x3f62bf7b, 0xbe95bec4, 0xbf7f3f55
.long 0xbf350000, 0xbf353f80, 0x3f350000, 0x3f35bf80
.long 0x3f460000, 0x3ef1bf7b, 0xbf753ec4, 0xbdc93f55
.long 0xbf550000, 0xbe483f6d, 0x3f7bbf35, 0xbf0ebec4
.long 0x3f620000, 0xbdc9bf55, 0xbf463f6d, 0x3f75be48
.long 0xbf6d0000, 0x3ec43f35, 0x3ec4bf80, 0xbf6d3f35
.long 0x3f750000, 0xbf22bf0e, 0x3dc93f6d, 0x3ef1bf7b
.long 0xbf7b0000, 0x3f553ec4, 0xbf0ebf35, 0x3e483f6d
.long 0x3f7f0000, 0xbf75be48, 0x3f623ec4, 0xbf46bf0e
.long 0x0, 0x0, 0x0, 0x0
.long 0x3f46bf35, 0x3f62bf55, 0x3f75bf6d, 0x3f7fbf7b
.long 0xbf7b3f80, 0xbf553f6d, 0xbf0e3f35, 0xbe483ec4
.long 0x3ef1bf35, 0xbdc9be48, 0xbf223ec4, 0xbf753f55
.long 0x3ec40000, 0x3f6dbf35, 0x3f6dbf80, 0x3ec4bf35
.long 0xbf753f35, 0xbf463f7b, 0x3dc93ec4, 0x3f62bf0e
.long 0x3f55bf80, 0xbe48bec4, 0xbf7b3f35, 0xbf0e3f6d
.long 0xbdc93f35, 0x3f75bf0e, 0x3ef1bf6d, 0xbf463e48
.long 0xbf350000, 0xbf353f80, 0x3f350000, 0x3f35bf80
.long 0x3f7fbf35, 0xbe95bf0e, 0xbf623f6d, 0x3f223e48
.long 0xbf0e3f80, 0x3f7bbec4, 0xbe48bf35, 0xbf553f6d
.long 0xbe95bf35, 0xbf223f7b, 0x3f7fbec4, 0xbef1bf0e
.long 0x3f6d0000, 0xbec4bf35, 0xbec43f80, 0x3f6dbf35
.long 0xbf623f35, 0x3f7fbe48, 0xbf46bec4, 0x3e953f55
.long 0x3e48bf80, 0xbf0e3f6d, 0x3f55bf35, 0xbf7b3ec4
.long 0x3f223f35, 0xbef1bf55, 0x3e953f6d, 0xbdc9bf7b
.long 0x0, 0x0, 0x0, 0x0
.long 0x3f7fbf80, 0x3f75bf7b, 0x3f62bf6d, 0x3f46bf55
.long 0x3e480000, 0x3f0ebec4, 0x3f55bf35, 0x3f7bbf6d
.long 0xbf753f80, 0xbf223f55, 0xbdc93ec4, 0x3ef1be48
.long 0xbec40000, 0xbf6d3f35, 0xbf6d3f80, 0xbec43f35
.long 0x3f62bf80, 0x3dc9bf0e, 0xbf463ec4, 0xbf753f7b
.long 0x3f0e0000, 0x3f7bbf6d, 0x3e48bf35, 0xbf553ec4
.long 0xbf463f80, 0x3ef13e48, 0x3f75bf6d, 0xbdc9bf0e
.long 0xbf350000, 0xbf353f80, 0x3f350000, 0x3f35bf80
.long 0x3f22bf80, 0xbf623e48, 0xbe953f6d, 0x3f7fbf0e
.long 0x3f550000, 0x3e48bf6d, 0xbf7b3f35, 0x3f0e3ec4
.long 0xbef13f80, 0x3f7fbf0e, 0xbf22bec4, 0xbe953f7b
.long 0xbf6d0000, 0x3ec43f35, 0x3ec4bf80, 0xbf6d3f35
.long 0x3e95bf80, 0xbf463f55, 0x3f7fbec4, 0xbf62be48
.long 0x3f7b0000, 0xbf55bec4, 0x3f0e3f35, 0xbe48bf6d
.long 0xbdc93f80, 0x3e95bf7b, 0xbef13f6d, 0x3f22bf55
.long 0x0, 0x0, 0x0, 0x0
.long 0x3f22bf35, 0x3ef1bf0e, 0x3e95bec4, 0x3dc9be48
.long 0x3f7bbf80, 0x3f55bf6d, 0x3f0ebf35, 0x3e48bec4
.long 0x3f62bf35, 0x3f7fbf7b, 0x3f46bf6d, 0x3e95bf0e
.long 0x3ec40000, 0x3f6dbf35, 0x3f6dbf80, 0x3ec4bf35
.long 0xbe953f35, 0x3f22be48, 0x3f7fbf6d, 0x3ef1bf55
.long 0xbf553f80, 0x3e483ec4, 0x3f7bbf35, 0x3f0ebf6d
.long 0xbf7f3f35, 0xbe953f55, 0x3f62bec4, 0x3f22bf7b
.long 0xbf350000, 0xbf353f80, 0x3f350000, 0x3f35bf80
.long 0xbdc9bf35, 0xbf753f55, 0x3ef13ec4, 0x3f46bf7b
.long 0x3f0ebf80, 0xbf7b3ec4, 0x3e483f35, 0x3f55bf6d
.long 0x3f75bf35, 0xbf46be48, 0xbdc93f6d, 0x3f62bf55
.long 0x3f6d0000, 0xbec4bf35, 0xbec43f80, 0x3f6dbf35
.long 0x3ef13f35, 0x3dc9bf7b, 0xbf223f6d, 0x3f75bf0e
.long 0xbe483f80, 0x3f0ebf6d, 0xbf553f35, 0x3f7bbec4
.long 0xbf463f35, 0x3f62bf0e, 0xbf753ec4, 0x3f7fbe48
.long 0x3f80, 0xbf80, 0x3f80, 0xbf80
.long 0x3dc93f80, 0xbe95bf7b, 0x3ef13f6d, 0xbf22bf55
.long 0x3e483f80, 0xbf0ebf6d, 0x3f553f35, 0xbf7bbec4
.long 0x3e953f80, 0xbf46bf55, 0x3f7f3ec4, 0xbf623e48
.long 0x3ec43f80, 0xbf6dbf35, 0x3f6d0000, 0xbec43f35
.long 0x3ef13f80, 0xbf7fbf0e, 0x3f22bec4, 0x3e953f7b
.long 0x3f0e3f80, 0xbf7bbec4, 0x3e48bf35, 0x3f553f6d
.long 0x3f223f80, 0xbf62be48, 0xbe95bf6d, 0x3f7f3f0e
.long 0x3f353f80, 0xbf350000, 0xbf35bf80, 0x3f350000
.long 0x3f463f80, 0xbef13e48, 0xbf75bf6d, 0x3dc9bf0e
.long 0x3f553f80, 0xbe483ec4, 0xbf7bbf35, 0xbf0ebf6d
.long 0x3f623f80, 0x3dc93f0e, 0xbf46bec4, 0xbf75bf7b
.long 0x3f6d3f80, 0x3ec43f35, 0xbec40000, 0xbf6dbf35
.long 0x3f753f80, 0x3f223f55, 0x3dc93ec4, 0xbef1be48
.long 0x3f7b3f80, 0x3f553f6d, 0x3f0e3f35, 0x3e483ec4
.long 0x3f7f3f80, 0x3f753f7b, 0x3f623f6d, 0x3f463f55
.long 0x3f80, 0xbf80, 0x3f80, 0xbf80
.long 0x3f463f35, 0xbf62bf0e, 0x3f753ec4, 0xbf7fbe48
.long 0x3f7b0000, 0xbf553ec4, 0x3f0ebf35, 0xbe483f6d
.long 0x3ef1bf35, 0x3dc93f7b, 0xbf22bf6d, 0x3f753f0e
.long 0xbec4bf80, 0x3f6d3f35, 0xbf6d0000, 0x3ec4bf35
.long 0xbf75bf35, 0x3f46be48, 0x3dc93f6d, 0xbf62bf55
.long 0xbf550000, 0xbe48bf6d, 0x3f7b3f35, 0xbf0e3ec4
.long 0xbdc93f35, 0xbf75bf55, 0x3ef1bec4, 0x3f463f7b
.long 0x3f353f80, 0xbf350000, 0xbf35bf80, 0x3f350000
.long 0x3f7f3f35, 0x3e953f55, 0xbf62bec4, 0xbf22bf7b
.long 0x3f0e0000, 0x3f7b3f6d, 0x3e483f35, 0xbf55bec4
.long 0xbe95bf35, 0x3f223e48, 0x3f7f3f6d, 0x3ef13f55
.long 0xbf6dbf80, 0xbec4bf35, 0x3ec40000, 0x3f6d3f35
.long 0xbf62bf35, 0xbf7fbf7b, 0xbf46bf6d, 0xbe95bf0e
.long 0xbe480000, 0xbf0ebec4, 0xbf55bf35, 0xbf7bbf6d
.long 0x3f223f35, 0x3ef13f0e, 0x3e953ec4, 0x3dc93e48
.long 0x3f80, 0xbf80, 0x3f80, 0xbf80
.long 0x3f7f0000, 0xbf753e48, 0x3f62bec4, 0xbf463f0e
.long 0xbe48bf80, 0x3f0e3f6d, 0xbf55bf35, 0x3f7b3ec4
.long 0xbf750000, 0x3f22bf0e, 0xbdc93f6d, 0xbef1bf7b
.long 0x3ec43f80, 0xbf6dbf35, 0x3f6d0000, 0xbec43f35
.long 0x3f620000, 0xbdc93f55, 0xbf46bf6d, 0x3f753e48
.long 0xbf0ebf80, 0x3f7b3ec4, 0xbe483f35, 0xbf55bf6d
.long 0xbf460000, 0xbef1bf7b, 0x3f753ec4, 0x3dc93f55
.long 0x3f353f80, 0xbf350000, 0xbf35bf80, 0x3f350000
.long 0x3f220000, 0x3f623f7b, 0xbe953ec4, 0xbf7fbf55
.long 0xbf55bf80, 0x3e48bec4, 0x3f7b3f35, 0x3f0e3f6d
.long 0xbef10000, 0xbf7fbf55, 0xbf22bf6d, 0x3e95be48
.long 0x3f6d3f80, 0x3ec43f35, 0xbec40000, 0xbf6dbf35
.long 0x3e950000, 0x3f463f0e, 0x3f7f3f6d, 0x3f623f7b
.long 0xbf7bbf80, 0xbf55bf6d, 0xbf0ebf35, 0xbe48bec4
.long 0xbdc90000, 0xbe95be48, 0xbef1bec4, 0xbf22bf0e
.long 0x3f80, 0xbf80, 0x3f80, 0xbf80
.long 0x3f22bf35, 0xbef13f55, 0x3e95bf6d, 0xbdc93f7b
.long 0xbf7b0000, 0x3f55bec4, 0xbf0e3f35, 0x3e48bf6d
.long 0x3f623f35, 0xbf7fbe48, 0x3f46bec4, 0xbe953f55
.long 0xbec4bf80, 0x3f6d3f35, 0xbf6d0000, 0x3ec4bf35
.long 0xbe953f35, 0xbf22bf7b, 0x3f7f3ec4, 0xbef13f0e
.long 0x3f550000, 0x3e483f6d, 0xbf7bbf35, 0x3f0ebec4
.long 0xbf7fbf35, 0x3e95bf0e, 0x3f623f6d, 0xbf223e48
.long 0x3f353f80, 0xbf350000, 0xbf35bf80, 0x3f350000
.long 0xbdc9bf35, 0x3f753f0e, 0x3ef13f6d, 0xbf46be48
.long 0xbf0e0000, 0xbf7bbf6d, 0xbe48bf35, 0x3f553ec4
.long 0x3f753f35, 0x3f463f7b, 0xbdc93ec4, 0xbf62bf0e
.long 0xbf6dbf80, 0xbec4bf35, 0x3ec40000, 0x3f6d3f35
.long 0x3ef13f35, 0xbdc93e48, 0xbf22bec4, 0xbf75bf55
.long 0x3e480000, 0x3f0e3ec4, 0x3f553f35, 0x3f7b3f6d
.long 0xbf46bf35, 0xbf62bf55, 0xbf75bf6d, 0xbf7fbf7b
.long 0x3f80, 0xbf80, 0x3f80, 0xbf80
.long 0xbdc9bf80, 0x3e953f7b, 0xbef1bf6d, 0x3f223f55
.long 0x3e483f80, 0xbf0ebf6d, 0x3f553f35, 0xbf7bbec4
.long 0xbe95bf80, 0x3f463f55, 0xbf7fbec4, 0x3f62be48
.long 0x3ec43f80, 0xbf6dbf35, 0x3f6d0000, 0xbec43f35
.long 0xbef1bf80, 0x3f7f3f0e, 0xbf223ec4, 0xbe95bf7b
.long 0x3f0e3f80, 0xbf7bbec4, 0x3e48bf35, 0x3f553f6d
.long 0xbf22bf80, 0x3f623e48, 0x3e953f6d, 0xbf7fbf0e
.long 0x3f353f80, 0xbf350000, 0xbf35bf80, 0x3f350000
.long 0xbf46bf80, 0x3ef1be48, 0x3f753f6d, 0xbdc93f0e
.long 0x3f553f80, 0xbe483ec4, 0xbf7bbf35, 0xbf0ebf6d
.long 0xbf62bf80, 0xbdc9bf0e, 0x3f463ec4, 0x3f753f7b
.long 0x3f6d3f80, 0x3ec43f35, 0xbec40000, 0xbf6dbf35
.long 0xbf75bf80, 0xbf22bf55, 0xbdc9bec4, 0x3ef13e48
.long 0x3f7b3f80, 0x3f553f6d, 0x3f0e3f35, 0x3e483ec4
.long 0xbf7fbf80, 0xbf75bf7b, 0xbf62bf6d, 0xbf46bf55
.long 0x3f80, 0xbf80, 0x3f80, 0xbf80
.long 0xbf46bf35, 0x3f623f0e, 0xbf75bec4, 0x3f7f3e48
.long 0x3f7b0000, 0xbf553ec4, 0x3f0ebf35, 0xbe483f6d
.long 0xbef13f35, 0xbdc9bf7b, 0x3f223f6d, 0xbf75bf0e
.long 0xbec4bf80, 0x3f6d3f35, 0xbf6d0000, 0x3ec4bf35
.long 0x3f753f35, 0xbf463e48, 0xbdc9bf6d, 0x3f623f55
.long 0xbf550000, 0xbe48bf6d, 0x3f7b3f35, 0xbf0e3ec4
.long 0x3dc9bf35, 0x3f753f55, 0xbef13ec4, 0xbf46bf7b
.long 0x3f353f80, 0xbf350000, 0xbf35bf80, 0x3f350000
.long 0xbf7fbf35, 0xbe95bf55, 0x3f623ec4, 0x3f223f7b
.long 0x3f0e0000, 0x3f7b3f6d, 0x3e483f35, 0xbf55bec4
.long 0x3e953f35, 0xbf22be48, 0xbf7fbf6d, 0xbef1bf55
.long 0xbf6dbf80, 0xbec4bf35, 0x3ec40000, 0x3f6d3f35
.long 0x3f623f35, 0x3f7f3f7b, 0x3f463f6d, 0x3e953f0e
.long 0xbe480000, 0xbf0ebec4, 0xbf55bf35, 0xbf7bbf6d
.long 0xbf22bf35, 0xbef1bf0e, 0xbe95bec4, 0xbdc9be48
.long 0x3f80, 0xbf80, 0x3f80, 0xbf80
.long 0xbf7f0000, 0x3f75be48, 0xbf623ec4, 0x3f46bf0e
.long 0xbe48bf80, 0x3f0e3f6d, 0xbf55bf35, 0x3f7b3ec4
.long 0x3f750000, 0xbf223f0e, 0x3dc9bf6d, 0x3ef13f7b
.long 0x3ec43f80, 0xbf6dbf35, 0x3f6d0000, 0xbec43f35
.long 0xbf620000, 0x3dc9bf55, 0x3f463f6d, 0xbf75be48
.long 0xbf0ebf80, 0x3f7b3ec4, 0xbe483f35, 0xbf55bf6d
.long 0x3f460000, 0x3ef13f7b, 0xbf75bec4, 0xbdc9bf55
.long 0x3f353f80, 0xbf350000, 0xbf35bf80, 0x3f350000
.long 0xbf220000, 0xbf62bf7b, 0x3e95bec4, 0x3f7f3f55
.long 0xbf55bf80, 0x3e48bec4, 0x3f7b3f35, 0x3f0e3f6d
.long 0x3ef10000, 0x3f7f3f55, 0x3f223f6d, 0xbe953e48
.long 0x3f6d3f80, 0x3ec43f35, 0xbec40000, 0xbf6dbf35
.long 0xbe950000, 0xbf46bf0e, 0xbf7fbf6d, 0xbf62bf7b
.long 0xbf7bbf80, 0xbf55bf6d, 0xbf0ebf35, 0xbe48bec4
.long 0x3dc90000, 0x3e953e48, 0x3ef13ec4, 0x3f223f0e
.long 0x3f80, 0xbf80, 0x3f80, 0xbf80
.long 0xbf223f35, 0x3ef1bf55, 0xbe953f6d, 0x3dc9bf7b
.long 0xbf7b0000, 0x3f55bec4, 0xbf0e3f35, 0x3e48bf6d
.long 0xbf62bf35, 0x3f7f3e48, 0xbf463ec4, 0x3e95bf55
.long 0xbec4bf80, 0x3f6d3f35, 0xbf6d0000, 0x3ec4bf35
.long 0x3e95bf35, 0x3f223f7b, 0xbf7fbec4, 0x3ef1bf0e
.long 0x3f550000, 0x3e483f6d, 0xbf7bbf35, 0x3f0ebec4
.long 0x3f7f3f35, 0xbe953f0e, 0xbf62bf6d, 0x3f22be48
.long 0x3f353f80, 0xbf350000, 0xbf35bf80, 0x3f350000
.long 0x3dc93f35, 0xbf75bf0e, 0xbef1bf6d, 0x3f463e48
.long 0xbf0e0000, 0xbf7bbf6d, 0xbe48bf35, 0x3f553ec4
.long 0xbf75bf35, 0xbf46bf7b, 0x3dc9bec4, 0x3f623f0e
.long 0xbf6dbf80, 0xbec4bf35, 0x3ec40000, 0x3f6d3f35
.long 0xbef1bf35, 0x3dc9be48, 0x3f223ec4, 0x3f753f55
.long 0x3e480000, 0x3f0e3ec4, 0x3f553f35, 0x3f7b3f6d
.long 0x3f463f35, 0x3f623f55, 0x3f753f6d, 0x3f7f3f7b
.long 0xbf800000, 0x3f800000, 0xbf800000, 0x3f800000
.long 0xbf7f0000, 0x3f75be48, 0xbf623ec4, 0x3f46bf0e
.long 0xbf7b0000, 0x3f55bec4, 0xbf0e3f35, 0x3e48bf6d
.long 0xbf750000, 0x3f22bf0e, 0xbdc93f6d, 0xbef1bf7b
.long 0xbf6d0000, 0x3ec4bf35, 0x3ec43f80, 0xbf6dbf35
.long 0xbf620000, 0x3dc9bf55, 0x3f463f6d, 0xbf75be48
.long 0xbf550000, 0xbe48bf6d, 0x3f7b3f35, 0xbf0e3ec4
.long 0xbf460000, 0xbef1bf7b, 0x3f753ec4, 0x3dc93f55
.long 0xbf350000, 0xbf35bf80, 0x3f350000, 0x3f353f80
.long 0xbf220000, 0xbf62bf7b, 0x3e95bec4, 0x3f7f3f55
.long 0xbf0e0000, 0xbf7bbf6d, 0xbe48bf35, 0x3f553ec4
.long 0xbef10000, 0xbf7fbf55, 0xbf22bf6d, 0x3e95be48
.long 0xbec40000, 0xbf6dbf35, 0xbf6dbf80, 0xbec4bf35
.long 0xbe950000, 0xbf46bf0e, 0xbf7fbf6d, 0xbf62bf7b
.long 0xbe480000, 0xbf0ebec4, 0xbf55bf35, 0xbf7bbf6d
.long 0xbdc90000, 0xbe95be48, 0xbef1bec4, 0xbf22bf0e
.long 0xbf800000, 0x3f800000, 0xbf800000, 0x3f800000
.long 0xbf223f35, 0x3ef1bf55, 0xbe953f6d, 0x3dc9bf7b
.long 0x3e483f80, 0xbf0ebf6d, 0x3f553f35, 0xbf7bbec4
.long 0x3f623f35, 0xbf7fbe48, 0x3f46bec4, 0xbe953f55
.long 0x3f6d0000, 0xbec43f35, 0xbec4bf80, 0x3f6d3f35
.long 0x3e95bf35, 0x3f223f7b, 0xbf7fbec4, 0x3ef1bf0e
.long 0xbf0ebf80, 0x3f7b3ec4, 0xbe483f35, 0xbf55bf6d
.long 0xbf7fbf35, 0x3e95bf0e, 0x3f623f6d, 0xbf223e48
.long 0xbf350000, 0xbf35bf80, 0x3f350000, 0x3f353f80
.long 0x3dc93f35, 0xbf75bf0e, 0xbef1bf6d, 0x3f463e48
.long 0x3f553f80, 0xbe483ec4, 0xbf7bbf35, 0xbf0ebf6d
.long 0x3f753f35, 0x3f463f7b, 0xbdc93ec4, 0xbf62bf0e
.long 0x3ec40000, 0x3f6d3f35, 0x3f6d3f80, 0x3ec43f35
.long 0xbef1bf35, 0x3dc9be48, 0x3f223ec4, 0x3f753f55
.long 0xbf7bbf80, 0xbf55bf6d, 0xbf0ebf35, 0xbe48bec4
.long 0xbf46bf35, 0xbf62bf55, 0xbf75bf6d, 0xbf7fbf7b
.long 0xbf800000, 0x3f800000, 0xbf800000, 0x3f800000
.long 0x3dc93f80, 0xbe95bf7b, 0x3ef13f6d, 0xbf22bf55
.long 0x3f7b0000, 0xbf553ec4, 0x3f0ebf35, 0xbe483f6d
.long 0xbe95bf80, 0x3f463f55, 0xbf7fbec4, 0x3f62be48
.long 0xbf6d0000, 0x3ec4bf35, 0x3ec43f80, 0xbf6dbf35
.long 0x3ef13f80, 0xbf7fbf0e, 0x3f22bec4, 0x3e953f7b
.long 0x3f550000, 0x3e483f6d, 0xbf7bbf35, 0x3f0ebec4
.long 0xbf22bf80, 0x3f623e48, 0x3e953f6d, 0xbf7fbf0e
.long 0xbf350000, 0xbf35bf80, 0x3f350000, 0x3f353f80
.long 0x3f463f80, 0xbef13e48, 0xbf75bf6d, 0x3dc9bf0e
.long 0x3f0e0000, 0x3f7b3f6d, 0x3e483f35, 0xbf55bec4
.long 0xbf62bf80, 0xbdc9bf0e, 0x3f463ec4, 0x3f753f7b
.long 0xbec40000, 0xbf6dbf35, 0xbf6dbf80, 0xbec4bf35
.long 0x3f753f80, 0x3f223f55, 0x3dc93ec4, 0xbef1be48
.long 0x3e480000, 0x3f0e3ec4, 0x3f553f35, 0x3f7b3f6d
.long 0xbf7fbf80, 0xbf75bf7b, 0xbf62bf6d, 0xbf46bf55
.long 0xbf800000, 0x3f800000, 0xbf800000, 0x3f800000
.long 0x3f463f35, 0xbf62bf0e, 0x3f753ec4, 0xbf7fbe48
.long 0xbe48bf80, 0x3f0e3f6d, 0xbf55bf35, 0x3f7b3ec4
.long 0xbef13f35, 0xbdc9bf7b, 0x3f223f6d, 0xbf75bf0e
.long 0x3f6d0000, 0xbec43f35, 0xbec4bf80, 0x3f6d3f35
.long 0xbf75bf35, 0x3f46be48, 0x3dc93f6d, 0xbf62bf55
.long 0x3f0e3f80, 0xbf7bbec4, 0x3e48bf35, 0x3f553f6d
.long 0x3dc9bf35, 0x3f753f55, 0xbef13ec4, 0xbf46bf7b
.long 0xbf350000, 0xbf35bf80, 0x3f350000, 0x3f353f80
.long 0x3f7f3f35, 0x3e953f55, 0xbf62bec4, 0xbf22bf7b
.long 0xbf55bf80, 0x3e48bec4, 0x3f7b3f35, 0x3f0e3f6d
.long 0x3e953f35, 0xbf22be48, 0xbf7fbf6d, 0xbef1bf55
.long 0x3ec40000, 0x3f6d3f35, 0x3f6d3f80, 0x3ec43f35
.long 0xbf62bf35, 0xbf7fbf7b, 0xbf46bf6d, 0xbe95bf0e
.long 0x3f7b3f80, 0x3f553f6d, 0x3f0e3f35, 0x3e483ec4
.long 0xbf22bf35, 0xbef1bf0e, 0xbe95bec4, 0xbdc9be48
.long 0xbf800000, 0x3f800000, 0xbf800000, 0x3f800000
.long 0x3f7f0000, 0xbf753e48, 0x3f62bec4, 0xbf463f0e
.long 0xbf7b0000, 0x3f55bec4, 0xbf0e3f35, 0x3e48bf6d
.long 0x3f750000, 0xbf223f0e, 0x3dc9bf6d, 0x3ef13f7b
.long 0xbf6d0000, 0x3ec4bf35, 0x3ec43f80, 0xbf6dbf35
.long 0x3f620000, 0xbdc93f55, 0xbf46bf6d, 0x3f753e48
.long 0xbf550000, 0xbe48bf6d, 0x3f7b3f35, 0xbf0e3ec4
.long 0x3f460000, 0x3ef13f7b, 0xbf75bec4, 0xbdc9bf55
.long 0xbf350000, 0xbf35bf80, 0x3f350000, 0x3f353f80
.long 0x3f220000, 0x3f623f7b, 0xbe953ec4, 0xbf7fbf55
.long 0xbf0e0000, 0xbf7bbf6d, 0xbe48bf35, 0x3f553ec4
.long 0x3ef10000, 0x3f7f3f55, 0x3f223f6d, 0xbe953e48
.long 0xbec40000, 0xbf6dbf35, 0xbf6dbf80, 0xbec4bf35
.long 0x3e950000, 0x3f463f0e, 0x3f7f3f6d, 0x3f623f7b
.long 0xbe480000, 0xbf0ebec4, 0xbf55bf35, 0xbf7bbf6d
.long 0x3dc90000, 0x3e953e48, 0x3ef13ec4, 0x3f223f0e
.long 0xbf800000, 0x3f800000, 0xbf800000, 0x3f800000
.long 0x3f22bf35, 0xbef13f55, 0x3e95bf6d, 0xbdc93f7b
.long 0x3e483f80, 0xbf0ebf6d, 0x3f553f35, 0xbf7bbec4
.long 0xbf62bf35, 0x3f7f3e48, 0xbf463ec4, 0x3e95bf55
.long 0x3f6d0000, 0xbec43f35, 0xbec4bf80, 0x3f6d3f35
.long 0xbe953f35, 0xbf22bf7b, 0x3f7f3ec4, 0xbef13f0e
.long 0xbf0ebf80, 0x3f7b3ec4, 0xbe483f35, 0xbf55bf6d
.long 0x3f7f3f35, 0xbe953f0e, 0xbf62bf6d, 0x3f22be48
.long 0xbf350000, 0xbf35bf80, 0x3f350000, 0x3f353f80
.long 0xbdc9bf35, 0x3f753f0e, 0x3ef13f6d, 0xbf46be48
.long 0x3f553f80, 0xbe483ec4, 0xbf7bbf35, 0xbf0ebf6d
.long 0xbf75bf35, 0xbf46bf7b, 0x3dc9bec4, 0x3f623f0e
.long 0x3ec40000, 0x3f6d3f35, 0x3f6d3f80, 0x3ec43f35
.long 0x3ef13f35, 0xbdc93e48, 0xbf22bec4, 0xbf75bf55
.long 0xbf7bbf80, 0xbf55bf6d, 0xbf0ebf35, 0xbe48bec4
.long 0x3f463f35, 0x3f623f55, 0x3f753f6d, 0x3f7f3f7b
.long 0xbf800000, 0x3f800000, 0xbf800000, 0x3f800000
.long 0xbdc9bf80, 0x3e953f7b, 0xbef1bf6d, 0x3f223f55
.long 0x3f7b0000, 0xbf553ec4, 0x3f0ebf35, 0xbe483f6d
.long 0x3e953f80, 0xbf46bf55, 0x3f7f3ec4, 0xbf623e48
.long 0xbf6d0000, 0x3ec4bf35, 0x3ec43f80, 0xbf6dbf35
.long 0xbef1bf80, 0x3f7f3f0e, 0xbf223ec4, 0xbe95bf7b
.long 0x3f550000, 0x3e483f6d, 0xbf7bbf35, 0x3f0ebec4
.long 0x3f223f80, 0xbf62be48, 0xbe95bf6d, 0x3f7f3f0e
.long 0xbf350000, 0xbf35bf80, 0x3f350000, 0x3f353f80
.long 0xbf46bf80, 0x3ef1be48, 0x3f753f6d, 0xbdc93f0e
.long 0x3f0e0000, 0x3f7b3f6d, 0x3e483f35, 0xbf55bec4
.long 0x3f623f80, 0x3dc93f0e, 0xbf46bec4, 0xbf75bf7b
.long 0xbec40000, 0xbf6dbf35, 0xbf6dbf80, 0xbec4bf35
.long 0xbf75bf80, 0xbf22bf55, 0xbdc9bec4, 0x3ef13e48
.long 0x3e480000, 0x3f0e3ec4, 0x3f553f35, 0x3f7b3f6d
.long 0x3f7f3f80, 0x3f753f7b, 0x3f623f6d, 0x3f463f55
.long 0xbf800000, 0x3f800000, 0xbf800000, 0x3f800000
.long 0xbf46bf35, 0x3f623f0e, 0xbf75bec4, 0x3f7f3e48
.long 0xbe48bf80, 0x3f0e3f6d, 0xbf55bf35, 0x3f7b3ec4
.long 0x3ef1bf35, 0x3dc93f7b, 0xbf22bf6d, 0x3f753f0e
.long 0x3f6d0000, 0xbec43f35, 0xbec4bf80, 0x3f6d3f35
.long 0x3f753f35, 0xbf463e48, 0xbdc9bf6d, 0x3f623f55
.long 0x3f0e3f80, 0xbf7bbec4, 0x3e48bf35, 0x3f553f6d
.long 0xbdc93f35, 0xbf75bf55, 0x3ef1bec4, 0x3f463f7b
.long 0xbf350000, 0xbf35bf80, 0x3f350000, 0x3f353f80
.long 0xbf7fbf35, 0xbe95bf55, 0x3f623ec4, 0x3f223f7b
.long 0xbf55bf80, 0x3e48bec4, 0x3f7b3f35, 0x3f0e3f6d
.long 0xbe95bf35, 0x3f223e48, 0x3f7f3f6d, 0x3ef13f55
.long 0x3ec40000, 0x3f6d3f35, 0x3f6d3f80, 0x3ec43f35
.long 0x3f623f35, 0x3f7f3f7b, 0x3f463f6d, 0x3e953f0e
.long 0x3f7b3f80, 0x3f553f6d, 0x3f0e3f35, 0x3e483ec4
.long 0x3f223f35, 0x3ef13f0e, 0x3e953ec4, 0x3dc93e48
.long 0x3f803f80, 0x3f803f80, 0x3f803f80, 0x3f803f80
.long 0x3f7b3f80, 0x3f553f6d, 0xbf7bbf80, 0xbf55bf6d
.long 0x3f6d3f80, 0x3ec43f35, 0x3f6d3f80, 0x3ec43f35
.long 0x3f553f80, 0xbe483ec4, 0xbf55bf80, 0x3e48bec4
.long 0x3f353f80, 0xbf350000, 0x3f353f80, 0xbf350000
.long 0x3f0e3f80, 0xbf7bbec4, 0xbf0ebf80, 0x3f7b3ec4
.long 0x3ec43f80, 0xbf6dbf35, 0x3ec43f80, 0xbf6dbf35
.long 0x3e483f80, 0xbf0ebf6d, 0xbe48bf80, 0x3f0e3f6d
.long 0x3f80, 0xbf80, 0x3f80, 0xbf80
.long 0xbe483f80, 0x3f0ebf6d, 0x3e48bf80, 0xbf0e3f6d
.long 0xbec43f80, 0x3f6dbf35, 0xbec43f80, 0x3f6dbf35
.long 0xbf0e3f80, 0x3f7bbec4, 0x3f0ebf80, 0xbf7b3ec4
.long 0xbf353f80, 0x3f350000, 0xbf353f80, 0x3f350000
.long 0xbf553f80, 0x3e483ec4, 0x3f55bf80, 0xbe48bec4
.long 0xbf6d3f80, 0xbec43f35, 0xbf6d3f80, 0xbec43f35
.long 0xbf7b3f80, 0xbf553f6d, 0x3f7bbf80, 0x3f55bf6d
.long 0x3f803f80, 0x3f803f80, 0x3f803f80, 0x3f803f80
.long 0x3f0e3f35, 0x3e483ec4, 0xbf0ebf35, 0xbe48bec4
.long 0xbec40000, 0xbf6dbf35, 0xbec40000, 0xbf6dbf35
.long 0xbf7bbf35, 0xbf0ebf6d, 0x3f7b3f35, 0x3f0e3f6d
.long 0xbf35bf80, 0x3f350000, 0xbf35bf80, 0x3f350000
.long 0x3e48bf35, 0x3f553f6d, 0xbe483f35, 0xbf55bf6d
.long 0x3f6d0000, 0xbec43f35, 0x3f6d0000, 0xbec43f35
.long 0x3f553f35, 0xbf7bbec4, 0xbf55bf35, 0x3f7b3ec4
.long 0x3f80, 0xbf80, 0x3f80, 0xbf80
.long 0xbf553f35, 0x3f7bbec4, 0x3f55bf35, 0xbf7b3ec4
.long 0xbf6d0000, 0x3ec43f35, 0xbf6d0000, 0x3ec43f35
.long 0xbe48bf35, 0xbf553f6d, 0x3e483f35, 0x3f55bf6d
.long 0x3f35bf80, 0xbf350000, 0x3f35bf80, 0xbf350000
.long 0x3f7bbf35, 0x3f0ebf6d, 0xbf7b3f35, 0xbf0e3f6d
.long 0x3ec40000, 0x3f6dbf35, 0x3ec40000, 0x3f6dbf35
.long 0xbf0e3f35, 0xbe483ec4, 0x3f0ebf35, 0x3e48bec4
.long 0x3f803f80, 0x3f803f80, 0x3f803f80, 0x3f803f80
.long 0xbe480000, 0xbf0ebec4, 0x3e480000, 0x3f0e3ec4
.long 0xbf6dbf80, 0xbec4bf35, 0xbf6dbf80, 0xbec4bf35
.long 0x3f0e0000, 0x3f7b3f6d, 0xbf0e0000, 0xbf7bbf6d
.long 0x3f353f80, 0xbf350000, 0x3f353f80, 0xbf350000
.long 0xbf550000, 0xbe48bf6d, 0x3f550000, 0x3e483f6d
.long 0xbec4bf80, 0x3f6d3f35, 0xbec4bf80, 0x3f6d3f35
.long 0x3f7b0000, 0xbf553ec4, 0xbf7b0000, 0x3f55bec4
.long 0x3f80, 0xbf80, 0x3f80, 0xbf80
.long 0xbf7b0000, 0x3f553ec4, 0x3f7b0000, 0xbf55bec4
.long 0x3ec4bf80, 0xbf6d3f35, 0x3ec4bf80, 0xbf6d3f35
.long 0x3f550000, 0x3e48bf6d, 0xbf550000, 0xbe483f6d
.long 0xbf353f80, 0x3f350000, 0xbf353f80, 0x3f350000
.long 0xbf0e0000, 0xbf7b3f6d, 0x3f0e0000, 0x3f7bbf6d
.long 0x3f6dbf80, 0x3ec4bf35, 0x3f6dbf80, 0x3ec4bf35
.long 0x3e480000, 0x3f0ebec4, 0xbe480000, 0xbf0e3ec4
.long 0x3f803f80, 0x3f803f80, 0x3f803f80, 0x3f803f80
.long 0xbf55bf35, 0xbf7bbf6d, 0x3f553f35, 0x3f7b3f6d
.long 0x3ec40000, 0x3f6d3f35, 0x3ec40000, 0x3f6d3f35
.long 0x3e483f35, 0xbf55bec4, 0xbe48bf35, 0x3f553ec4
.long 0xbf35bf80, 0x3f350000, 0xbf35bf80, 0x3f350000
.long 0x3f7b3f35, 0xbf0e3ec4, 0xbf7bbf35, 0x3f0ebec4
.long 0xbf6d0000, 0x3ec4bf35, 0xbf6d0000, 0x3ec4bf35
.long 0x3f0ebf35, 0xbe483f6d, 0xbf0e3f35, 0x3e48bf6d
.long 0x3f80, 0xbf80, 0x3f80, 0xbf80
.long 0xbf0ebf35, 0x3e483f6d, 0x3f0e3f35, 0xbe48bf6d
.long 0x3f6d0000, 0xbec4bf35, 0x3f6d0000, 0xbec4bf35
.long 0xbf7b3f35, 0x3f0e3ec4, 0x3f7bbf35, 0xbf0ebec4
.long 0x3f35bf80, 0xbf350000, 0x3f35bf80, 0xbf350000
.long 0xbe483f35, 0x3f55bec4, 0x3e48bf35, 0xbf553ec4
.long 0xbec40000, 0xbf6d3f35, 0xbec40000, 0xbf6d3f35
.long 0x3f55bf35, 0x3f7bbf6d, 0xbf553f35, 0xbf7b3f6d
.long 0xbf803f80, 0xbf803f80, 0xbf803f80, 0xbf803f80
.long 0xbf7b3f80, 0xbf553f6d, 0x3f7bbf80, 0x3f55bf6d
.long 0xbf6d3f80, 0xbec43f35, 0xbf6d3f80, 0xbec43f35
.long 0xbf553f80, 0x3e483ec4, 0x3f55bf80, 0xbe48bec4
.long 0xbf353f80, 0x3f350000, 0xbf353f80, 0x3f350000
.long 0xbf0e3f80, 0x3f7bbec4, 0x3f0ebf80, 0xbf7b3ec4
.long 0xbec43f80, 0x3f6dbf35, 0xbec43f80, 0x3f6dbf35
.long 0xbe483f80, 0x3f0ebf6d, 0x3e48bf80, 0xbf0e3f6d
.long 0x3f80, 0xbf80, 0x3f80, 0xbf80
.long 0x3e483f80, 0xbf0ebf6d, 0xbe48bf80, 0x3f0e3f6d
.long 0x3ec43f80, 0xbf6dbf35, 0x3ec43f80, 0xbf6dbf35
.long 0x3f0e3f80, 0xbf7bbec4, 0xbf0ebf80, 0x3f7b3ec4
.long 0x3f353f80, 0xbf350000, 0x3f353f80, 0xbf350000
.long 0x3f553f80, 0xbe483ec4, 0xbf55bf80, 0x3e48bec4
.long 0x3f6d3f80, 0x3ec43f35, 0x3f6d3f80, 0x3ec43f35
.long 0x3f7b3f80, 0x3f553f6d, 0xbf7bbf80, 0xbf55bf6d
.long 0xbf803f80, 0xbf803f80, 0xbf803f80, 0xbf803f80
.long 0xbf0e3f35, 0xbe483ec4, 0x3f0ebf35, 0x3e48bec4
.long 0x3ec40000, 0x3f6dbf35, 0x3ec40000, 0x3f6dbf35
.long 0x3f7bbf35, 0x3f0ebf6d, 0xbf7b3f35, 0xbf0e3f6d
.long 0x3f35bf80, 0xbf350000, 0x3f35bf80, 0xbf350000
.long 0xbe48bf35, 0xbf553f6d, 0x3e483f35, 0x3f55bf6d
.long 0xbf6d0000, 0x3ec43f35, 0xbf6d0000, 0x3ec43f35
.long 0xbf553f35, 0x3f7bbec4, 0x3f55bf35, 0xbf7b3ec4
.long 0x3f80, 0xbf80, 0x3f80, 0xbf80
.long 0x3f553f35, 0xbf7bbec4, 0xbf55bf35, 0x3f7b3ec4
.long 0x3f6d0000, 0xbec43f35, 0x3f6d0000, 0xbec43f35
.long 0x3e48bf35, 0x3f553f6d, 0xbe483f35, 0xbf55bf6d
.long 0xbf35bf80, 0x3f350000, 0xbf35bf80, 0x3f350000
.long 0xbf7bbf35, 0xbf0ebf6d, 0x3f7b3f35, 0x3f0e3f6d
.long 0xbec40000, 0xbf6dbf35, 0xbec40000, 0xbf6dbf35
.long 0x3f0e3f35, 0x3e483ec4, 0xbf0ebf35, 0xbe48bec4
.long 0xbf803f80, 0xbf803f80, 0xbf803f80, 0xbf803f80
.long 0x3e480000, 0x3f0ebec4, 0xbe480000, 0xbf0e3ec4
.long 0x3f6dbf80, 0x3ec4bf35, 0x3f6dbf80, 0x3ec4bf35
.long 0xbf0e0000, 0xbf7b3f6d, 0x3f0e0000, 0x3f7bbf6d
.long 0xbf353f80, 0x3f350000, 0xbf353f80, 0x3f350000
.long 0x3f550000, 0x3e48bf6d, 0xbf550000, 0xbe483f6d
.long 0x3ec4bf80, 0xbf6d3f35, 0x3ec4bf80, 0xbf6d3f35
.long 0xbf7b0000, 0x3f553ec4, 0x3f7b0000, 0xbf55bec4
.long 0x3f80, 0xbf80, 0x3f80, 0xbf80
.long 0x3f7b0000, 0xbf553ec4, 0xbf7b0000, 0x3f55bec4
.long 0xbec4bf80, 0x3f6d3f35, 0xbec4bf80, 0x3f6d3f35
.long 0xbf550000, 0xbe48bf6d, 0x3f550000, 0x3e483f6d
.long 0x3f353f80, 0xbf350000, 0x3f353f80, 0xbf350000
.long 0x3f0e0000, 0x3f7b3f6d, 0xbf0e0000, 0xbf7bbf6d
.long 0xbf6dbf80, 0xbec4bf35, 0xbf6dbf80, 0xbec4bf35
.long 0xbe480000, 0xbf0ebec4, 0x3e480000, 0x3f0e3ec4
.long 0xbf803f80, 0xbf803f80, 0xbf803f80, 0xbf803f80
.long 0x3f55bf35, 0x3f7bbf6d, 0xbf553f35, 0xbf7b3f6d
.long 0xbec40000, 0xbf6d3f35, 0xbec40000, 0xbf6d3f35
.long 0xbe483f35, 0x3f55bec4, 0x3e48bf35, 0xbf553ec4
.long 0x3f35bf80, 0xbf350000, 0x3f35bf80, 0xbf350000
.long 0xbf7b3f35, 0x3f0e3ec4, 0x3f7bbf35, 0xbf0ebec4
.long 0x3f6d0000, 0xbec4bf35, 0x3f6d0000, 0xbec4bf35
.long 0xbf0ebf35, 0x3e483f6d, 0x3f0e3f35, 0xbe48bf6d
.long 0x3f80, 0xbf80, 0x3f80, 0xbf80
.long 0x3f0ebf35, 0xbe483f6d, 0xbf0e3f35, 0x3e48bf6d
.long 0xbf6d0000, 0x3ec4bf35, 0xbf6d0000, 0x3ec4bf35
.long 0x3f7b3f35, 0xbf0e3ec4, 0xbf7bbf35, 0x3f0ebec4
.long 0xbf35bf80, 0x3f350000, 0xbf35bf80, 0x3f350000
.long 0x3e483f35, 0xbf55bec4, 0xbe48bf35, 0x3f553ec4
.long 0x3ec40000, 0x3f6d3f35, 0x3ec40000, 0x3f6d3f35
.long 0xbf55bf35, 0xbf7bbf6d, 0x3f553f35, 0x3f7b3f6d
.long 0x0, 0x0, 0x0, 0x0
.long 0x3e480000, 0x3f0e3ec4, 0xbe480000, 0xbf0ebec4
.long 0x3ec40000, 0x3f6d3f35, 0x3ec40000, 0x3f6d3f35
.long 0x3f0e0000, 0x3f7b3f6d, 0xbf0e0000, 0xbf7bbf6d
.long 0x3f350000, 0x3f353f80, 0x3f350000, 0x3f353f80
.long 0x3f550000, 0x3e483f6d, 0xbf550000, 0xbe48bf6d
.long 0x3f6d0000, 0xbec43f35, 0x3f6d0000, 0xbec43f35
.long 0x3f7b0000, 0xbf553ec4, 0xbf7b0000, 0x3f55bec4
.long 0x3f800000, 0xbf800000, 0x3f800000, 0xbf800000
.long 0x3f7b0000, 0xbf55bec4, 0xbf7b0000, 0x3f553ec4
.long 0x3f6d0000, 0xbec4bf35, 0x3f6d0000, 0xbec4bf35
.long 0x3f550000, 0x3e48bf6d, 0xbf550000, 0xbe483f6d
.long 0x3f350000, 0x3f35bf80, 0x3f350000, 0x3f35bf80
.long 0x3f0e0000, 0x3f7bbf6d, 0xbf0e0000, 0xbf7b3f6d
.long 0x3ec40000, 0x3f6dbf35, 0x3ec40000, 0x3f6dbf35
.long 0x3e480000, 0x3f0ebec4, 0xbe480000, 0xbf0e3ec4
.long 0x0, 0x0, 0x0, 0x0
.long 0x3f553f35, 0x3f7b3f6d, 0xbf55bf35, 0xbf7bbf6d
.long 0x3f6d3f80, 0x3ec43f35, 0x3f6d3f80, 0x3ec43f35
.long 0x3e483f35, 0xbf55bec4, 0xbe48bf35, 0x3f553ec4
.long 0xbf350000, 0xbf35bf80, 0xbf350000, 0xbf35bf80
.long 0xbf7bbf35, 0x3f0ebec4, 0x3f7b3f35, 0xbf0e3ec4
.long 0xbec4bf80, 0x3f6d3f35, 0xbec4bf80, 0x3f6d3f35
.long 0x3f0ebf35, 0xbe483f6d, 0xbf0e3f35, 0x3e48bf6d
.long 0x3f800000, 0xbf800000, 0x3f800000, 0xbf800000
.long 0x3f0e3f35, 0xbe48bf6d, 0xbf0ebf35, 0x3e483f6d
.long 0xbec43f80, 0x3f6dbf35, 0xbec43f80, 0x3f6dbf35
.long 0xbf7b3f35, 0x3f0e3ec4, 0x3f7bbf35, 0xbf0ebec4
.long 0xbf350000, 0xbf353f80, 0xbf350000, 0xbf353f80
.long 0x3e48bf35, 0xbf553ec4, 0xbe483f35, 0x3f55bec4
.long 0x3f6dbf80, 0x3ec4bf35, 0x3f6dbf80, 0x3ec4bf35
.long 0x3f55bf35, 0x3f7bbf6d, 0xbf553f35, 0xbf7b3f6d
.long 0x0, 0x0, 0x0, 0x0
.long 0x3f7b3f80, 0x3f553f6d, 0xbf7bbf80, 0xbf55bf6d
.long 0xbec40000, 0xbf6dbf35, 0xbec40000, 0xbf6dbf35
.long 0xbf55bf80, 0x3e48bec4, 0x3f553f80, 0xbe483ec4
.long 0x3f350000, 0x3f353f80, 0x3f350000, 0x3f353f80
.long 0x3f0e3f80, 0xbf7bbec4, 0xbf0ebf80, 0x3f7b3ec4
.long 0xbf6d0000, 0x3ec4bf35, 0xbf6d0000, 0x3ec4bf35
.long 0xbe48bf80, 0x3f0e3f6d, 0x3e483f80, 0xbf0ebf6d
.long 0x3f800000, 0xbf800000, 0x3f800000, 0xbf800000
.long 0xbe483f80, 0x3f0ebf6d, 0x3e48bf80, 0xbf0e3f6d
.long 0xbf6d0000, 0x3ec43f35, 0xbf6d0000, 0x3ec43f35
.long 0x3f0ebf80, 0xbf7b3ec4, 0xbf0e3f80, 0x3f7bbec4
.long 0x3f350000, 0x3f35bf80, 0x3f350000, 0x3f35bf80
.long 0xbf553f80, 0x3e483ec4, 0x3f55bf80, 0xbe48bec4
.long 0xbec40000, 0xbf6d3f35, 0xbec40000, 0xbf6d3f35
.long 0x3f7bbf80, 0x3f55bf6d, 0xbf7b3f80, 0xbf553f6d
.long 0x0, 0x0, 0x0, 0x0
.long 0x3f0e3f35, 0x3e483ec4, 0xbf0ebf35, 0xbe48bec4
.long 0xbf6dbf80, 0xbec4bf35, 0xbf6dbf80, 0xbec4bf35
.long 0x3f7b3f35, 0x3f0e3f6d, 0xbf7bbf35, 0xbf0ebf6d
.long 0xbf350000, 0xbf35bf80, 0xbf350000, 0xbf35bf80
.long 0x3e48bf35, 0x3f553f6d, 0xbe483f35, 0xbf55bf6d
.long 0x3ec43f80, 0xbf6dbf35, 0x3ec43f80, 0xbf6dbf35
.long 0xbf55bf35, 0x3f7b3ec4, 0x3f553f35, 0xbf7bbec4
.long 0x3f800000, 0xbf800000, 0x3f800000, 0xbf800000
.long 0xbf553f35, 0x3f7bbec4, 0x3f55bf35, 0xbf7b3ec4
.long 0x3ec4bf80, 0xbf6d3f35, 0x3ec4bf80, 0xbf6d3f35
.long 0x3e483f35, 0x3f55bf6d, 0xbe48bf35, 0xbf553f6d
.long 0xbf350000, 0xbf353f80, 0xbf350000, 0xbf353f80
.long 0x3f7bbf35, 0x3f0ebf6d, 0xbf7b3f35, 0xbf0e3f6d
.long 0xbf6d3f80, 0xbec43f35, 0xbf6d3f80, 0xbec43f35
.long 0x3f0ebf35, 0x3e48bec4, 0xbf0e3f35, 0xbe483ec4
.long 0x0, 0x0, 0x0, 0x0
.long 0xbe480000, 0xbf0e3ec4, 0x3e480000, 0x3f0ebec4
.long 0xbec40000, 0xbf6d3f35, 0xbec40000, 0xbf6d3f35
.long 0xbf0e0000, 0xbf7b3f6d, 0x3f0e0000, 0x3f7bbf6d
.long 0xbf350000, 0xbf353f80, 0xbf350000, 0xbf353f80
.long 0xbf550000, 0xbe483f6d, 0x3f550000, 0x3e48bf6d
.long 0xbf6d0000, 0x3ec43f35, 0xbf6d0000, 0x3ec43f35
.long 0xbf7b0000, 0x3f553ec4, 0x3f7b0000, 0xbf55bec4
.long 0xbf800000, 0x3f800000, 0xbf800000, 0x3f800000
.long 0xbf7b0000, 0x3f55bec4, 0x3f7b0000, 0xbf553ec4
.long 0xbf6d0000, 0x3ec4bf35, 0xbf6d0000, 0x3ec4bf35
.long 0xbf550000, 0xbe48bf6d, 0x3f550000, 0x3e483f6d
.long 0xbf350000, 0xbf35bf80, 0xbf350000, 0xbf35bf80
.long 0xbf0e0000, 0xbf7bbf6d, 0x3f0e0000, 0x3f7b3f6d
.long 0xbec40000, 0xbf6dbf35, 0xbec40000, 0xbf6dbf35
.long 0xbe480000, 0xbf0ebec4, 0x3e480000, 0x3f0e3ec4
.long 0x0, 0x0, 0x0, 0x0
.long 0xbf553f35, 0xbf7b3f6d, 0x3f55bf35, 0x3f7bbf6d
.long 0xbf6d3f80, 0xbec43f35, 0xbf6d3f80, 0xbec43f35
.long 0xbe483f35, 0x3f55bec4, 0x3e48bf35, 0xbf553ec4
.long 0x3f350000, 0x3f35bf80, 0x3f350000, 0x3f35bf80
.long 0x3f7bbf35, 0xbf0ebec4, 0xbf7b3f35, 0x3f0e3ec4
.long 0x3ec4bf80, 0xbf6d3f35, 0x3ec4bf80, 0xbf6d3f35
.long 0xbf0ebf35, 0x3e483f6d, 0x3f0e3f35, 0xbe48bf6d
.long 0xbf800000, 0x3f800000, 0xbf800000, 0x3f800000
.long 0xbf0e3f35, 0x3e48bf6d, 0x3f0ebf35, 0xbe483f6d
.long 0x3ec43f80, 0xbf6dbf35, 0x3ec43f80, 0xbf6dbf35
.long 0x3f7b3f35, 0xbf0e3ec4, 0xbf7bbf35, 0x3f0ebec4
.long 0x3f350000, 0x3f353f80, 0x3f350000, 0x3f353f80
.long 0xbe48bf35, 0x3f553ec4, 0x3e483f35, 0xbf55bec4
.long 0xbf6dbf80, 0xbec4bf35, 0xbf6dbf80, 0xbec4bf35
.long 0xbf55bf35, 0xbf7bbf6d, 0x3f553f35, 0x3f7b3f6d
.long 0x0, 0x0, 0x0, 0x0
.long 0xbf7b3f80, 0xbf553f6d, 0x3f7bbf80, 0x3f55bf6d
.long 0x3ec40000, 0x3f6dbf35, 0x3ec40000, 0x3f6dbf35
.long 0x3f55bf80, 0xbe48bec4, 0xbf553f80, 0x3e483ec4
.long 0xbf350000, 0xbf353f80, 0xbf350000, 0xbf353f80
.long 0xbf0e3f80, 0x3f7bbec4, 0x3f0ebf80, 0xbf7b3ec4
.long 0x3f6d0000, 0xbec4bf35, 0x3f6d0000, 0xbec4bf35
.long 0x3e48bf80, 0xbf0e3f6d, 0xbe483f80, 0x3f0ebf6d
.long 0xbf800000, 0x3f800000, 0xbf800000, 0x3f800000
.long 0x3e483f80, 0xbf0ebf6d, 0xbe48bf80, 0x3f0e3f6d
.long 0x3f6d0000, 0xbec43f35, 0x3f6d0000, 0xbec43f35
.long 0xbf0ebf80, 0x3f7b3ec4, 0x3f0e3f80, 0xbf7bbec4
.long 0xbf350000, 0xbf35bf80, 0xbf350000, 0xbf35bf80
.long 0x3f553f80, 0xbe483ec4, 0xbf55bf80, 0x3e48bec4
.long 0x3ec40000, 0x3f6d3f35, 0x3ec40000, 0x3f6d3f35
.long 0xbf7bbf80, 0xbf55bf6d, 0x3f7b3f80, 0x3f553f6d
.long 0x0, 0x0, 0x0, 0x0
.long 0xbf0e3f35, 0xbe483ec4, 0x3f0ebf35, 0x3e48bec4
.long 0x3f6dbf80, 0x3ec4bf35, 0x3f6dbf80, 0x3ec4bf35
.long 0xbf7b3f35, 0xbf0e3f6d, 0x3f7bbf35, 0x3f0ebf6d
.long 0x3f350000, 0x3f35bf80, 0x3f350000, 0x3f35bf80
.long 0xbe48bf35, 0xbf553f6d, 0x3e483f35, 0x3f55bf6d
.long 0xbec43f80, 0x3f6dbf35, 0xbec43f80, 0x3f6dbf35
.long 0x3f55bf35, 0xbf7b3ec4, 0xbf553f35, 0x3f7bbec4
.long 0xbf800000, 0x3f800000, 0xbf800000, 0x3f800000
.long 0x3f553f35, 0xbf7bbec4, 0xbf55bf35, 0x3f7b3ec4
.long 0xbec4bf80, 0x3f6d3f35, 0xbec4bf80, 0x3f6d3f35
.long 0xbe483f35, 0xbf55bf6d, 0x3e48bf35, 0x3f553f6d
.long 0x3f350000, 0x3f353f80, 0x3f350000, 0x3f353f80
.long 0xbf7bbf35, 0xbf0ebf6d, 0x3f7b3f35, 0x3f0e3f6d
.long 0x3f6d3f80, 0x3ec43f35, 0x3f6d3f80, 0x3ec43f35
.long 0xbf0ebf35, 0xbe48bec4, 0x3f0e3f35, 0x3e483ec4

.globl parallel_sum__spectral_gfnet__glu_gated_reglu__prompt_kernel
.p2align 8
.type parallel_sum__spectral_gfnet__glu_gated_reglu__prompt_kernel,@function
parallel_sum__spectral_gfnet__glu_gated_reglu__prompt_kernel:
    s_cmp_ge_u32 s2, 256
    s_cbranch_scc1 L_end
    s_load_dwordx16 s[48:63], s[0:1], 0
    s_load_dwordx4 s[64:67], s[0:1], 64
    s_getpc_b64 s[40:41]
L_pc:
    s_sub_u32 s40, s40, L_pc-CTAB
    s_subb_u32 s41, s41, 0
    s_mov_b32 s42, 544768
    s_mov_b32 s43, 0x00020000
    s_mov_b32 s16, s40
    s_mov_b32 s17, s41
    s_mov_b32 s18, L_codeend-CTAB
    s_mov_b32 s19, 0x00020000
    s_mov_b32 s20, 544768
    v_lshlrev_b32 v6, 7, v0
    buffer_load_dword v7, v6, s[16:19], s20 offen
    s_and_b32 s75, s2, 7
    s_lshr_b32 s74, s2, 3
    s_and_b32 s76, s75, 1
    s_lshl_b32 s76, s76, 3
    s_and_b32 s77, s74, 7
    s_add_u32 s69, s76, s77
    s_lshr_b32 s78, s75, 1
    s_lshl_b32 s78, s78, 2
    s_lshr_b32 s77, s74, 3
    s_add_u32 s70, s78, s77
    s_lshl_b32 s87, s76, 1
    s_add_u32 s87, s87, s70
    s_lshr_b32 s78, s75, 1
    s_mul_i32 s70, s78, 3
    s_add_u32 s70, s70, s77
    s_add_u32 s70, s70, 3
    s_cmp_eq_u32 s77, 0
    s_cselect_b32 s70, s78, s70
    s_mov_b32 s33, s77
    s_and_b32 s88, s74, 7
    v_lshrrev_b32 v8, 6, v0
    v_and_b32 v1, 63, v0
    v_readfirstlane_b32 s101, v8
    s_nop 0
    s_and_b32 s71, s101, 3
    s_lshr_b32 s101, s101, 2
    s_lshr_b32 s72, s71, 1
    s_and_b32 s73, s71, 1
    s_lshl_b32 s84, s71, 12
    s_sub_u32 s76, s70, 4
    s_lshl_b32 s85, s76, 1
    s_add_u32 s86, s85, 1
    s_add_u32 s76, s70, 24
    s_cmp_lt_u32 s70, 4
    s_cselect_b32 s86, s76, s86
    s_cselect_b32 s85, s76, s85
    s_lshl_b32 s76, s33, 1
    s_add_u32 s3, s69, s76
    s_and_b32 s3, s3, 7
    s_and_b32 s44, s3, 6
    v_lshlrev_b32 v2, 4, v1
    v_mov_b32 v3, 162816
    s_lshl_b32 s76, s71, 2
    s_add_u32 s76, s76, 162816
    v_mov_b32 v4, s76
    v_and_b32 v8, 31, v1
    v_lshlrev_b32 v8, 2, v8
    v_add_u32 v8, 162816, v8
    v_mov_b32 v9, 0
    ds_write_b32 v8, v9
    s_and_b32 s76, s69, 7
    s_lshl_b32 s76, s76, 18
    s_lshr_b32 s77, s69, 3
    s_lshl_b32 s77, s77, 14
    s_add_u32 s80, s76, s77
    s_add_u32 s81, s80, s84
    s_waitcnt lgkmcnt(0)
    s_load_dword s68, s[66:67], 0
    s_mov_b32 s8, s48
    s_mov_b32 s9, s49
    s_mov_b32 s10, 2097152
    s_mov_b32 s11, 0x00020000
    s_mov_b32 s12, s66
    s_mov_b32 s13, s67
    s_mov_b32 s14, 16777216
    s_mov_b32 s15, 0x00020000
    s_barrier
    s_cmp_eq_u32 s101, 0
    s_cbranch_scc1 L_compute
    v_lshrrev_b32 v8, 3, v1
    v_and_b32 v9, 7, v1
    v_lshrrev_b32 v10, 1, v8
    v_xor_b32 v10, v10, v9
    v_lshlrev_b32 v10, 4, v10
    v_lshlrev_b32 v11, 15, v8
    v_add_u32 v30, v10, v11
    v_xor_b32 v31, 64, v30
    v_lshrrev_b32 v8, 3, v1
    v_and_b32 v9, 7, v1
    v_lshrrev_b32 v10, 2, v1
    v_and_b32 v10, 4, v10
    v_xor_b32 v10, v10, v9
    v_lshlrev_b32 v10, 4, v10
    v_mul_u32_u24 v11, 3584, v8
    v_add_u32 v32, v10, v11
    v_mul_u32_u24 v11, 1024, v8
    v_add_u32 v33, v10, v11
    s_mov_b32 s20, s56
    s_mov_b32 s21, s57
    s_mov_b32 s22, 1835008
    s_mov_b32 s23, 0x00020000
    s_mov_b32 s24, s58
    s_mov_b32 s25, s59
    s_mov_b32 s26, 1835008
    s_mov_b32 s27, 0x00020000
    s_lshl_b32 s93, s70, 8
    s_lshl_b32 s76, s72, 7
    s_add_u32 s93, s93, s76
    s_lshl_b32 s76, s73, 15
    s_add_u32 s93, s93, s76
    s_cmp_lt_u32 s70, 4
    s_cbranch_scc1 L_h_dft
    s_mov_b32 s39, s80
    s_lshl_b32 s37, s71, 14
    s_cmp_lt_u32 s71, 2
    s_cbranch_scc0 L_on_2
    s_lshl_b32 s45, s44, 7
    s_add_u32 s45, s45, s39
    s_lshl_b32 s79, s71, 13
    s_add_u32 s45, s45, s79
    s_add_u32 m0, s79, 0
    s_add_u32 s76, s45, 0
    buffer_load_dwordx4 v30, s[8:11], s76 offen lds
    s_add_u32 m0, s79, 1024
    s_add_u32 s76, s45, 1024
    buffer_load_dwordx4 v31, s[8:11], s76 offen lds
    s_add_u32 m0, s79, 2048
    s_add_u32 s76, s45, 2048
    buffer_load_dwordx4 v30, s[8:11], s76 offen lds
    s_add_u32 m0, s79, 3072
    s_add_u32 s76, s45, 3072
    buffer_load_dwordx4 v31, s[8:11], s76 offen lds
    s_add_u32 m0, s79, 4096
    s_add_u32 s76, s45, 4096
    buffer_load_dwordx4 v30, s[8:11], s76 offen lds
    s_add_u32 m0, s79, 5120
    s_add_u32 s76, s45, 5120
    buffer_load_dwordx4 v31, s[8:11], s76 offen lds
    s_add_u32 m0, s79, 6144
    s_add_u32 s76, s45, 6144
    buffer_load_dwordx4 v30, s[8:11], s76 offen lds
    s_add_u32 m0, s79, 7168
    s_add_u32 s76, s45, 7168
    buffer_load_dwordx4 v31, s[8:11], s76 offen lds
    s_lshl_b32 s78, s44, 2
    s_add_u32 s78, s78, s71
    s_lshl_b32 s78, s78, 4
    s_mul_i32 s46, s78, 3584
    s_lshl_b32 s77, s85, 7
    s_add_u32 s46, s46, s77
    s_lshl_b32 s78, s71, 11
    s_add_u32 m0, s78, 65536
    s_add_u32 s76, s46, 0
    buffer_load_dwordx4 v32, s[20:23], s76 offen lds
    s_add_u32 m0, s78, 66560
    s_add_u32 s76, s46, 28672
    buffer_load_dwordx4 v32, s[20:23], s76 offen lds
    s_add_u32 m0, s78, 69632
    s_add_u32 s76, s46, 0
    buffer_load_dwordx4 v32, s[24:27], s76 offen lds
    s_add_u32 m0, s78, 70656
    s_add_u32 s76, s46, 28672
    buffer_load_dwordx4 v32, s[24:27], s76 offen lds
    s_add_u32 m0, s78, 73728
    s_add_u32 s76, s46, 128
    buffer_load_dwordx4 v32, s[20:23], s76 offen lds
    s_add_u32 m0, s78, 74752
    s_add_u32 s76, s46, 28800
    buffer_load_dwordx4 v32, s[20:23], s76 offen lds
    s_add_u32 m0, s78, 77824
    s_add_u32 s76, s46, 128
    buffer_load_dwordx4 v32, s[24:27], s76 offen lds
    s_add_u32 m0, s78, 78848
    s_add_u32 s76, s46, 28800
    buffer_load_dwordx4 v32, s[24:27], s76 offen lds
    s_add_u32 m0, s78, 81920
    s_add_u32 s76, s46, 114688
    buffer_load_dwordx4 v32, s[20:23], s76 offen lds
    s_add_u32 m0, s78, 82944
    s_add_u32 s76, s46, 143360
    buffer_load_dwordx4 v32, s[20:23], s76 offen lds
    s_add_u32 m0, s78, 86016
    s_add_u32 s76, s46, 114688
    buffer_load_dwordx4 v32, s[24:27], s76 offen lds
    s_add_u32 m0, s78, 87040
    s_add_u32 s76, s46, 143360
    buffer_load_dwordx4 v32, s[24:27], s76 offen lds
    s_add_u32 m0, s78, 90112
    s_add_u32 s76, s46, 114816
    buffer_load_dwordx4 v32, s[20:23], s76 offen lds
    s_add_u32 m0, s78, 91136
    s_add_u32 s76, s46, 143488
    buffer_load_dwordx4 v32, s[20:23], s76 offen lds
    s_add_u32 m0, s78, 94208
    s_add_u32 s76, s46, 114816
    buffer_load_dwordx4 v32, s[24:27], s76 offen lds
    s_add_u32 m0, s78, 95232
    s_add_u32 s76, s46, 143488
    buffer_load_dwordx4 v32, s[24:27], s76 offen lds
    s_waitcnt vmcnt(8)
    v_mov_b32 v27, 1
    ds_write_b32 v4, v27 offset:96
    s_waitcnt vmcnt(0)
    v_mov_b32 v27, 2
    ds_write_b32 v4, v27 offset:96
    s_cmp_eq_u32 s71, 1
    s_cbranch_scc0 L_on_3
    s_add_u32 s38, s44, 3
    s_and_b32 s38, s38, 7
    s_mov_b32 s37, 49152
    s_lshl_b32 s45, s38, 7
    s_add_u32 s45, s45, s39
    s_add_u32 m0, s37, 0
    s_add_u32 s76, s45, 0
    buffer_load_dwordx4 v30, s[8:11], s76 offen lds
    s_add_u32 m0, s37, 1024
    s_add_u32 s76, s45, 1024
    buffer_load_dwordx4 v31, s[8:11], s76 offen lds
    s_add_u32 m0, s37, 2048
    s_add_u32 s76, s45, 2048
    buffer_load_dwordx4 v30, s[8:11], s76 offen lds
    s_add_u32 m0, s37, 3072
    s_add_u32 s76, s45, 3072
    buffer_load_dwordx4 v31, s[8:11], s76 offen lds
    s_add_u32 m0, s37, 4096
    s_add_u32 s76, s45, 4096
    buffer_load_dwordx4 v30, s[8:11], s76 offen lds
    s_add_u32 m0, s37, 5120
    s_add_u32 s76, s45, 5120
    buffer_load_dwordx4 v31, s[8:11], s76 offen lds
    s_add_u32 m0, s37, 6144
    s_add_u32 s76, s45, 6144
    buffer_load_dwordx4 v30, s[8:11], s76 offen lds
    s_add_u32 m0, s37, 7168
    s_add_u32 s76, s45, 7168
    buffer_load_dwordx4 v31, s[8:11], s76 offen lds
    s_add_u32 m0, s37, 8192
    s_add_u32 s76, s45, 8192
    buffer_load_dwordx4 v30, s[8:11], s76 offen lds
    s_add_u32 m0, s37, 9216
    s_add_u32 s76, s45, 9216
    buffer_load_dwordx4 v31, s[8:11], s76 offen lds
    s_add_u32 m0, s37, 10240
    s_add_u32 s76, s45, 10240
    buffer_load_dwordx4 v30, s[8:11], s76 offen lds
    s_add_u32 m0, s37, 11264
    s_add_u32 s76, s45, 11264
    buffer_load_dwordx4 v31, s[8:11], s76 offen lds
    s_add_u32 m0, s37, 12288
    s_add_u32 s76, s45, 12288
    buffer_load_dwordx4 v30, s[8:11], s76 offen lds
    s_add_u32 m0, s37, 13312
    s_add_u32 s76, s45, 13312
    buffer_load_dwordx4 v31, s[8:11], s76 offen lds
    s_add_u32 m0, s37, 14336
    s_add_u32 s76, s45, 14336
    buffer_load_dwordx4 v30, s[8:11], s76 offen lds
    s_add_u32 m0, s37, 15360
    s_add_u32 s76, s45, 15360
    buffer_load_dwordx4 v31, s[8:11], s76 offen lds
    s_lshl_b32 s37, s71, 14
L_on_3:
    s_branch L_r0j_1
L_on_2:
    s_mov_b32 s36, s71
    s_lshr_b32 s77, s36, 1
    s_add_u32 s77, s77, s44
    s_and_b32 s77, s77, 7
    s_lshl_b32 s78, s77, 1
    s_and_b32 s77, s36, 1
    s_add_u32 s78, s78, s77
    s_lshl_b32 s78, s78, 5
    s_mul_i32 s46, s78, 3584
    s_lshl_b32 s77, s85, 7
    s_add_u32 s46, s46, s77
    s_cmp_eq_u32 s71, 2
    s_cbranch_scc0 L_on_4
    s_add_u32 s38, s44, 1
    s_and_b32 s38, s38, 7
    s_mov_b32 s37, 16384
    s_lshl_b32 s45, s38, 7
    s_add_u32 s45, s45, s39
    s_add_u32 m0, s37, 0
    s_add_u32 s76, s45, 0
    buffer_load_dwordx4 v30, s[8:11], s76 offen lds
    s_add_u32 m0, s37, 1024
    s_add_u32 s76, s45, 1024
    buffer_load_dwordx4 v31, s[8:11], s76 offen lds
    s_add_u32 m0, s37, 2048
    s_add_u32 s76, s45, 2048
    buffer_load_dwordx4 v30, s[8:11], s76 offen lds
    s_add_u32 m0, s37, 3072
    s_add_u32 s76, s45, 3072
    buffer_load_dwordx4 v31, s[8:11], s76 offen lds
    s_add_u32 m0, s37, 4096
    s_add_u32 s76, s45, 4096
    buffer_load_dwordx4 v30, s[8:11], s76 offen lds
    s_add_u32 m0, s37, 5120
    s_add_u32 s76, s45, 5120
    buffer_load_dwordx4 v31, s[8:11], s76 offen lds
    s_add_u32 m0, s37, 6144
    s_add_u32 s76, s45, 6144
    buffer_load_dwordx4 v30, s[8:11], s76 offen lds
    s_add_u32 m0, s37, 7168
    s_add_u32 s76, s45, 7168
    buffer_load_dwordx4 v31, s[8:11], s76 offen lds
    s_add_u32 m0, s37, 8192
    s_add_u32 s76, s45, 8192
    buffer_load_dwordx4 v30, s[8:11], s76 offen lds
    s_add_u32 m0, s37, 9216
    s_add_u32 s76, s45, 9216
    buffer_load_dwordx4 v31, s[8:11], s76 offen lds
    s_add_u32 m0, s37, 10240
    s_add_u32 s76, s45, 10240
    buffer_load_dwordx4 v30, s[8:11], s76 offen lds
    s_add_u32 m0, s37, 11264
    s_add_u32 s76, s45, 11264
    buffer_load_dwordx4 v31, s[8:11], s76 offen lds
    s_add_u32 m0, s37, 12288
    s_add_u32 s76, s45, 12288
    buffer_load_dwordx4 v30, s[8:11], s76 offen lds
    s_add_u32 m0, s37, 13312
    s_add_u32 s76, s45, 13312
    buffer_load_dwordx4 v31, s[8:11], s76 offen lds
    s_add_u32 m0, s37, 14336
    s_add_u32 s76, s45, 14336
    buffer_load_dwordx4 v30, s[8:11], s76 offen lds
    s_add_u32 m0, s37, 15360
    s_add_u32 s76, s45, 15360
    buffer_load_dwordx4 v31, s[8:11], s76 offen lds
    s_lshl_b32 s37, s71, 14
    s_add_u32 m0, s37, 65536
    s_add_u32 s76, s46, 0
    buffer_load_dwordx4 v32, s[20:23], s76 offen lds
    s_add_u32 m0, s37, 66560
    s_add_u32 s76, s46, 28672
    buffer_load_dwordx4 v32, s[20:23], s76 offen lds
    s_add_u32 m0, s37, 67584
    s_add_u32 s76, s46, 57344
    buffer_load_dwordx4 v32, s[20:23], s76 offen lds
    s_add_u32 m0, s37, 68608
    s_add_u32 s76, s46, 86016
    buffer_load_dwordx4 v32, s[20:23], s76 offen lds
    s_add_u32 m0, s37, 69632
    s_add_u32 s76, s46, 0
    buffer_load_dwordx4 v32, s[24:27], s76 offen lds
    s_add_u32 m0, s37, 70656
    s_add_u32 s76, s46, 28672
    buffer_load_dwordx4 v32, s[24:27], s76 offen lds
    s_add_u32 m0, s37, 71680
    s_add_u32 s76, s46, 57344
    buffer_load_dwordx4 v32, s[24:27], s76 offen lds
    s_add_u32 m0, s37, 72704
    s_add_u32 s76, s46, 86016
    buffer_load_dwordx4 v32, s[24:27], s76 offen lds
    s_add_u32 m0, s37, 73728
    s_add_u32 s76, s46, 128
    buffer_load_dwordx4 v32, s[20:23], s76 offen lds
    s_add_u32 m0, s37, 74752
    s_add_u32 s76, s46, 28800
    buffer_load_dwordx4 v32, s[20:23], s76 offen lds
    s_add_u32 m0, s37, 75776
    s_add_u32 s76, s46, 57472
    buffer_load_dwordx4 v32, s[20:23], s76 offen lds
    s_add_u32 m0, s37, 76800
    s_add_u32 s76, s46, 86144
    buffer_load_dwordx4 v32, s[20:23], s76 offen lds
    s_add_u32 m0, s37, 77824
    s_add_u32 s76, s46, 128
    buffer_load_dwordx4 v32, s[24:27], s76 offen lds
    s_add_u32 m0, s37, 78848
    s_add_u32 s76, s46, 28800
    buffer_load_dwordx4 v32, s[24:27], s76 offen lds
    s_add_u32 m0, s37, 79872
    s_add_u32 s76, s46, 57472
    buffer_load_dwordx4 v32, s[24:27], s76 offen lds
    s_add_u32 m0, s37, 80896
    s_add_u32 s76, s46, 86144
    buffer_load_dwordx4 v32, s[24:27], s76 offen lds
    s_branch L_r0j_1
L_on_4:
    s_add_u32 m0, s37, 65536
    s_add_u32 s76, s46, 0
    buffer_load_dwordx4 v32, s[20:23], s76 offen lds
    s_add_u32 m0, s37, 66560
    s_add_u32 s76, s46, 28672
    buffer_load_dwordx4 v32, s[20:23], s76 offen lds
    s_add_u32 m0, s37, 67584
    s_add_u32 s76, s46, 57344
    buffer_load_dwordx4 v32, s[20:23], s76 offen lds
    s_add_u32 m0, s37, 68608
    s_add_u32 s76, s46, 86016
    buffer_load_dwordx4 v32, s[20:23], s76 offen lds
    s_add_u32 m0, s37, 69632
    s_add_u32 s76, s46, 0
    buffer_load_dwordx4 v32, s[24:27], s76 offen lds
    s_add_u32 m0, s37, 70656
    s_add_u32 s76, s46, 28672
    buffer_load_dwordx4 v32, s[24:27], s76 offen lds
    s_add_u32 m0, s37, 71680
    s_add_u32 s76, s46, 57344
    buffer_load_dwordx4 v32, s[24:27], s76 offen lds
    s_add_u32 m0, s37, 72704
    s_add_u32 s76, s46, 86016
    buffer_load_dwordx4 v32, s[24:27], s76 offen lds
    s_add_u32 m0, s37, 73728
    s_add_u32 s76, s46, 128
    buffer_load_dwordx4 v32, s[20:23], s76 offen lds
    s_add_u32 m0, s37, 74752
    s_add_u32 s76, s46, 28800
    buffer_load_dwordx4 v32, s[20:23], s76 offen lds
    s_add_u32 m0, s37, 75776
    s_add_u32 s76, s46, 57472
    buffer_load_dwordx4 v32, s[20:23], s76 offen lds
    s_add_u32 m0, s37, 76800
    s_add_u32 s76, s46, 86144
    buffer_load_dwordx4 v32, s[20:23], s76 offen lds
    s_add_u32 m0, s37, 77824
    s_add_u32 s76, s46, 128
    buffer_load_dwordx4 v32, s[24:27], s76 offen lds
    s_add_u32 m0, s37, 78848
    s_add_u32 s76, s46, 28800
    buffer_load_dwordx4 v32, s[24:27], s76 offen lds
    s_add_u32 m0, s37, 79872
    s_add_u32 s76, s46, 57472
    buffer_load_dwordx4 v32, s[24:27], s76 offen lds
    s_add_u32 m0, s37, 80896
    s_add_u32 s76, s46, 86144
    buffer_load_dwordx4 v32, s[24:27], s76 offen lds
    s_add_u32 s38, s44, 2
    s_and_b32 s38, s38, 7
    s_mov_b32 s37, 32768
    s_lshl_b32 s45, s38, 7
    s_add_u32 s45, s45, s39
    s_add_u32 m0, s37, 0
    s_add_u32 s76, s45, 0
    buffer_load_dwordx4 v30, s[8:11], s76 offen lds
    s_add_u32 m0, s37, 1024
    s_add_u32 s76, s45, 1024
    buffer_load_dwordx4 v31, s[8:11], s76 offen lds
    s_add_u32 m0, s37, 2048
    s_add_u32 s76, s45, 2048
    buffer_load_dwordx4 v30, s[8:11], s76 offen lds
    s_add_u32 m0, s37, 3072
    s_add_u32 s76, s45, 3072
    buffer_load_dwordx4 v31, s[8:11], s76 offen lds
    s_add_u32 m0, s37, 4096
    s_add_u32 s76, s45, 4096
    buffer_load_dwordx4 v30, s[8:11], s76 offen lds
    s_add_u32 m0, s37, 5120
    s_add_u32 s76, s45, 5120
    buffer_load_dwordx4 v31, s[8:11], s76 offen lds
    s_add_u32 m0, s37, 6144
    s_add_u32 s76, s45, 6144
    buffer_load_dwordx4 v30, s[8:11], s76 offen lds
    s_add_u32 m0, s37, 7168
    s_add_u32 s76, s45, 7168
    buffer_load_dwordx4 v31, s[8:11], s76 offen lds
    s_add_u32 m0, s37, 8192
    s_add_u32 s76, s45, 8192
    buffer_load_dwordx4 v30, s[8:11], s76 offen lds
    s_add_u32 m0, s37, 9216
    s_add_u32 s76, s45, 9216
    buffer_load_dwordx4 v31, s[8:11], s76 offen lds
    s_add_u32 m0, s37, 10240
    s_add_u32 s76, s45, 10240
    buffer_load_dwordx4 v30, s[8:11], s76 offen lds
    s_add_u32 m0, s37, 11264
    s_add_u32 s76, s45, 11264
    buffer_load_dwordx4 v31, s[8:11], s76 offen lds
    s_add_u32 m0, s37, 12288
    s_add_u32 s76, s45, 12288
    buffer_load_dwordx4 v30, s[8:11], s76 offen lds
    s_add_u32 m0, s37, 13312
    s_add_u32 s76, s45, 13312
    buffer_load_dwordx4 v31, s[8:11], s76 offen lds
    s_add_u32 m0, s37, 14336
    s_add_u32 s76, s45, 14336
    buffer_load_dwordx4 v30, s[8:11], s76 offen lds
    s_add_u32 m0, s37, 15360
    s_add_u32 s76, s45, 15360
    buffer_load_dwordx4 v31, s[8:11], s76 offen lds
    s_lshl_b32 s37, s71, 14
    s_waitcnt vmcnt(16)
    v_mov_b32 v27, 1
    ds_write_b32 v4, v27 offset:0
L_r0j_1:
    s_waitcnt vmcnt(0)
    v_mov_b32 v27, 1
    ds_write_b32 v4, v27 offset:0
    v_mov_b32 v27, 1
    ds_write_b32 v4, v27 offset:112
    s_lshl_b32 s76, s71, 6
    v_add_u32 v39, s76, v1
    v_and_b32 v36, 127, v39
    v_lshlrev_b32 v37, 4, v36
    s_lshl_b32 s32, s69, 11
    s_add_u32 s32, s32, 65536
    s_cmp_eq_u32 s72, 0
    s_cselect_b32 s33, s85, s86
    s_lshl_b32 s33, s33, 1
    s_add_u32 s33, s33, s73
    s_lshl_b32 s33, s33, 12
    s_add_u32 s33, s33, 131072
    v_lshlrev_b32 v38, 3, v1
    s_waitcnt lgkmcnt(0)
    s_add_u32 s68, s68, 1
    s_add_u32 s36, s71, 4
    s_sub_u32 s79, s36, 3
    s_add_u32 s38, s71, s44
    s_add_u32 s38, s38, 4
    s_max_u32 s79, s79, 2
    s_and_b32 s38, s38, 7
    s_lshr_b32 s77, s36, 1
    s_add_u32 s77, s77, s44
    s_and_b32 s77, s77, 7
    s_lshl_b32 s78, s77, 1
    s_and_b32 s77, s36, 1
    s_add_u32 s78, s78, s77
    s_lshl_b32 s78, s78, 5
    s_mul_i32 s46, s78, 3584
    s_lshl_b32 s77, s85, 7
    s_add_u32 s46, s46, s77
    ds_read_b128 v[24:27], v3 offset:16
    s_waitcnt lgkmcnt(0)
    v_min3_u32 v24, v24, v25, v26
    v_min_u32 v24, v24, v27
    s_nop 0
    v_readfirstlane_b32 s89, v24
    s_nop 0
    s_cmp_ge_u32 s89, s79
    s_cbranch_scc1 L_bk_6
L_sl_5:
    s_mov_b32 s100, 0
L_sp_7:
    s_sleep 1
    ds_read_b128 v[24:27], v3 offset:16
    s_waitcnt lgkmcnt(0)
    v_min3_u32 v24, v24, v25, v26
    v_min_u32 v24, v24, v27
    s_nop 0
    v_readfirstlane_b32 s89, v24
    s_nop 0
    s_cmp_ge_u32 s89, s79
    s_cbranch_scc1 L_bk_6
    s_add_u32 s100, s100, 1
    s_cmp_lt_u32 s100, 8388608
    s_cbranch_scc1 L_sp_7
L_bk_6:
    s_add_u32 m0, s37, 65536
    s_add_u32 s76, s46, 0
    buffer_load_dwordx4 v32, s[20:23], s76 offen lds
    s_add_u32 m0, s37, 66560
    s_add_u32 s76, s46, 28672
    buffer_load_dwordx4 v32, s[20:23], s76 offen lds
    s_add_u32 m0, s37, 67584
    s_add_u32 s76, s46, 57344
    buffer_load_dwordx4 v32, s[20:23], s76 offen lds
    s_add_u32 m0, s37, 68608
    s_add_u32 s76, s46, 86016
    buffer_load_dwordx4 v32, s[20:23], s76 offen lds
    s_add_u32 m0, s37, 69632
    s_add_u32 s76, s46, 0
    buffer_load_dwordx4 v32, s[24:27], s76 offen lds
    s_add_u32 m0, s37, 70656
    s_add_u32 s76, s46, 28672
    buffer_load_dwordx4 v32, s[24:27], s76 offen lds
    s_add_u32 m0, s37, 71680
    s_add_u32 s76, s46, 57344
    buffer_load_dwordx4 v32, s[24:27], s76 offen lds
    s_add_u32 m0, s37, 72704
    s_add_u32 s76, s46, 86016
    buffer_load_dwordx4 v32, s[24:27], s76 offen lds
    s_add_u32 m0, s37, 73728
    s_add_u32 s76, s46, 128
    buffer_load_dwordx4 v32, s[20:23], s76 offen lds
    s_add_u32 m0, s37, 74752
    s_add_u32 s76, s46, 28800
    buffer_load_dwordx4 v32, s[20:23], s76 offen lds
    s_add_u32 m0, s37, 75776
    s_add_u32 s76, s46, 57472
    buffer_load_dwordx4 v32, s[20:23], s76 offen lds
    s_add_u32 m0, s37, 76800
    s_add_u32 s76, s46, 86144
    buffer_load_dwordx4 v32, s[20:23], s76 offen lds
    s_add_u32 m0, s37, 77824
    s_add_u32 s76, s46, 128
    buffer_load_dwordx4 v32, s[24:27], s76 offen lds
    s_add_u32 m0, s37, 78848
    s_add_u32 s76, s46, 28800
    buffer_load_dwordx4 v32, s[24:27], s76 offen lds
    s_add_u32 m0, s37, 79872
    s_add_u32 s76, s46, 57472
    buffer_load_dwordx4 v32, s[24:27], s76 offen lds
    s_add_u32 m0, s37, 80896
    s_add_u32 s76, s46, 86144
    buffer_load_dwordx4 v32, s[24:27], s76 offen lds
    s_cmp_eq_u32 s71, 0
    s_cbranch_scc0 L_on_8
    s_lshl_b32 s45, s38, 7
    s_add_u32 s45, s45, s39
    s_add_u32 m0, s37, 0
    s_add_u32 s76, s45, 0
    buffer_load_dwordx4 v30, s[8:11], s76 offen lds
    s_add_u32 m0, s37, 1024
    s_add_u32 s76, s45, 1024
    buffer_load_dwordx4 v31, s[8:11], s76 offen lds
    s_add_u32 m0, s37, 2048
    s_add_u32 s76, s45, 2048
    buffer_load_dwordx4 v30, s[8:11], s76 offen lds
    s_add_u32 m0, s37, 3072
    s_add_u32 s76, s45, 3072
    buffer_load_dwordx4 v31, s[8:11], s76 offen lds
    s_add_u32 m0, s37, 4096
    s_add_u32 s76, s45, 4096
    buffer_load_dwordx4 v30, s[8:11], s76 offen lds
    s_add_u32 m0, s37, 5120
    s_add_u32 s76, s45, 5120
    buffer_load_dwordx4 v31, s[8:11], s76 offen lds
    s_add_u32 m0, s37, 6144
    s_add_u32 s76, s45, 6144
    buffer_load_dwordx4 v30, s[8:11], s76 offen lds
    s_add_u32 m0, s37, 7168
    s_add_u32 s76, s45, 7168
    buffer_load_dwordx4 v31, s[8:11], s76 offen lds
    s_add_u32 m0, s37, 8192
    s_add_u32 s76, s45, 8192
    buffer_load_dwordx4 v30, s[8:11], s76 offen lds
    s_add_u32 m0, s37, 9216
    s_add_u32 s76, s45, 9216
    buffer_load_dwordx4 v31, s[8:11], s76 offen lds
    s_add_u32 m0, s37, 10240
    s_add_u32 s76, s45, 10240
    buffer_load_dwordx4 v30, s[8:11], s76 offen lds
    s_add_u32 m0, s37, 11264
    s_add_u32 s76, s45, 11264
    buffer_load_dwordx4 v31, s[8:11], s76 offen lds
    s_add_u32 m0, s37, 12288
    s_add_u32 s76, s45, 12288
    buffer_load_dwordx4 v30, s[8:11], s76 offen lds
    s_add_u32 m0, s37, 13312
    s_add_u32 s76, s45, 13312
    buffer_load_dwordx4 v31, s[8:11], s76 offen lds
    s_add_u32 m0, s37, 14336
    s_add_u32 s76, s45, 14336
    buffer_load_dwordx4 v30, s[8:11], s76 offen lds
    s_add_u32 m0, s37, 15360
    s_add_u32 s76, s45, 15360
    buffer_load_dwordx4 v31, s[8:11], s76 offen lds
L_on_8:
    s_lshl_b32 s79, s70, 10
    s_add_u32 s79, s79, s39
    s_lshl_b32 s76, s71, 16
    s_add_u32 s79, s79, s76
    buffer_load_dwordx4 v[72:75], v2, s[8:11], s79 offen
    s_add_u32 s79, s79, 32768
    buffer_load_dwordx4 v[76:79], v2, s[8:11], s79 offen
    s_cmp_lt_u32 s71, 2
    s_cselect_b32 s4, s50, s52
    s_cselect_b32 s5, s51, s53
    s_mov_b32 s6, 1052672
    s_mov_b32 s7, 0x00020000
    s_lshl_b32 s47, s75, 2
    s_lshr_b32 s78, s74, 3
    s_add_u32 s47, s47, s78
    s_lshr_b32 s78, s47, 3
    s_lshl_b32 s78, s78, 4
    s_and_b32 s79, s47, 7
    s_lshl_b32 s79, s79, 8
    s_add_u32 s78, s78, s79
    s_lshl_b32 s79, s73, 7
    s_add_u32 s78, s78, s79
    s_mul_i32 s78, s78, 514
    s_lshl_b32 s79, s88, 6
    s_add_u32 s78, s78, s79
    v_lshrrev_b32 v16, 3, v1
    v_mul_u32_u24 v17, 514, v16
    v_add_u32 v17, 2, v17
    v_and_b32 v17, -16, v17
    v_and_b32 v18, 7, v1
    v_xor_b32 v18, v18, v16
    v_lshl_add_u32 v17, v18, 4, v17
    s_add_u32 m0, s84, 131072
    s_add_u32 s79, s78, 0
    buffer_load_dwordx4 v17, s[4:7], s79 offen nt lds
    s_add_u32 m0, s84, 132096
    s_add_u32 s79, s78, 4112
    buffer_load_dwordx4 v17, s[4:7], s79 offen nt lds
    s_add_u32 m0, s84, 133120
    s_add_u32 s79, s78, 32896
    buffer_load_dwordx4 v17, s[4:7], s79 offen nt lds
    s_add_u32 m0, s84, 134144
    s_add_u32 s79, s78, 37008
    buffer_load_dwordx4 v17, s[4:7], s79 offen nt lds
    s_waitcnt vmcnt(6)
    v_mov_b32 v27, 2
    ds_write_b32 v4, v27 offset:0
    s_add_u32 s79, s71, 0
    s_and_b32 s76, s74, 7
    s_cmp_lg_u32 s76, s79
    s_cbranch_scc1 L_nt_9
    s_mov_b32 s16, s60
    s_mov_b32 s17, s61
    s_mov_b32 s18, 1835008
    s_mov_b32 s19, 0x00020000
    v_lshlrev_b32 v44, 7, v1
    s_mul_i32 s76, s74, 57344
    s_add_u32 s77, s76, 0
    buffer_load_dword v45, v44, s[16:19], s77 offen
    s_add_u32 s77, s76, 8192
    buffer_load_dword v45, v44, s[16:19], s77 offen
    s_add_u32 s77, s76, 16384
    buffer_load_dword v45, v44, s[16:19], s77 offen
    s_add_u32 s77, s76, 24576
    buffer_load_dword v45, v44, s[16:19], s77 offen
    s_add_u32 s77, s76, 32768
    buffer_load_dword v45, v44, s[16:19], s77 offen
    s_add_u32 s77, s76, 40960
    buffer_load_dword v45, v44, s[16:19], s77 offen
    s_add_u32 s77, s76, 49152
    buffer_load_dword v45, v44, s[16:19], s77 offen
    s_lshl_b32 s76, s74, 14
L_nt_9:
    s_waitcnt vmcnt(4)
    v_lshlrev_b32 v80, 16, v72
    v_and_b32 v81, 0xffff0000, v72
    v_lshlrev_b32 v82, 16, v73
    v_and_b32 v83, 0xffff0000, v73
    v_lshlrev_b32 v84, 16, v74
    v_and_b32 v85, 0xffff0000, v74
    v_lshlrev_b32 v86, 16, v75
    v_and_b32 v87, 0xffff0000, v75
    v_lshlrev_b32 v88, 16, v76
    v_and_b32 v89, 0xffff0000, v76
    v_lshlrev_b32 v90, 16, v77
    v_and_b32 v91, 0xffff0000, v77
    v_lshlrev_b32 v92, 16, v78
    v_and_b32 v93, 0xffff0000, v78
    v_lshlrev_b32 v94, 16, v79
    v_and_b32 v95, 0xffff0000, v79
    v_add_f32 v96, v80, v81
    v_add_f32 v97, v88, v89
    v_add_f32 v96, v96, v82
    v_add_f32 v97, v97, v90
    v_add_f32 v96, v96, v83
    v_add_f32 v97, v97, v91
    v_add_f32 v96, v96, v84
    v_add_f32 v97, v97, v92
    v_add_f32 v96, v96, v85
    v_add_f32 v97, v97, v93
    v_add_f32 v96, v96, v86
    v_add_f32 v97, v97, v94
    v_add_f32 v96, v96, v87
    v_add_f32 v97, v97, v95
    s_nop 0
    v_add_f32_dpp v96, v96, v96 row_shr:1
    v_add_f32_dpp v97, v97, v97 row_shr:1
    s_nop 0
    v_add_f32_dpp v96, v96, v96 row_shr:2
    v_add_f32_dpp v97, v97, v97 row_shr:2
    s_nop 0
    v_add_f32_dpp v96, v96, v96 row_shr:4
    v_add_f32_dpp v97, v97, v97 row_shr:4
    s_nop 0
    v_add_f32_dpp v96, v96, v96 row_shr:8
    v_add_f32_dpp v97, v97, v97 row_shr:8
    s_nop 0
    v_add_f32_dpp v96, v96, v96 row_bcast:15 row_mask:0xa
    v_add_f32_dpp v97, v97, v97 row_bcast:15 row_mask:0xa
    s_nop 0
    v_add_f32_dpp v96, v96, v96 row_bcast:31 row_mask:0xc
    v_add_f32_dpp v97, v97, v97 row_bcast:31 row_mask:0xc
    v_readlane_b32 s79, v96, 63
    v_readlane_b32 s78, v97, 63
    v_mov_b32 v98, 0x3b000000
    v_mul_f32 v96, s79, v98
    v_mul_f32 v97, s78, v98
    v_sub_f32 v80, v80, v96
    v_sub_f32 v88, v88, v97
    v_sub_f32 v81, v81, v96
    v_sub_f32 v89, v89, v97
    v_sub_f32 v82, v82, v96
    v_sub_f32 v90, v90, v97
    v_sub_f32 v83, v83, v96
    v_sub_f32 v91, v91, v97
    v_sub_f32 v84, v84, v96
    v_sub_f32 v92, v92, v97
    v_sub_f32 v85, v85, v96
    v_sub_f32 v93, v93, v97
    v_sub_f32 v86, v86, v96
    v_sub_f32 v94, v94, v97
    v_sub_f32 v87, v87, v96
    v_sub_f32 v95, v95, v97
    v_mul_f32 v100, v80, v80
    v_mul_f32 v101, v88, v88
    v_fmac_f32 v100, v81, v81
    v_fmac_f32 v101, v89, v89
    v_fmac_f32 v100, v82, v82
    v_fmac_f32 v101, v90, v90
    v_fmac_f32 v100, v83, v83
    v_fmac_f32 v101, v91, v91
    v_fmac_f32 v100, v84, v84
    v_fmac_f32 v101, v92, v92
    v_fmac_f32 v100, v85, v85
    v_fmac_f32 v101, v93, v93
    v_fmac_f32 v100, v86, v86
    v_fmac_f32 v101, v94, v94
    v_fmac_f32 v100, v87, v87
    v_fmac_f32 v101, v95, v95
    s_nop 0
    v_add_f32_dpp v100, v100, v100 row_shr:1
    v_add_f32_dpp v101, v101, v101 row_shr:1
    s_nop 0
    v_add_f32_dpp v100, v100, v100 row_shr:2
    v_add_f32_dpp v101, v101, v101 row_shr:2
    s_nop 0
    v_add_f32_dpp v100, v100, v100 row_shr:4
    v_add_f32_dpp v101, v101, v101 row_shr:4
    s_nop 0
    v_add_f32_dpp v100, v100, v100 row_shr:8
    v_add_f32_dpp v101, v101, v101 row_shr:8
    s_nop 0
    v_add_f32_dpp v100, v100, v100 row_bcast:15 row_mask:0xa
    v_add_f32_dpp v101, v101, v101 row_bcast:15 row_mask:0xa
    s_nop 0
    v_add_f32_dpp v100, v100, v100 row_bcast:31 row_mask:0xc
    v_add_f32_dpp v101, v101, v101 row_bcast:31 row_mask:0xc
    v_readlane_b32 s79, v100, 63
    v_readlane_b32 s78, v101, 63
    v_cmp_eq_u32 vcc, 1, v1
    v_mov_b32 v102, s79
    v_mov_b32 v103, s78
    v_cndmask_b32 v102, v102, v103, vcc
    v_cndmask_b32 v104, v96, v97, vcc
    v_mul_f32 v102, v102, v98
    v_cvt_pk_bf16_f32 v102, v102, v102
    v_and_b32 v102, 0xffff0000, v102
    v_cvt_pk_bf16_f32 v104, v104, v104
    v_and_b32 v104, 0xffff0000, v104
    v_add_f32 v102, 0x3727c5ac, v102
    v_cvt_pk_bf16_f32 v102, v102, v102
    v_and_b32 v102, 0xffff0000, v102
    v_sqrt_f32 v102, v102
    s_nop 0
    v_cvt_pk_bf16_f32 v102, v102, v102
    v_and_b32 v102, 0xffff0000, v102
    v_rcp_f32 v105, v102
    s_lshl_b32 s79, s69, 7
    s_lshl_b32 s78, s70, 3
    s_add_u32 s79, s79, s78
    s_lshl_b32 s78, s71, 1
    s_add_u32 s79, s79, s78
    s_lshl_b32 s79, s79, 4
    s_add_u32 s79, s79, 65536
    v_mov_b32 v106, s68
    v_mov_b32 v107, s68
    s_mov_b64 exec, 3
    buffer_store_dwordx4 v[104:107], v2, s[12:15], s79 offen sc1
    s_mov_b64 exec, -1
    s_waitcnt vmcnt(1)
    v_mov_b32 v27, 1
    ds_write_b32 v4, v27 offset:48
    s_add_u32 s36, s71, 8
    s_sub_u32 s79, s36, 3
    s_add_u32 s38, s71, s44
    s_add_u32 s38, s38, 4
    s_and_b32 s38, s38, 7
    s_lshr_b32 s77, s36, 1
    s_add_u32 s77, s77, s44
    s_and_b32 s77, s77, 7
    s_lshl_b32 s78, s77, 1
    s_and_b32 s77, s36, 1
    s_add_u32 s78, s78, s77
    s_lshl_b32 s78, s78, 5
    s_mul_i32 s46, s78, 3584
    s_lshl_b32 s77, s85, 7
    s_add_u32 s46, s46, s77
    ds_read_b128 v[24:27], v3 offset:16
    s_waitcnt lgkmcnt(0)
    v_min3_u32 v24, v24, v25, v26
    v_min_u32 v24, v24, v27
    s_nop 0
    v_readfirstlane_b32 s89, v24
    s_nop 0
    s_cmp_ge_u32 s89, s79
    s_cbranch_scc1 L_bk_11
L_sl_10:
    s_mov_b32 s100, 0
L_sp_12:
    s_sleep 1
    ds_read_b128 v[24:27], v3 offset:16
    s_waitcnt lgkmcnt(0)
    v_min3_u32 v24, v24, v25, v26
    v_min_u32 v24, v24, v27
    s_nop 0
    v_readfirstlane_b32 s89, v24
    s_nop 0
    s_cmp_ge_u32 s89, s79
    s_cbranch_scc1 L_bk_11
    s_add_u32 s100, s100, 1
    s_cmp_lt_u32 s100, 8388608
    s_cbranch_scc1 L_sp_12
L_bk_11:
    s_add_u32 m0, s37, 65536
    s_add_u32 s76, s46, 0
    buffer_load_dwordx4 v32, s[20:23], s76 offen lds
    s_add_u32 m0, s37, 66560
    s_add_u32 s76, s46, 28672
    buffer_load_dwordx4 v32, s[20:23], s76 offen lds
    s_add_u32 m0, s37, 67584
    s_add_u32 s76, s46, 57344
    buffer_load_dwordx4 v32, s[20:23], s76 offen lds
    s_add_u32 m0, s37, 68608
    s_add_u32 s76, s46, 86016
    buffer_load_dwordx4 v32, s[20:23], s76 offen lds
    s_add_u32 m0, s37, 69632
    s_add_u32 s76, s46, 0
    buffer_load_dwordx4 v32, s[24:27], s76 offen lds
    s_add_u32 m0, s37, 70656
    s_add_u32 s76, s46, 28672
    buffer_load_dwordx4 v32, s[24:27], s76 offen lds
    s_add_u32 m0, s37, 71680
    s_add_u32 s76, s46, 57344
    buffer_load_dwordx4 v32, s[24:27], s76 offen lds
    s_add_u32 m0, s37, 72704
    s_add_u32 s76, s46, 86016
    buffer_load_dwordx4 v32, s[24:27], s76 offen lds
    s_add_u32 m0, s37, 73728
    s_add_u32 s76, s46, 128
    buffer_load_dwordx4 v32, s[20:23], s76 offen lds
    s_add_u32 m0, s37, 74752
    s_add_u32 s76, s46, 28800
    buffer_load_dwordx4 v32, s[20:23], s76 offen lds
    s_add_u32 m0, s37, 75776
    s_add_u32 s76, s46, 57472
    buffer_load_dwordx4 v32, s[20:23], s76 offen lds
    s_add_u32 m0, s37, 76800
    s_add_u32 s76, s46, 86144
    buffer_load_dwordx4 v32, s[20:23], s76 offen lds
    s_add_u32 m0, s37, 77824
    s_add_u32 s76, s46, 128
    buffer_load_dwordx4 v32, s[24:27], s76 offen lds
    s_add_u32 m0, s37, 78848
    s_add_u32 s76, s46, 28800
    buffer_load_dwordx4 v32, s[24:27], s76 offen lds
    s_add_u32 m0, s37, 79872
    s_add_u32 s76, s46, 57472
    buffer_load_dwordx4 v32, s[24:27], s76 offen lds
    s_add_u32 m0, s37, 80896
    s_add_u32 s76, s46, 86144
    buffer_load_dwordx4 v32, s[24:27], s76 offen lds
    s_cmp_lg_u32 s71, 0
    s_cbranch_scc0 L_on_13
    s_lshl_b32 s45, s38, 7
    s_add_u32 s45, s45, s39
    s_add_u32 m0, s37, 0
    s_add_u32 s76, s45, 0
    buffer_load_dwordx4 v30, s[8:11], s76 offen lds
    s_add_u32 m0, s37, 1024
    s_add_u32 s76, s45, 1024
    buffer_load_dwordx4 v31, s[8:11], s76 offen lds
    s_add_u32 m0, s37, 2048
    s_add_u32 s76, s45, 2048
    buffer_load_dwordx4 v30, s[8:11], s76 offen lds
    s_add_u32 m0, s37, 3072
    s_add_u32 s76, s45, 3072
    buffer_load_dwordx4 v31, s[8:11], s76 offen lds
    s_add_u32 m0, s37, 4096
    s_add_u32 s76, s45, 4096
    buffer_load_dwordx4 v30, s[8:11], s76 offen lds
    s_add_u32 m0, s37, 5120
    s_add_u32 s76, s45, 5120
    buffer_load_dwordx4 v31, s[8:11], s76 offen lds
    s_add_u32 m0, s37, 6144
    s_add_u32 s76, s45, 6144
    buffer_load_dwordx4 v30, s[8:11], s76 offen lds
    s_add_u32 m0, s37, 7168
    s_add_u32 s76, s45, 7168
    buffer_load_dwordx4 v31, s[8:11], s76 offen lds
    s_add_u32 m0, s37, 8192
    s_add_u32 s76, s45, 8192
    buffer_load_dwordx4 v30, s[8:11], s76 offen lds
    s_add_u32 m0, s37, 9216
    s_add_u32 s76, s45, 9216
    buffer_load_dwordx4 v31, s[8:11], s76 offen lds
    s_add_u32 m0, s37, 10240
    s_add_u32 s76, s45, 10240
    buffer_load_dwordx4 v30, s[8:11], s76 offen lds
    s_add_u32 m0, s37, 11264
    s_add_u32 s76, s45, 11264
    buffer_load_dwordx4 v31, s[8:11], s76 offen lds
    s_add_u32 m0, s37, 12288
    s_add_u32 s76, s45, 12288
    buffer_load_dwordx4 v30, s[8:11], s76 offen lds
    s_add_u32 m0, s37, 13312
    s_add_u32 s76, s45, 13312
    buffer_load_dwordx4 v31, s[8:11], s76 offen lds
    s_add_u32 m0, s37, 14336
    s_add_u32 s76, s45, 14336
    buffer_load_dwordx4 v30, s[8:11], s76 offen lds
    s_add_u32 m0, s37, 15360
    s_add_u32 s76, s45, 15360
    buffer_load_dwordx4 v31, s[8:11], s76 offen lds
L_on_13:
    s_waitcnt vmcnt(0)
    v_mov_b32 v27, 3
    ds_write_b32 v4, v27 offset:0
    s_add_u32 s79, s71, 4
    s_and_b32 s76, s74, 7
    s_cmp_lg_u32 s76, s79
    s_cbranch_scc1 L_nt_14
    s_mov_b32 s16, s60
    s_mov_b32 s17, s61
    s_mov_b32 s18, 1835008
    s_mov_b32 s19, 0x00020000
    v_lshlrev_b32 v44, 7, v1
    s_mul_i32 s76, s74, 57344
    s_add_u32 s77, s76, 0
    buffer_load_dword v45, v44, s[16:19], s77 offen
    s_add_u32 s77, s76, 8192
    buffer_load_dword v45, v44, s[16:19], s77 offen
    s_add_u32 s77, s76, 16384
    buffer_load_dword v45, v44, s[16:19], s77 offen
    s_add_u32 s77, s76, 24576
    buffer_load_dword v45, v44, s[16:19], s77 offen
    s_add_u32 s77, s76, 32768
    buffer_load_dword v45, v44, s[16:19], s77 offen
    s_add_u32 s77, s76, 40960
    buffer_load_dword v45, v44, s[16:19], s77 offen
    s_add_u32 s77, s76, 49152
    buffer_load_dword v45, v44, s[16:19], s77 offen
    s_lshl_b32 s76, s74, 14
L_nt_14:
    ds_read_b128 v[24:27], v3 offset:48
    s_waitcnt lgkmcnt(0)
    v_min3_u32 v24, v24, v25, v26
    v_min_u32 v24, v24, v27
    s_nop 0
    v_readfirstlane_b32 s89, v24
    s_nop 0
    s_cmp_ge_u32 s89, 1
    s_cbranch_scc1 L_bk_16
L_sl_15:
    s_mov_b32 s100, 0
L_sp_17:
    s_sleep 1
    ds_read_b128 v[24:27], v3 offset:48
    s_waitcnt lgkmcnt(0)
    v_min3_u32 v24, v24, v25, v26
    v_min_u32 v24, v24, v27
    s_nop 0
    v_readfirstlane_b32 s89, v24
    s_nop 0
    s_cmp_ge_u32 s89, 1
    s_cbranch_scc1 L_bk_16
    s_add_u32 s100, s100, 1
    s_cmp_lt_u32 s100, 8388608
    s_cbranch_scc1 L_sp_17
L_bk_16:
    v_and_b32 v16, 15, v1
    v_lshrrev_b32 v17, 4, v1
    v_lshlrev_b32 v18, 1, v16
    v_add_u32 v18, 2, v18
    v_and_b32 v18, 15, v18
    v_lshl_add_u32 v18, v17, 1, v18
    s_lshl_b32 s78, s71, 4
    v_add_u32 v18, s78, v18
    v_and_b32 v19, 7, v16
    v_lshlrev_b32 v19, 4, v19
    v_lshlrev_b32 v20, 7, v16
    v_add_u32 v20, 131072, v20
    v_xor_b32 v21, v18, v19
    v_add_u32 v21, v21, v20
    ds_read_u16 v112, v21 offset:0
    ds_read_u16 v120, v21 offset:8192
    ds_read_u16 v113, v21 offset:2048
    ds_read_u16 v121, v21 offset:10240
    ds_read_u16 v114, v21 offset:4096
    ds_read_u16 v122, v21 offset:12288
    ds_read_u16 v115, v21 offset:6144
    ds_read_u16 v123, v21 offset:14336
    v_add_u32 v18, 8, v18
    v_xor_b32 v22, v18, v19
    v_add_u32 v22, v22, v20
    ds_read_u16 v116, v22 offset:0
    ds_read_u16 v124, v22 offset:8192
    ds_read_u16 v117, v22 offset:2048
    ds_read_u16 v125, v22 offset:10240
    ds_read_u16 v118, v22 offset:4096
    ds_read_u16 v126, v22 offset:12288
    ds_read_u16 v119, v22 offset:6144
    ds_read_u16 v127, v22 offset:14336
    v_lshlrev_b32 v17, 13, v17
    v_lshl_add_u32 v17, v16, 4, v17
    s_lshl_b32 s78, s88, 18
    s_lshl_b32 s79, s71, 16
    s_add_u32 s78, s78, s79
    s_lshl_b32 s79, s47, 8
    s_add_u32 s78, s78, s79
    s_add_u32 s78, s78, 13631488
    s_add_u32 s79, s78, 32768
    s_waitcnt lgkmcnt(8)
    v_lshl_or_b32 v112, v120, 16, v112
    v_lshl_or_b32 v113, v121, 16, v113
    v_lshl_or_b32 v114, v122, 16, v114
    v_lshl_or_b32 v115, v123, 16, v115
    buffer_store_dwordx4 v[112:115], v17, s[12:15], s78 offen sc1
    s_waitcnt lgkmcnt(0)
    v_lshl_or_b32 v116, v124, 16, v116
    v_lshl_or_b32 v117, v125, 16, v117
    v_lshl_or_b32 v118, v126, 16, v118
    v_lshl_or_b32 v119, v127, 16, v119
    buffer_store_dwordx4 v[116:119], v17, s[12:15], s79 offen sc1
    s_waitcnt lgkmcnt(0)
    s_add_u32 s36, s71, 12
    s_sub_u32 s79, s36, 3
    s_add_u32 s38, s71, s44
    s_add_u32 s38, s38, 4
    s_and_b32 s38, s38, 7
    s_lshr_b32 s77, s36, 1
    s_add_u32 s77, s77, s44
    s_and_b32 s77, s77, 7
    s_lshl_b32 s78, s77, 1
    s_and_b32 s77, s36, 1
    s_add_u32 s78, s78, s77
    s_lshl_b32 s78, s78, 5
    s_mul_i32 s46, s78, 3584
    s_lshl_b32 s77, s85, 7
    s_add_u32 s46, s46, s77
    ds_read_b128 v[24:27], v3 offset:16
    s_waitcnt lgkmcnt(0)
    v_min3_u32 v24, v24, v25, v26
    v_min_u32 v24, v24, v27
    s_nop 0
    v_readfirstlane_b32 s89, v24
    s_nop 0
    s_cmp_ge_u32 s89, s79
    s_cbranch_scc1 L_bk_19
L_sl_18:
    s_mov_b32 s100, 0
L_sp_20:
    s_sleep 1
    ds_read_b128 v[24:27], v3 offset:16
    s_waitcnt lgkmcnt(0)
    v_min3_u32 v24, v24, v25, v26
    v_min_u32 v24, v24, v27
    s_nop 0
    v_readfirstlane_b32 s89, v24
    s_nop 0
    s_cmp_ge_u32 s89, s79
    s_cbranch_scc1 L_bk_19
    s_add_u32 s100, s100, 1
    s_cmp_lt_u32 s100, 8388608
    s_cbranch_scc1 L_sp_20
L_bk_19:
    s_add_u32 m0, s37, 65536
    s_add_u32 s76, s46, 0
    buffer_load_dwordx4 v32, s[20:23], s76 offen lds
    s_add_u32 m0, s37, 66560
    s_add_u32 s76, s46, 28672
    buffer_load_dwordx4 v32, s[20:23], s76 offen lds
    s_add_u32 m0, s37, 67584
    s_add_u32 s76, s46, 57344
    buffer_load_dwordx4 v32, s[20:23], s76 offen lds
    s_add_u32 m0, s37, 68608
    s_add_u32 s76, s46, 86016
    buffer_load_dwordx4 v32, s[20:23], s76 offen lds
    s_add_u32 m0, s37, 69632
    s_add_u32 s76, s46, 0
    buffer_load_dwordx4 v32, s[24:27], s76 offen lds
    s_add_u32 m0, s37, 70656
    s_add_u32 s76, s46, 28672
    buffer_load_dwordx4 v32, s[24:27], s76 offen lds
    s_add_u32 m0, s37, 71680
    s_add_u32 s76, s46, 57344
    buffer_load_dwordx4 v32, s[24:27], s76 offen lds
    s_add_u32 m0, s37, 72704
    s_add_u32 s76, s46, 86016
    buffer_load_dwordx4 v32, s[24:27], s76 offen lds
    s_add_u32 m0, s37, 73728
    s_add_u32 s76, s46, 128
    buffer_load_dwordx4 v32, s[20:23], s76 offen lds
    s_add_u32 m0, s37, 74752
    s_add_u32 s76, s46, 28800
    buffer_load_dwordx4 v32, s[20:23], s76 offen lds
    s_add_u32 m0, s37, 75776
    s_add_u32 s76, s46, 57472
    buffer_load_dwordx4 v32, s[20:23], s76 offen lds
    s_add_u32 m0, s37, 76800
    s_add_u32 s76, s46, 86144
    buffer_load_dwordx4 v32, s[20:23], s76 offen lds
    s_add_u32 m0, s37, 77824
    s_add_u32 s76, s46, 128
    buffer_load_dwordx4 v32, s[24:27], s76 offen lds
    s_add_u32 m0, s37, 78848
    s_add_u32 s76, s46, 28800
    buffer_load_dwordx4 v32, s[24:27], s76 offen lds
    s_add_u32 m0, s37, 79872
    s_add_u32 s76, s46, 57472
    buffer_load_dwordx4 v32, s[24:27], s76 offen lds
    s_add_u32 m0, s37, 80896
    s_add_u32 s76, s46, 86144
    buffer_load_dwordx4 v32, s[24:27], s76 offen lds
    s_waitcnt vmcnt(0)
    v_mov_b32 v27, 4
    ds_write_b32 v4, v27 offset:0
    ds_read_b128 v[24:27], v3 offset:0
    s_waitcnt lgkmcnt(0)
    v_min3_u32 v24, v24, v25, v26
    v_min_u32 v24, v24, v27
    s_nop 0
    v_readfirstlane_b32 s89, v24
    s_nop 0
    s_cmp_ge_u32 s89, 4
    s_cbranch_scc1 L_bk_22
L_sl_21:
    s_mov_b32 s100, 0
L_sp_23:
    s_sleep 1
    ds_read_b128 v[24:27], v3 offset:0
    s_waitcnt lgkmcnt(0)
    v_min3_u32 v24, v24, v25, v26
    v_min_u32 v24, v24, v27
    s_nop 0
    v_readfirstlane_b32 s89, v24
    s_nop 0
    s_cmp_ge_u32 s89, 4
    s_cbranch_scc1 L_bk_22
    s_add_u32 s100, s100, 1
    s_cmp_lt_u32 s100, 8388608
    s_cbranch_scc1 L_sp_23
L_bk_22:
    buffer_load_dwordx4 v[64:67], v37, s[12:15], s32 offen sc1
    buffer_load_dwordx2 v[68:69], v38, s[12:15], s33 offen offset:0 sc1
    buffer_load_dwordx2 v[70:71], v38, s[12:15], s33 offen offset:512 sc1
    buffer_load_dwordx2 v[72:73], v38, s[12:15], s33 offen offset:1024 sc1
    buffer_load_dwordx2 v[74:75], v38, s[12:15], s33 offen offset:1536 sc1
    buffer_load_dwordx2 v[76:77], v38, s[12:15], s33 offen offset:2048 sc1
    buffer_load_dwordx2 v[78:79], v38, s[12:15], s33 offen offset:2560 sc1
    buffer_load_dwordx2 v[80:81], v38, s[12:15], s33 offen offset:3072 sc1
    buffer_load_dwordx2 v[82:83], v38, s[12:15], s33 offen offset:3584 sc1
    s_add_u32 s76, s84, 524288
    s_mov_b32 s77, 540672
    buffer_load_dwordx4 v[128:131], v2, s[40:43], s76 offen offset:0
    buffer_load_dwordx4 v[136:139], v2, s[40:43], s76 offen offset:2048
    buffer_load_dwordx4 v[152:155], v2, s[40:43], s77 offen offset:0
    buffer_load_dwordx4 v[160:163], v2, s[40:43], s77 offen offset:2048
    buffer_load_dwordx4 v[132:135], v2, s[40:43], s76 offen offset:1024
    buffer_load_dwordx4 v[140:143], v2, s[40:43], s76 offen offset:3072
    buffer_load_dwordx4 v[156:159], v2, s[40:43], s77 offen offset:1024
    buffer_load_dwordx4 v[164:167], v2, s[40:43], s77 offen offset:3072
    s_waitcnt vmcnt(16)
    v_xor_b32 v8, s68, v66
    v_xor_b32 v9, s68, v67
    v_or_b32 v8, v8, v9
    v_cmp_ne_u32 vcc, 0, v8
    s_nop 4
    s_cbranch_vccz L_back_25
L_slow_24:
    s_mov_b32 s89, 0
L_spin_26:
    s_sleep 6
    buffer_load_dwordx4 v[64:67], v37, s[12:15], s32 offen sc1
    s_waitcnt vmcnt(0)
    v_xor_b32 v8, s68, v66
    v_xor_b32 v9, s68, v67
    v_or_b32 v8, v8, v9
    v_cmp_ne_u32 vcc, 0, v8
    s_nop 4
    s_cbranch_vccz L_back_25
    s_add_u32 s89, s89, 1
    s_cmp_lt_u32 s89, 1048576
    s_cbranch_scc1 L_spin_26
L_back_25:
    v_lshlrev_b32 v8, 3, v36
    v_add_u32 v8, 159744, v8
    ds_write_b64 v8, v[64:65]
    v_lshlrev_b32 v9, 2, v36
    v_add_u32 v9, 160768, v9
    ds_write_b32 v9, v65
    s_waitcnt vmcnt(8)
    v_xor_b32 v8, s68, v69
    v_xor_b32 v9, s68, v71
    v_or_b32 v8, v8, v9
    v_xor_b32 v9, s68, v73
    v_or_b32 v8, v8, v9
    v_xor_b32 v9, s68, v75
    v_or_b32 v8, v8, v9
    v_xor_b32 v9, s68, v77
    v_or_b32 v8, v8, v9
    v_xor_b32 v9, s68, v79
    v_or_b32 v8, v8, v9
    v_xor_b32 v9, s68, v81
    v_or_b32 v8, v8, v9
    v_xor_b32 v9, s68, v83
    v_or_b32 v8, v8, v9
    v_cmp_ne_u32 vcc, 0, v8
    s_nop 4
    s_cbranch_vccz L_back_28
L_slow_27:
    s_mov_b32 s89, 0
L_spin_29:
    s_sleep 6
    buffer_load_dwordx2 v[68:69], v38, s[12:15], s33 offen offset:0 sc1
    buffer_load_dwordx2 v[70:71], v38, s[12:15], s33 offen offset:512 sc1
    buffer_load_dwordx2 v[72:73], v38, s[12:15], s33 offen offset:1024 sc1
    buffer_load_dwordx2 v[74:75], v38, s[12:15], s33 offen offset:1536 sc1
    buffer_load_dwordx2 v[76:77], v38, s[12:15], s33 offen offset:2048 sc1
    buffer_load_dwordx2 v[78:79], v38, s[12:15], s33 offen offset:2560 sc1
    buffer_load_dwordx2 v[80:81], v38, s[12:15], s33 offen offset:3072 sc1
    buffer_load_dwordx2 v[82:83], v38, s[12:15], s33 offen offset:3584 sc1
    s_waitcnt vmcnt(0)
    v_xor_b32 v8, s68, v69
    v_xor_b32 v9, s68, v71
    v_or_b32 v8, v8, v9
    v_xor_b32 v9, s68, v73
    v_or_b32 v8, v8, v9
    v_xor_b32 v9, s68, v75
    v_or_b32 v8, v8, v9
    v_xor_b32 v9, s68, v77
    v_or_b32 v8, v8, v9
    v_xor_b32 v9, s68, v79
    v_or_b32 v8, v8, v9
    v_xor_b32 v9, s68, v81
    v_or_b32 v8, v8, v9
    v_xor_b32 v9, s68, v83
    v_or_b32 v8, v8, v9
    v_cmp_ne_u32 vcc, 0, v8
    s_nop 4
    s_cbranch_vccz L_back_28
    s_add_u32 s89, s89, 1
    s_cmp_lt_u32 s89, 1048576
    s_cbranch_scc1 L_spin_29
L_back_28:
    v_add_f32 v68, v68, v70
    v_add_f32 v72, v72, v74
    v_add_f32 v76, v76, v78
    v_add_f32 v80, v80, v82
    v_add_f32 v68, v68, v72
    v_add_f32 v76, v76, v80
    v_add_f32 v68, v68, v76
    v_lshlrev_b32 v10, 2, v39
    v_add_u32 v10, 161792, v10
    ds_write_b32 v10, v68
    s_waitcnt lgkmcnt(0)
    v_mov_b32 v27, 2
    ds_write_b32 v4, v27 offset:32
    s_lshl_b32 s77, s88, 5
    s_add_u32 s77, s77, s47
    v_mov_b32 v24, 1
    s_mov_b64 exec, 1
    ds_add_rtn_u32 v25, v3, v24 offset:72
    s_mov_b64 exec, -1
    s_waitcnt lgkmcnt(0)
    v_readfirstlane_b32 s78, v25
    s_nop 0
    s_cmp_lg_u32 s78, 3
    s_cbranch_scc1 L_nl_30
    s_lshl_b32 s78, s77, 7
    s_add_u32 s78, s78, 458752
    v_mov_b32 v28, s68
    v_mov_b32 v29, 0
    s_mov_b64 exec, 1
    buffer_store_dword v28, v29, s[12:15], s78 offen sc1
    s_mov_b64 exec, -1
L_nl_30:
    s_branch L_h_join
L_h_dft:
    s_mov_b32 s39, s80
    s_lshl_b32 s37, s71, 14
    s_cmp_lt_u32 s71, 2
    s_cbranch_scc0 L_on_32
    s_lshl_b32 s45, s44, 7
    s_add_u32 s45, s45, s39
    s_lshl_b32 s79, s71, 13
    s_add_u32 s45, s45, s79
    s_add_u32 m0, s79, 0
    s_add_u32 s76, s45, 0
    buffer_load_dwordx4 v30, s[8:11], s76 offen lds
    s_add_u32 m0, s79, 1024
    s_add_u32 s76, s45, 1024
    buffer_load_dwordx4 v31, s[8:11], s76 offen lds
    s_add_u32 m0, s79, 2048
    s_add_u32 s76, s45, 2048
    buffer_load_dwordx4 v30, s[8:11], s76 offen lds
    s_add_u32 m0, s79, 3072
    s_add_u32 s76, s45, 3072
    buffer_load_dwordx4 v31, s[8:11], s76 offen lds
    s_add_u32 m0, s79, 4096
    s_add_u32 s76, s45, 4096
    buffer_load_dwordx4 v30, s[8:11], s76 offen lds
    s_add_u32 m0, s79, 5120
    s_add_u32 s76, s45, 5120
    buffer_load_dwordx4 v31, s[8:11], s76 offen lds
    s_add_u32 m0, s79, 6144
    s_add_u32 s76, s45, 6144
    buffer_load_dwordx4 v30, s[8:11], s76 offen lds
    s_add_u32 m0, s79, 7168
    s_add_u32 s76, s45, 7168
    buffer_load_dwordx4 v31, s[8:11], s76 offen lds
    s_lshl_b32 s78, s44, 2
    s_add_u32 s78, s78, s71
    s_lshl_b32 s78, s78, 4
    s_mul_i32 s46, s78, 3584
    s_lshl_b32 s77, s85, 7
    s_add_u32 s46, s46, s77
    s_lshl_b32 s82, s78, 10
    s_lshl_b32 s77, s70, 8
    s_add_u32 s82, s82, s77
    s_lshl_b32 s78, s71, 11
    s_add_u32 m0, s78, 65536
    s_add_u32 s76, s82, 0
    buffer_load_dwordx4 v33, s[40:43], s76 offen lds
    s_add_u32 m0, s78, 66560
    s_add_u32 s76, s82, 8192
    buffer_load_dwordx4 v33, s[40:43], s76 offen lds
    s_add_u32 m0, s78, 69632
    s_add_u32 s76, s82, 128
    buffer_load_dwordx4 v33, s[40:43], s76 offen lds
    s_add_u32 m0, s78, 70656
    s_add_u32 s76, s82, 8320
    buffer_load_dwordx4 v33, s[40:43], s76 offen lds
    s_add_u32 m0, s78, 73728
    s_add_u32 s76, s46, 0
    buffer_load_dwordx4 v32, s[20:23], s76 offen lds
    s_add_u32 m0, s78, 74752
    s_add_u32 s76, s46, 28672
    buffer_load_dwordx4 v32, s[20:23], s76 offen lds
    s_add_u32 m0, s78, 77824
    s_add_u32 s76, s46, 0
    buffer_load_dwordx4 v32, s[24:27], s76 offen lds
    s_add_u32 m0, s78, 78848
    s_add_u32 s76, s46, 28672
    buffer_load_dwordx4 v32, s[24:27], s76 offen lds
    s_add_u32 m0, s78, 81920
    s_add_u32 s76, s82, 32768
    buffer_load_dwordx4 v33, s[40:43], s76 offen lds
    s_add_u32 m0, s78, 82944
    s_add_u32 s76, s82, 40960
    buffer_load_dwordx4 v33, s[40:43], s76 offen lds
    s_add_u32 m0, s78, 86016
    s_add_u32 s76, s82, 32896
    buffer_load_dwordx4 v33, s[40:43], s76 offen lds
    s_add_u32 m0, s78, 87040
    s_add_u32 s76, s82, 41088
    buffer_load_dwordx4 v33, s[40:43], s76 offen lds
    s_add_u32 m0, s78, 90112
    s_add_u32 s76, s46, 114688
    buffer_load_dwordx4 v32, s[20:23], s76 offen lds
    s_add_u32 m0, s78, 91136
    s_add_u32 s76, s46, 143360
    buffer_load_dwordx4 v32, s[20:23], s76 offen lds
    s_add_u32 m0, s78, 94208
    s_add_u32 s76, s46, 114688
    buffer_load_dwordx4 v32, s[24:27], s76 offen lds
    s_add_u32 m0, s78, 95232
    s_add_u32 s76, s46, 143360
    buffer_load_dwordx4 v32, s[24:27], s76 offen lds
    s_waitcnt vmcnt(8)
    v_mov_b32 v27, 1
    ds_write_b32 v4, v27 offset:96
    s_waitcnt vmcnt(0)
    v_mov_b32 v27, 2
    ds_write_b32 v4, v27 offset:96
    s_cmp_eq_u32 s71, 1
    s_cbranch_scc0 L_on_33
    s_add_u32 s38, s44, 3
    s_and_b32 s38, s38, 7
    s_mov_b32 s37, 49152
    s_lshl_b32 s45, s38, 7
    s_add_u32 s45, s45, s39
    s_add_u32 m0, s37, 0
    s_add_u32 s76, s45, 0
    buffer_load_dwordx4 v30, s[8:11], s76 offen lds
    s_add_u32 m0, s37, 1024
    s_add_u32 s76, s45, 1024
    buffer_load_dwordx4 v31, s[8:11], s76 offen lds
    s_add_u32 m0, s37, 2048
    s_add_u32 s76, s45, 2048
    buffer_load_dwordx4 v30, s[8:11], s76 offen lds
    s_add_u32 m0, s37, 3072
    s_add_u32 s76, s45, 3072
    buffer_load_dwordx4 v31, s[8:11], s76 offen lds
    s_add_u32 m0, s37, 4096
    s_add_u32 s76, s45, 4096
    buffer_load_dwordx4 v30, s[8:11], s76 offen lds
    s_add_u32 m0, s37, 5120
    s_add_u32 s76, s45, 5120
    buffer_load_dwordx4 v31, s[8:11], s76 offen lds
    s_add_u32 m0, s37, 6144
    s_add_u32 s76, s45, 6144
    buffer_load_dwordx4 v30, s[8:11], s76 offen lds
    s_add_u32 m0, s37, 7168
    s_add_u32 s76, s45, 7168
    buffer_load_dwordx4 v31, s[8:11], s76 offen lds
    s_add_u32 m0, s37, 8192
    s_add_u32 s76, s45, 8192
    buffer_load_dwordx4 v30, s[8:11], s76 offen lds
    s_add_u32 m0, s37, 9216
    s_add_u32 s76, s45, 9216
    buffer_load_dwordx4 v31, s[8:11], s76 offen lds
    s_add_u32 m0, s37, 10240
    s_add_u32 s76, s45, 10240
    buffer_load_dwordx4 v30, s[8:11], s76 offen lds
    s_add_u32 m0, s37, 11264
    s_add_u32 s76, s45, 11264
    buffer_load_dwordx4 v31, s[8:11], s76 offen lds
    s_add_u32 m0, s37, 12288
    s_add_u32 s76, s45, 12288
    buffer_load_dwordx4 v30, s[8:11], s76 offen lds
    s_add_u32 m0, s37, 13312
    s_add_u32 s76, s45, 13312
    buffer_load_dwordx4 v31, s[8:11], s76 offen lds
    s_add_u32 m0, s37, 14336
    s_add_u32 s76, s45, 14336
    buffer_load_dwordx4 v30, s[8:11], s76 offen lds
    s_add_u32 m0, s37, 15360
    s_add_u32 s76, s45, 15360
    buffer_load_dwordx4 v31, s[8:11], s76 offen lds
    s_lshl_b32 s37, s71, 14
L_on_33:
    s_branch L_r0j_31
L_on_32:
    s_mov_b32 s36, s71
    s_lshr_b32 s77, s36, 1
    s_add_u32 s77, s77, s44
    s_and_b32 s77, s77, 7
    s_lshl_b32 s78, s77, 1
    s_and_b32 s77, s36, 1
    s_add_u32 s78, s78, s77
    s_lshl_b32 s78, s78, 5
    s_mul_i32 s46, s78, 3584
    s_lshl_b32 s77, s85, 7
    s_add_u32 s46, s46, s77
    s_lshl_b32 s82, s78, 10
    s_lshl_b32 s77, s70, 8
    s_add_u32 s82, s82, s77
    s_cmp_eq_u32 s71, 2
    s_cbranch_scc0 L_on_34
    s_add_u32 s38, s44, 1
    s_and_b32 s38, s38, 7
    s_mov_b32 s37, 16384
    s_lshl_b32 s45, s38, 7
    s_add_u32 s45, s45, s39
    s_add_u32 m0, s37, 0
    s_add_u32 s76, s45, 0
    buffer_load_dwordx4 v30, s[8:11], s76 offen lds
    s_add_u32 m0, s37, 1024
    s_add_u32 s76, s45, 1024
    buffer_load_dwordx4 v31, s[8:11], s76 offen lds
    s_add_u32 m0, s37, 2048
    s_add_u32 s76, s45, 2048
    buffer_load_dwordx4 v30, s[8:11], s76 offen lds
    s_add_u32 m0, s37, 3072
    s_add_u32 s76, s45, 3072
    buffer_load_dwordx4 v31, s[8:11], s76 offen lds
    s_add_u32 m0, s37, 4096
    s_add_u32 s76, s45, 4096
    buffer_load_dwordx4 v30, s[8:11], s76 offen lds
    s_add_u32 m0, s37, 5120
    s_add_u32 s76, s45, 5120
    buffer_load_dwordx4 v31, s[8:11], s76 offen lds
    s_add_u32 m0, s37, 6144
    s_add_u32 s76, s45, 6144
    buffer_load_dwordx4 v30, s[8:11], s76 offen lds
    s_add_u32 m0, s37, 7168
    s_add_u32 s76, s45, 7168
    buffer_load_dwordx4 v31, s[8:11], s76 offen lds
    s_add_u32 m0, s37, 8192
    s_add_u32 s76, s45, 8192
    buffer_load_dwordx4 v30, s[8:11], s76 offen lds
    s_add_u32 m0, s37, 9216
    s_add_u32 s76, s45, 9216
    buffer_load_dwordx4 v31, s[8:11], s76 offen lds
    s_add_u32 m0, s37, 10240
    s_add_u32 s76, s45, 10240
    buffer_load_dwordx4 v30, s[8:11], s76 offen lds
    s_add_u32 m0, s37, 11264
    s_add_u32 s76, s45, 11264
    buffer_load_dwordx4 v31, s[8:11], s76 offen lds
    s_add_u32 m0, s37, 12288
    s_add_u32 s76, s45, 12288
    buffer_load_dwordx4 v30, s[8:11], s76 offen lds
    s_add_u32 m0, s37, 13312
    s_add_u32 s76, s45, 13312
    buffer_load_dwordx4 v31, s[8:11], s76 offen lds
    s_add_u32 m0, s37, 14336
    s_add_u32 s76, s45, 14336
    buffer_load_dwordx4 v30, s[8:11], s76 offen lds
    s_add_u32 m0, s37, 15360
    s_add_u32 s76, s45, 15360
    buffer_load_dwordx4 v31, s[8:11], s76 offen lds
    s_lshl_b32 s37, s71, 14
    s_add_u32 m0, s37, 65536
    s_add_u32 s76, s82, 0
    buffer_load_dwordx4 v33, s[40:43], s76 offen lds
    s_add_u32 m0, s37, 66560
    s_add_u32 s76, s82, 8192
    buffer_load_dwordx4 v33, s[40:43], s76 offen lds
    s_add_u32 m0, s37, 67584
    s_add_u32 s76, s82, 16384
    buffer_load_dwordx4 v33, s[40:43], s76 offen lds
    s_add_u32 m0, s37, 68608
    s_add_u32 s76, s82, 24576
    buffer_load_dwordx4 v33, s[40:43], s76 offen lds
    s_add_u32 m0, s37, 69632
    s_add_u32 s76, s82, 128
    buffer_load_dwordx4 v33, s[40:43], s76 offen lds
    s_add_u32 m0, s37, 70656
    s_add_u32 s76, s82, 8320
    buffer_load_dwordx4 v33, s[40:43], s76 offen lds
    s_add_u32 m0, s37, 71680
    s_add_u32 s76, s82, 16512
    buffer_load_dwordx4 v33, s[40:43], s76 offen lds
    s_add_u32 m0, s37, 72704
    s_add_u32 s76, s82, 24704
    buffer_load_dwordx4 v33, s[40:43], s76 offen lds
    s_add_u32 m0, s37, 73728
    s_add_u32 s76, s46, 0
    buffer_load_dwordx4 v32, s[20:23], s76 offen lds
    s_add_u32 m0, s37, 74752
    s_add_u32 s76, s46, 28672
    buffer_load_dwordx4 v32, s[20:23], s76 offen lds
    s_add_u32 m0, s37, 75776
    s_add_u32 s76, s46, 57344
    buffer_load_dwordx4 v32, s[20:23], s76 offen lds
    s_add_u32 m0, s37, 76800
    s_add_u32 s76, s46, 86016
    buffer_load_dwordx4 v32, s[20:23], s76 offen lds
    s_add_u32 m0, s37, 77824
    s_add_u32 s76, s46, 0
    buffer_load_dwordx4 v32, s[24:27], s76 offen lds
    s_add_u32 m0, s37, 78848
    s_add_u32 s76, s46, 28672
    buffer_load_dwordx4 v32, s[24:27], s76 offen lds
    s_add_u32 m0, s37, 79872
    s_add_u32 s76, s46, 57344
    buffer_load_dwordx4 v32, s[24:27], s76 offen lds
    s_add_u32 m0, s37, 80896
    s_add_u32 s76, s46, 86016
    buffer_load_dwordx4 v32, s[24:27], s76 offen lds
    s_branch L_r0j_31
L_on_34:
    s_add_u32 m0, s37, 65536
    s_add_u32 s76, s82, 0
    buffer_load_dwordx4 v33, s[40:43], s76 offen lds
    s_add_u32 m0, s37, 66560
    s_add_u32 s76, s82, 8192
    buffer_load_dwordx4 v33, s[40:43], s76 offen lds
    s_add_u32 m0, s37, 67584
    s_add_u32 s76, s82, 16384
    buffer_load_dwordx4 v33, s[40:43], s76 offen lds
    s_add_u32 m0, s37, 68608
    s_add_u32 s76, s82, 24576
    buffer_load_dwordx4 v33, s[40:43], s76 offen lds
    s_add_u32 m0, s37, 69632
    s_add_u32 s76, s82, 128
    buffer_load_dwordx4 v33, s[40:43], s76 offen lds
    s_add_u32 m0, s37, 70656
    s_add_u32 s76, s82, 8320
    buffer_load_dwordx4 v33, s[40:43], s76 offen lds
    s_add_u32 m0, s37, 71680
    s_add_u32 s76, s82, 16512
    buffer_load_dwordx4 v33, s[40:43], s76 offen lds
    s_add_u32 m0, s37, 72704
    s_add_u32 s76, s82, 24704
    buffer_load_dwordx4 v33, s[40:43], s76 offen lds
    s_add_u32 m0, s37, 73728
    s_add_u32 s76, s46, 0
    buffer_load_dwordx4 v32, s[20:23], s76 offen lds
    s_add_u32 m0, s37, 74752
    s_add_u32 s76, s46, 28672
    buffer_load_dwordx4 v32, s[20:23], s76 offen lds
    s_add_u32 m0, s37, 75776
    s_add_u32 s76, s46, 57344
    buffer_load_dwordx4 v32, s[20:23], s76 offen lds
    s_add_u32 m0, s37, 76800
    s_add_u32 s76, s46, 86016
    buffer_load_dwordx4 v32, s[20:23], s76 offen lds
    s_add_u32 m0, s37, 77824
    s_add_u32 s76, s46, 0
    buffer_load_dwordx4 v32, s[24:27], s76 offen lds
    s_add_u32 m0, s37, 78848
    s_add_u32 s76, s46, 28672
    buffer_load_dwordx4 v32, s[24:27], s76 offen lds
    s_add_u32 m0, s37, 79872
    s_add_u32 s76, s46, 57344
    buffer_load_dwordx4 v32, s[24:27], s76 offen lds
    s_add_u32 m0, s37, 80896
    s_add_u32 s76, s46, 86016
    buffer_load_dwordx4 v32, s[24:27], s76 offen lds
    s_add_u32 s38, s44, 2
    s_and_b32 s38, s38, 7
    s_mov_b32 s37, 32768
    s_lshl_b32 s45, s38, 7
    s_add_u32 s45, s45, s39
    s_add_u32 m0, s37, 0
    s_add_u32 s76, s45, 0
    buffer_load_dwordx4 v30, s[8:11], s76 offen lds
    s_add_u32 m0, s37, 1024
    s_add_u32 s76, s45, 1024
    buffer_load_dwordx4 v31, s[8:11], s76 offen lds
    s_add_u32 m0, s37, 2048
    s_add_u32 s76, s45, 2048
    buffer_load_dwordx4 v30, s[8:11], s76 offen lds
    s_add_u32 m0, s37, 3072
    s_add_u32 s76, s45, 3072
    buffer_load_dwordx4 v31, s[8:11], s76 offen lds
    s_add_u32 m0, s37, 4096
    s_add_u32 s76, s45, 4096
    buffer_load_dwordx4 v30, s[8:11], s76 offen lds
    s_add_u32 m0, s37, 5120
    s_add_u32 s76, s45, 5120
    buffer_load_dwordx4 v31, s[8:11], s76 offen lds
    s_add_u32 m0, s37, 6144
    s_add_u32 s76, s45, 6144
    buffer_load_dwordx4 v30, s[8:11], s76 offen lds
    s_add_u32 m0, s37, 7168
    s_add_u32 s76, s45, 7168
    buffer_load_dwordx4 v31, s[8:11], s76 offen lds
    s_add_u32 m0, s37, 8192
    s_add_u32 s76, s45, 8192
    buffer_load_dwordx4 v30, s[8:11], s76 offen lds
    s_add_u32 m0, s37, 9216
    s_add_u32 s76, s45, 9216
    buffer_load_dwordx4 v31, s[8:11], s76 offen lds
    s_add_u32 m0, s37, 10240
    s_add_u32 s76, s45, 10240
    buffer_load_dwordx4 v30, s[8:11], s76 offen lds
    s_add_u32 m0, s37, 11264
    s_add_u32 s76, s45, 11264
    buffer_load_dwordx4 v31, s[8:11], s76 offen lds
    s_add_u32 m0, s37, 12288
    s_add_u32 s76, s45, 12288
    buffer_load_dwordx4 v30, s[8:11], s76 offen lds
    s_add_u32 m0, s37, 13312
    s_add_u32 s76, s45, 13312
    buffer_load_dwordx4 v31, s[8:11], s76 offen lds
    s_add_u32 m0, s37, 14336
    s_add_u32 s76, s45, 14336
    buffer_load_dwordx4 v30, s[8:11], s76 offen lds
    s_add_u32 m0, s37, 15360
    s_add_u32 s76, s45, 15360
    buffer_load_dwordx4 v31, s[8:11], s76 offen lds
    s_lshl_b32 s37, s71, 14
    s_waitcnt vmcnt(16)
    v_mov_b32 v27, 1
    ds_write_b32 v4, v27 offset:0
L_r0j_31:
    s_waitcnt vmcnt(0)
    v_mov_b32 v27, 1
    ds_write_b32 v4, v27 offset:0
    v_mov_b32 v27, 1
    ds_write_b32 v4, v27 offset:112
    s_lshl_b32 s76, s71, 6
    v_add_u32 v39, s76, v1
    v_and_b32 v36, 127, v39
    v_lshlrev_b32 v37, 4, v36
    s_lshl_b32 s32, s69, 11
    s_add_u32 s32, s32, 65536
    s_cmp_eq_u32 s72, 0
    s_cselect_b32 s33, s85, s86
    s_lshl_b32 s33, s33, 1
    s_add_u32 s33, s33, s73
    s_lshl_b32 s33, s33, 12
    s_add_u32 s33, s33, 131072
    v_lshlrev_b32 v38, 3, v1
    s_waitcnt lgkmcnt(0)
    s_add_u32 s68, s68, 1
    s_add_u32 s36, s71, 4
    s_sub_u32 s79, s36, 3
    s_add_u32 s38, s71, s44
    s_add_u32 s38, s38, 4
    s_max_u32 s79, s79, 2
    s_and_b32 s38, s38, 7
    s_lshr_b32 s77, s36, 1
    s_add_u32 s77, s77, s44
    s_and_b32 s77, s77, 7
    s_lshl_b32 s78, s77, 1
    s_and_b32 s77, s36, 1
    s_add_u32 s78, s78, s77
    s_lshl_b32 s78, s78, 5
    s_mul_i32 s46, s78, 3584
    s_lshl_b32 s77, s85, 7
    s_add_u32 s46, s46, s77
    s_lshl_b32 s82, s78, 10
    s_lshl_b32 s77, s70, 8
    s_add_u32 s82, s82, s77
    ds_read_b128 v[24:27], v3 offset:16
    s_waitcnt lgkmcnt(0)
    v_min3_u32 v24, v24, v25, v26
    v_min_u32 v24, v24, v27
    s_nop 0
    v_readfirstlane_b32 s89, v24
    s_nop 0
    s_cmp_ge_u32 s89, s79
    s_cbranch_scc1 L_bk_36
L_sl_35:
    s_mov_b32 s100, 0
L_sp_37:
    s_sleep 1
    ds_read_b128 v[24:27], v3 offset:16
    s_waitcnt lgkmcnt(0)
    v_min3_u32 v24, v24, v25, v26
    v_min_u32 v24, v24, v27
    s_nop 0
    v_readfirstlane_b32 s89, v24
    s_nop 0
    s_cmp_ge_u32 s89, s79
    s_cbranch_scc1 L_bk_36
    s_add_u32 s100, s100, 1
    s_cmp_lt_u32 s100, 8388608
    s_cbranch_scc1 L_sp_37
L_bk_36:
    s_add_u32 m0, s37, 65536
    s_add_u32 s76, s82, 0
    buffer_load_dwordx4 v33, s[40:43], s76 offen lds
    s_add_u32 m0, s37, 66560
    s_add_u32 s76, s82, 8192
    buffer_load_dwordx4 v33, s[40:43], s76 offen lds
    s_add_u32 m0, s37, 67584
    s_add_u32 s76, s82, 16384
    buffer_load_dwordx4 v33, s[40:43], s76 offen lds
    s_add_u32 m0, s37, 68608
    s_add_u32 s76, s82, 24576
    buffer_load_dwordx4 v33, s[40:43], s76 offen lds
    s_add_u32 m0, s37, 69632
    s_add_u32 s76, s82, 128
    buffer_load_dwordx4 v33, s[40:43], s76 offen lds
    s_add_u32 m0, s37, 70656
    s_add_u32 s76, s82, 8320
    buffer_load_dwordx4 v33, s[40:43], s76 offen lds
    s_add_u32 m0, s37, 71680
    s_add_u32 s76, s82, 16512
    buffer_load_dwordx4 v33, s[40:43], s76 offen lds
    s_add_u32 m0, s37, 72704
    s_add_u32 s76, s82, 24704
    buffer_load_dwordx4 v33, s[40:43], s76 offen lds
    s_add_u32 m0, s37, 73728
    s_add_u32 s76, s46, 0
    buffer_load_dwordx4 v32, s[20:23], s76 offen lds
    s_add_u32 m0, s37, 74752
    s_add_u32 s76, s46, 28672
    buffer_load_dwordx4 v32, s[20:23], s76 offen lds
    s_add_u32 m0, s37, 75776
    s_add_u32 s76, s46, 57344
    buffer_load_dwordx4 v32, s[20:23], s76 offen lds
    s_add_u32 m0, s37, 76800
    s_add_u32 s76, s46, 86016
    buffer_load_dwordx4 v32, s[20:23], s76 offen lds
    s_add_u32 m0, s37, 77824
    s_add_u32 s76, s46, 0
    buffer_load_dwordx4 v32, s[24:27], s76 offen lds
    s_add_u32 m0, s37, 78848
    s_add_u32 s76, s46, 28672
    buffer_load_dwordx4 v32, s[24:27], s76 offen lds
    s_add_u32 m0, s37, 79872
    s_add_u32 s76, s46, 57344
    buffer_load_dwordx4 v32, s[24:27], s76 offen lds
    s_add_u32 m0, s37, 80896
    s_add_u32 s76, s46, 86016
    buffer_load_dwordx4 v32, s[24:27], s76 offen lds
    s_cmp_eq_u32 s71, 0
    s_cbranch_scc0 L_on_38
    s_lshl_b32 s45, s38, 7
    s_add_u32 s45, s45, s39
    s_add_u32 m0, s37, 0
    s_add_u32 s76, s45, 0
    buffer_load_dwordx4 v30, s[8:11], s76 offen lds
    s_add_u32 m0, s37, 1024
    s_add_u32 s76, s45, 1024
    buffer_load_dwordx4 v31, s[8:11], s76 offen lds
    s_add_u32 m0, s37, 2048
    s_add_u32 s76, s45, 2048
    buffer_load_dwordx4 v30, s[8:11], s76 offen lds
    s_add_u32 m0, s37, 3072
    s_add_u32 s76, s45, 3072
    buffer_load_dwordx4 v31, s[8:11], s76 offen lds
    s_add_u32 m0, s37, 4096
    s_add_u32 s76, s45, 4096
    buffer_load_dwordx4 v30, s[8:11], s76 offen lds
    s_add_u32 m0, s37, 5120
    s_add_u32 s76, s45, 5120
    buffer_load_dwordx4 v31, s[8:11], s76 offen lds
    s_add_u32 m0, s37, 6144
    s_add_u32 s76, s45, 6144
    buffer_load_dwordx4 v30, s[8:11], s76 offen lds
    s_add_u32 m0, s37, 7168
    s_add_u32 s76, s45, 7168
    buffer_load_dwordx4 v31, s[8:11], s76 offen lds
    s_add_u32 m0, s37, 8192
    s_add_u32 s76, s45, 8192
    buffer_load_dwordx4 v30, s[8:11], s76 offen lds
    s_add_u32 m0, s37, 9216
    s_add_u32 s76, s45, 9216
    buffer_load_dwordx4 v31, s[8:11], s76 offen lds
    s_add_u32 m0, s37, 10240
    s_add_u32 s76, s45, 10240
    buffer_load_dwordx4 v30, s[8:11], s76 offen lds
    s_add_u32 m0, s37, 11264
    s_add_u32 s76, s45, 11264
    buffer_load_dwordx4 v31, s[8:11], s76 offen lds
    s_add_u32 m0, s37, 12288
    s_add_u32 s76, s45, 12288
    buffer_load_dwordx4 v30, s[8:11], s76 offen lds
    s_add_u32 m0, s37, 13312
    s_add_u32 s76, s45, 13312
    buffer_load_dwordx4 v31, s[8:11], s76 offen lds
    s_add_u32 m0, s37, 14336
    s_add_u32 s76, s45, 14336
    buffer_load_dwordx4 v30, s[8:11], s76 offen lds
    s_add_u32 m0, s37, 15360
    s_add_u32 s76, s45, 15360
    buffer_load_dwordx4 v31, s[8:11], s76 offen lds
L_on_38:
    s_lshl_b32 s79, s70, 10
    s_add_u32 s79, s79, s39
    s_lshl_b32 s76, s71, 16
    s_add_u32 s79, s79, s76
    buffer_load_dwordx4 v[72:75], v2, s[8:11], s79 offen
    s_add_u32 s79, s79, 32768
    buffer_load_dwordx4 v[76:79], v2, s[8:11], s79 offen
    s_cmp_lt_u32 s71, 2
    s_cselect_b32 s4, s50, s52
    s_cselect_b32 s5, s51, s53
    s_mov_b32 s6, 1052672
    s_mov_b32 s7, 0x00020000
    s_lshl_b32 s47, s75, 2
    s_lshr_b32 s78, s74, 3
    s_add_u32 s47, s47, s78
    s_lshr_b32 s78, s47, 3
    s_lshl_b32 s78, s78, 4
    s_and_b32 s79, s47, 7
    s_lshl_b32 s79, s79, 8
    s_add_u32 s78, s78, s79
    s_lshl_b32 s79, s73, 7
    s_add_u32 s78, s78, s79
    s_mul_i32 s78, s78, 514
    s_lshl_b32 s79, s88, 6
    s_add_u32 s78, s78, s79
    v_lshrrev_b32 v16, 3, v1
    v_mul_u32_u24 v17, 514, v16
    v_add_u32 v17, 2, v17
    v_and_b32 v17, -16, v17
    v_and_b32 v18, 7, v1
    v_xor_b32 v18, v18, v16
    v_lshl_add_u32 v17, v18, 4, v17
    s_add_u32 m0, s84, 131072
    s_add_u32 s79, s78, 0
    buffer_load_dwordx4 v17, s[4:7], s79 offen nt lds
    s_add_u32 m0, s84, 132096
    s_add_u32 s79, s78, 4112
    buffer_load_dwordx4 v17, s[4:7], s79 offen nt lds
    s_add_u32 m0, s84, 133120
    s_add_u32 s79, s78, 32896
    buffer_load_dwordx4 v17, s[4:7], s79 offen nt lds
    s_add_u32 m0, s84, 134144
    s_add_u32 s79, s78, 37008
    buffer_load_dwordx4 v17, s[4:7], s79 offen nt lds
    s_waitcnt vmcnt(6)
    v_mov_b32 v27, 2
    ds_write_b32 v4, v27 offset:0
    s_add_u32 s79, s71, 0
    s_and_b32 s76, s74, 7
    s_cmp_lg_u32 s76, s79
    s_cbranch_scc1 L_nt_39
    s_mov_b32 s16, s60
    s_mov_b32 s17, s61
    s_mov_b32 s18, 1835008
    s_mov_b32 s19, 0x00020000
    v_lshlrev_b32 v44, 7, v1
    s_mul_i32 s76, s74, 57344
    s_add_u32 s77, s76, 0
    buffer_load_dword v45, v44, s[16:19], s77 offen
    s_add_u32 s77, s76, 8192
    buffer_load_dword v45, v44, s[16:19], s77 offen
    s_add_u32 s77, s76, 16384
    buffer_load_dword v45, v44, s[16:19], s77 offen
    s_add_u32 s77, s76, 24576
    buffer_load_dword v45, v44, s[16:19], s77 offen
    s_add_u32 s77, s76, 32768
    buffer_load_dword v45, v44, s[16:19], s77 offen
    s_add_u32 s77, s76, 40960
    buffer_load_dword v45, v44, s[16:19], s77 offen
    s_add_u32 s77, s76, 49152
    buffer_load_dword v45, v44, s[16:19], s77 offen
    s_lshl_b32 s76, s74, 14
L_nt_39:
    s_waitcnt vmcnt(4)
    v_lshlrev_b32 v80, 16, v72
    v_and_b32 v81, 0xffff0000, v72
    v_lshlrev_b32 v82, 16, v73
    v_and_b32 v83, 0xffff0000, v73
    v_lshlrev_b32 v84, 16, v74
    v_and_b32 v85, 0xffff0000, v74
    v_lshlrev_b32 v86, 16, v75
    v_and_b32 v87, 0xffff0000, v75
    v_lshlrev_b32 v88, 16, v76
    v_and_b32 v89, 0xffff0000, v76
    v_lshlrev_b32 v90, 16, v77
    v_and_b32 v91, 0xffff0000, v77
    v_lshlrev_b32 v92, 16, v78
    v_and_b32 v93, 0xffff0000, v78
    v_lshlrev_b32 v94, 16, v79
    v_and_b32 v95, 0xffff0000, v79
    v_add_f32 v96, v80, v81
    v_add_f32 v97, v88, v89
    v_add_f32 v96, v96, v82
    v_add_f32 v97, v97, v90
    v_add_f32 v96, v96, v83
    v_add_f32 v97, v97, v91
    v_add_f32 v96, v96, v84
    v_add_f32 v97, v97, v92
    v_add_f32 v96, v96, v85
    v_add_f32 v97, v97, v93
    v_add_f32 v96, v96, v86
    v_add_f32 v97, v97, v94
    v_add_f32 v96, v96, v87
    v_add_f32 v97, v97, v95
    s_nop 0
    v_add_f32_dpp v96, v96, v96 row_shr:1
    v_add_f32_dpp v97, v97, v97 row_shr:1
    s_nop 0
    v_add_f32_dpp v96, v96, v96 row_shr:2
    v_add_f32_dpp v97, v97, v97 row_shr:2
    s_nop 0
    v_add_f32_dpp v96, v96, v96 row_shr:4
    v_add_f32_dpp v97, v97, v97 row_shr:4
    s_nop 0
    v_add_f32_dpp v96, v96, v96 row_shr:8
    v_add_f32_dpp v97, v97, v97 row_shr:8
    s_nop 0
    v_add_f32_dpp v96, v96, v96 row_bcast:15 row_mask:0xa
    v_add_f32_dpp v97, v97, v97 row_bcast:15 row_mask:0xa
    s_nop 0
    v_add_f32_dpp v96, v96, v96 row_bcast:31 row_mask:0xc
    v_add_f32_dpp v97, v97, v97 row_bcast:31 row_mask:0xc
    v_readlane_b32 s79, v96, 63
    v_readlane_b32 s78, v97, 63
    v_mov_b32 v98, 0x3b000000
    v_mul_f32 v96, s79, v98
    v_mul_f32 v97, s78, v98
    v_sub_f32 v80, v80, v96
    v_sub_f32 v88, v88, v97
    v_sub_f32 v81, v81, v96
    v_sub_f32 v89, v89, v97
    v_sub_f32 v82, v82, v96
    v_sub_f32 v90, v90, v97
    v_sub_f32 v83, v83, v96
    v_sub_f32 v91, v91, v97
    v_sub_f32 v84, v84, v96
    v_sub_f32 v92, v92, v97
    v_sub_f32 v85, v85, v96
    v_sub_f32 v93, v93, v97
    v_sub_f32 v86, v86, v96
    v_sub_f32 v94, v94, v97
    v_sub_f32 v87, v87, v96
    v_sub_f32 v95, v95, v97
    v_mul_f32 v100, v80, v80
    v_mul_f32 v101, v88, v88
    v_fmac_f32 v100, v81, v81
    v_fmac_f32 v101, v89, v89
    v_fmac_f32 v100, v82, v82
    v_fmac_f32 v101, v90, v90
    v_fmac_f32 v100, v83, v83
    v_fmac_f32 v101, v91, v91
    v_fmac_f32 v100, v84, v84
    v_fmac_f32 v101, v92, v92
    v_fmac_f32 v100, v85, v85
    v_fmac_f32 v101, v93, v93
    v_fmac_f32 v100, v86, v86
    v_fmac_f32 v101, v94, v94
    v_fmac_f32 v100, v87, v87
    v_fmac_f32 v101, v95, v95
    s_nop 0
    v_add_f32_dpp v100, v100, v100 row_shr:1
    v_add_f32_dpp v101, v101, v101 row_shr:1
    s_nop 0
    v_add_f32_dpp v100, v100, v100 row_shr:2
    v_add_f32_dpp v101, v101, v101 row_shr:2
    s_nop 0
    v_add_f32_dpp v100, v100, v100 row_shr:4
    v_add_f32_dpp v101, v101, v101 row_shr:4
    s_nop 0
    v_add_f32_dpp v100, v100, v100 row_shr:8
    v_add_f32_dpp v101, v101, v101 row_shr:8
    s_nop 0
    v_add_f32_dpp v100, v100, v100 row_bcast:15 row_mask:0xa
    v_add_f32_dpp v101, v101, v101 row_bcast:15 row_mask:0xa
    s_nop 0
    v_add_f32_dpp v100, v100, v100 row_bcast:31 row_mask:0xc
    v_add_f32_dpp v101, v101, v101 row_bcast:31 row_mask:0xc
    v_readlane_b32 s79, v100, 63
    v_readlane_b32 s78, v101, 63
    v_cmp_eq_u32 vcc, 1, v1
    v_mov_b32 v102, s79
    v_mov_b32 v103, s78
    v_cndmask_b32 v102, v102, v103, vcc
    v_cndmask_b32 v104, v96, v97, vcc
    v_mul_f32 v102, v102, v98
    v_cvt_pk_bf16_f32 v102, v102, v102
    v_and_b32 v102, 0xffff0000, v102
    v_cvt_pk_bf16_f32 v104, v104, v104
    v_and_b32 v104, 0xffff0000, v104
    v_add_f32 v102, 0x3727c5ac, v102
    v_cvt_pk_bf16_f32 v102, v102, v102
    v_and_b32 v102, 0xffff0000, v102
    v_sqrt_f32 v102, v102
    s_nop 0
    v_cvt_pk_bf16_f32 v102, v102, v102
    v_and_b32 v102, 0xffff0000, v102
    v_rcp_f32 v105, v102
    s_lshl_b32 s79, s69, 7
    s_lshl_b32 s78, s70, 3
    s_add_u32 s79, s79, s78
    s_lshl_b32 s78, s71, 1
    s_add_u32 s79, s79, s78
    s_lshl_b32 s79, s79, 4
    s_add_u32 s79, s79, 65536
    v_mov_b32 v106, s68
    v_mov_b32 v107, s68
    s_mov_b64 exec, 3
    buffer_store_dwordx4 v[104:107], v2, s[12:15], s79 offen sc1
    s_mov_b64 exec, -1
    s_waitcnt vmcnt(1)
    v_mov_b32 v27, 1
    ds_write_b32 v4, v27 offset:48
    s_add_u32 s36, s71, 8
    s_sub_u32 s79, s36, 3
    s_add_u32 s38, s71, s44
    s_add_u32 s38, s38, 4
    s_and_b32 s38, s38, 7
    s_lshr_b32 s77, s36, 1
    s_add_u32 s77, s77, s44
    s_and_b32 s77, s77, 7
    s_lshl_b32 s78, s77, 1
    s_and_b32 s77, s36, 1
    s_add_u32 s78, s78, s77
    s_lshl_b32 s78, s78, 5
    s_mul_i32 s46, s78, 3584
    s_lshl_b32 s77, s85, 7
    s_add_u32 s46, s46, s77
    s_lshl_b32 s82, s78, 10
    s_lshl_b32 s77, s70, 8
    s_add_u32 s82, s82, s77
    ds_read_b128 v[24:27], v3 offset:16
    s_waitcnt lgkmcnt(0)
    v_min3_u32 v24, v24, v25, v26
    v_min_u32 v24, v24, v27
    s_nop 0
    v_readfirstlane_b32 s89, v24
    s_nop 0
    s_cmp_ge_u32 s89, s79
    s_cbranch_scc1 L_bk_41
L_sl_40:
    s_mov_b32 s100, 0
L_sp_42:
    s_sleep 1
    ds_read_b128 v[24:27], v3 offset:16
    s_waitcnt lgkmcnt(0)
    v_min3_u32 v24, v24, v25, v26
    v_min_u32 v24, v24, v27
    s_nop 0
    v_readfirstlane_b32 s89, v24
    s_nop 0
    s_cmp_ge_u32 s89, s79
    s_cbranch_scc1 L_bk_41
    s_add_u32 s100, s100, 1
    s_cmp_lt_u32 s100, 8388608
    s_cbranch_scc1 L_sp_42
L_bk_41:
    s_add_u32 m0, s37, 65536
    s_add_u32 s76, s82, 0
    buffer_load_dwordx4 v33, s[40:43], s76 offen lds
    s_add_u32 m0, s37, 66560
    s_add_u32 s76, s82, 8192
    buffer_load_dwordx4 v33, s[40:43], s76 offen lds
    s_add_u32 m0, s37, 67584
    s_add_u32 s76, s82, 16384
    buffer_load_dwordx4 v33, s[40:43], s76 offen lds
    s_add_u32 m0, s37, 68608
    s_add_u32 s76, s82, 24576
    buffer_load_dwordx4 v33, s[40:43], s76 offen lds
    s_add_u32 m0, s37, 69632
    s_add_u32 s76, s82, 128
    buffer_load_dwordx4 v33, s[40:43], s76 offen lds
    s_add_u32 m0, s37, 70656
    s_add_u32 s76, s82, 8320
    buffer_load_dwordx4 v33, s[40:43], s76 offen lds
    s_add_u32 m0, s37, 71680
    s_add_u32 s76, s82, 16512
    buffer_load_dwordx4 v33, s[40:43], s76 offen lds
    s_add_u32 m0, s37, 72704
    s_add_u32 s76, s82, 24704
    buffer_load_dwordx4 v33, s[40:43], s76 offen lds
    s_add_u32 m0, s37, 73728
    s_add_u32 s76, s46, 0
    buffer_load_dwordx4 v32, s[20:23], s76 offen lds
    s_add_u32 m0, s37, 74752
    s_add_u32 s76, s46, 28672
    buffer_load_dwordx4 v32, s[20:23], s76 offen lds
    s_add_u32 m0, s37, 75776
    s_add_u32 s76, s46, 57344
    buffer_load_dwordx4 v32, s[20:23], s76 offen lds
    s_add_u32 m0, s37, 76800
    s_add_u32 s76, s46, 86016
    buffer_load_dwordx4 v32, s[20:23], s76 offen lds
    s_add_u32 m0, s37, 77824
    s_add_u32 s76, s46, 0
    buffer_load_dwordx4 v32, s[24:27], s76 offen lds
    s_add_u32 m0, s37, 78848
    s_add_u32 s76, s46, 28672
    buffer_load_dwordx4 v32, s[24:27], s76 offen lds
    s_add_u32 m0, s37, 79872
    s_add_u32 s76, s46, 57344
    buffer_load_dwordx4 v32, s[24:27], s76 offen lds
    s_add_u32 m0, s37, 80896
    s_add_u32 s76, s46, 86016
    buffer_load_dwordx4 v32, s[24:27], s76 offen lds
    s_cmp_lg_u32 s71, 0
    s_cbranch_scc0 L_on_43
    s_lshl_b32 s45, s38, 7
    s_add_u32 s45, s45, s39
    s_add_u32 m0, s37, 0
    s_add_u32 s76, s45, 0
    buffer_load_dwordx4 v30, s[8:11], s76 offen lds
    s_add_u32 m0, s37, 1024
    s_add_u32 s76, s45, 1024
    buffer_load_dwordx4 v31, s[8:11], s76 offen lds
    s_add_u32 m0, s37, 2048
    s_add_u32 s76, s45, 2048
    buffer_load_dwordx4 v30, s[8:11], s76 offen lds
    s_add_u32 m0, s37, 3072
    s_add_u32 s76, s45, 3072
    buffer_load_dwordx4 v31, s[8:11], s76 offen lds
    s_add_u32 m0, s37, 4096
    s_add_u32 s76, s45, 4096
    buffer_load_dwordx4 v30, s[8:11], s76 offen lds
    s_add_u32 m0, s37, 5120
    s_add_u32 s76, s45, 5120
    buffer_load_dwordx4 v31, s[8:11], s76 offen lds
    s_add_u32 m0, s37, 6144
    s_add_u32 s76, s45, 6144
    buffer_load_dwordx4 v30, s[8:11], s76 offen lds
    s_add_u32 m0, s37, 7168
    s_add_u32 s76, s45, 7168
    buffer_load_dwordx4 v31, s[8:11], s76 offen lds
    s_add_u32 m0, s37, 8192
    s_add_u32 s76, s45, 8192
    buffer_load_dwordx4 v30, s[8:11], s76 offen lds
    s_add_u32 m0, s37, 9216
    s_add_u32 s76, s45, 9216
    buffer_load_dwordx4 v31, s[8:11], s76 offen lds
    s_add_u32 m0, s37, 10240
    s_add_u32 s76, s45, 10240
    buffer_load_dwordx4 v30, s[8:11], s76 offen lds
    s_add_u32 m0, s37, 11264
    s_add_u32 s76, s45, 11264
    buffer_load_dwordx4 v31, s[8:11], s76 offen lds
    s_add_u32 m0, s37, 12288
    s_add_u32 s76, s45, 12288
    buffer_load_dwordx4 v30, s[8:11], s76 offen lds
    s_add_u32 m0, s37, 13312
    s_add_u32 s76, s45, 13312
    buffer_load_dwordx4 v31, s[8:11], s76 offen lds
    s_add_u32 m0, s37, 14336
    s_add_u32 s76, s45, 14336
    buffer_load_dwordx4 v30, s[8:11], s76 offen lds
    s_add_u32 m0, s37, 15360
    s_add_u32 s76, s45, 15360
    buffer_load_dwordx4 v31, s[8:11], s76 offen lds
L_on_43:
    s_waitcnt vmcnt(0)
    v_mov_b32 v27, 3
    ds_write_b32 v4, v27 offset:0
    s_add_u32 s79, s71, 4
    s_and_b32 s76, s74, 7
    s_cmp_lg_u32 s76, s79
    s_cbranch_scc1 L_nt_44
    s_mov_b32 s16, s60
    s_mov_b32 s17, s61
    s_mov_b32 s18, 1835008
    s_mov_b32 s19, 0x00020000
    v_lshlrev_b32 v44, 7, v1
    s_mul_i32 s76, s74, 57344
    s_add_u32 s77, s76, 0
    buffer_load_dword v45, v44, s[16:19], s77 offen
    s_add_u32 s77, s76, 8192
    buffer_load_dword v45, v44, s[16:19], s77 offen
    s_add_u32 s77, s76, 16384
    buffer_load_dword v45, v44, s[16:19], s77 offen
    s_add_u32 s77, s76, 24576
    buffer_load_dword v45, v44, s[16:19], s77 offen
    s_add_u32 s77, s76, 32768
    buffer_load_dword v45, v44, s[16:19], s77 offen
    s_add_u32 s77, s76, 40960
    buffer_load_dword v45, v44, s[16:19], s77 offen
    s_add_u32 s77, s76, 49152
    buffer_load_dword v45, v44, s[16:19], s77 offen
    s_lshl_b32 s76, s74, 14
L_nt_44:
    ds_read_b128 v[24:27], v3 offset:48
    s_waitcnt lgkmcnt(0)
    v_min3_u32 v24, v24, v25, v26
    v_min_u32 v24, v24, v27
    s_nop 0
    v_readfirstlane_b32 s89, v24
    s_nop 0
    s_cmp_ge_u32 s89, 1
    s_cbranch_scc1 L_bk_46
L_sl_45:
    s_mov_b32 s100, 0
L_sp_47:
    s_sleep 1
    ds_read_b128 v[24:27], v3 offset:48
    s_waitcnt lgkmcnt(0)
    v_min3_u32 v24, v24, v25, v26
    v_min_u32 v24, v24, v27
    s_nop 0
    v_readfirstlane_b32 s89, v24
    s_nop 0
    s_cmp_ge_u32 s89, 1
    s_cbranch_scc1 L_bk_46
    s_add_u32 s100, s100, 1
    s_cmp_lt_u32 s100, 8388608
    s_cbranch_scc1 L_sp_47
L_bk_46:
    v_and_b32 v16, 15, v1
    v_lshrrev_b32 v17, 4, v1
    v_lshlrev_b32 v18, 1, v16
    v_add_u32 v18, 2, v18
    v_and_b32 v18, 15, v18
    v_lshl_add_u32 v18, v17, 1, v18
    s_lshl_b32 s78, s71, 4
    v_add_u32 v18, s78, v18
    v_and_b32 v19, 7, v16
    v_lshlrev_b32 v19, 4, v19
    v_lshlrev_b32 v20, 7, v16
    v_add_u32 v20, 131072, v20
    v_xor_b32 v21, v18, v19
    v_add_u32 v21, v21, v20
    ds_read_u16 v112, v21 offset:0
    ds_read_u16 v120, v21 offset:8192
    ds_read_u16 v113, v21 offset:2048
    ds_read_u16 v121, v21 offset:10240
    ds_read_u16 v114, v21 offset:4096
    ds_read_u16 v122, v21 offset:12288
    ds_read_u16 v115, v21 offset:6144
    ds_read_u16 v123, v21 offset:14336
    v_add_u32 v18, 8, v18
    v_xor_b32 v22, v18, v19
    v_add_u32 v22, v22, v20
    ds_read_u16 v116, v22 offset:0
    ds_read_u16 v124, v22 offset:8192
    ds_read_u16 v117, v22 offset:2048
    ds_read_u16 v125, v22 offset:10240
    ds_read_u16 v118, v22 offset:4096
    ds_read_u16 v126, v22 offset:12288
    ds_read_u16 v119, v22 offset:6144
    ds_read_u16 v127, v22 offset:14336
    v_lshlrev_b32 v17, 13, v17
    v_lshl_add_u32 v17, v16, 4, v17
    s_lshl_b32 s78, s88, 18
    s_lshl_b32 s79, s71, 16
    s_add_u32 s78, s78, s79
    s_lshl_b32 s79, s47, 8
    s_add_u32 s78, s78, s79
    s_add_u32 s78, s78, 13631488
    s_add_u32 s79, s78, 32768
    s_waitcnt lgkmcnt(8)
    v_lshl_or_b32 v112, v120, 16, v112
    v_lshl_or_b32 v113, v121, 16, v113
    v_lshl_or_b32 v114, v122, 16, v114
    v_lshl_or_b32 v115, v123, 16, v115
    buffer_store_dwordx4 v[112:115], v17, s[12:15], s78 offen sc1
    s_waitcnt lgkmcnt(0)
    v_lshl_or_b32 v116, v124, 16, v116
    v_lshl_or_b32 v117, v125, 16, v117
    v_lshl_or_b32 v118, v126, 16, v118
    v_lshl_or_b32 v119, v127, 16, v119
    buffer_store_dwordx4 v[116:119], v17, s[12:15], s79 offen sc1
    s_waitcnt lgkmcnt(0)
    s_add_u32 s36, s71, 12
    s_sub_u32 s79, s36, 3
    s_add_u32 s38, s71, s44
    s_add_u32 s38, s38, 4
    s_and_b32 s38, s38, 7
    s_lshr_b32 s77, s36, 1
    s_add_u32 s77, s77, s44
    s_and_b32 s77, s77, 7
    s_lshl_b32 s78, s77, 1
    s_and_b32 s77, s36, 1
    s_add_u32 s78, s78, s77
    s_lshl_b32 s78, s78, 5
    s_mul_i32 s46, s78, 3584
    s_lshl_b32 s77, s85, 7
    s_add_u32 s46, s46, s77
    s_lshl_b32 s82, s78, 10
    s_lshl_b32 s77, s70, 8
    s_add_u32 s82, s82, s77
    ds_read_b128 v[24:27], v3 offset:16
    s_waitcnt lgkmcnt(0)
    v_min3_u32 v24, v24, v25, v26
    v_min_u32 v24, v24, v27
    s_nop 0
    v_readfirstlane_b32 s89, v24
    s_nop 0
    s_cmp_ge_u32 s89, s79
    s_cbranch_scc1 L_bk_49
L_sl_48:
    s_mov_b32 s100, 0
L_sp_50:
    s_sleep 1
    ds_read_b128 v[24:27], v3 offset:16
    s_waitcnt lgkmcnt(0)
    v_min3_u32 v24, v24, v25, v26
    v_min_u32 v24, v24, v27
    s_nop 0
    v_readfirstlane_b32 s89, v24
    s_nop 0
    s_cmp_ge_u32 s89, s79
    s_cbranch_scc1 L_bk_49
    s_add_u32 s100, s100, 1
    s_cmp_lt_u32 s100, 8388608
    s_cbranch_scc1 L_sp_50
L_bk_49:
    s_add_u32 m0, s37, 65536
    s_add_u32 s76, s82, 0
    buffer_load_dwordx4 v33, s[40:43], s76 offen lds
    s_add_u32 m0, s37, 66560
    s_add_u32 s76, s82, 8192
    buffer_load_dwordx4 v33, s[40:43], s76 offen lds
    s_add_u32 m0, s37, 67584
    s_add_u32 s76, s82, 16384
    buffer_load_dwordx4 v33, s[40:43], s76 offen lds
    s_add_u32 m0, s37, 68608
    s_add_u32 s76, s82, 24576
    buffer_load_dwordx4 v33, s[40:43], s76 offen lds
    s_add_u32 m0, s37, 69632
    s_add_u32 s76, s82, 128
    buffer_load_dwordx4 v33, s[40:43], s76 offen lds
    s_add_u32 m0, s37, 70656
    s_add_u32 s76, s82, 8320
    buffer_load_dwordx4 v33, s[40:43], s76 offen lds
    s_add_u32 m0, s37, 71680
    s_add_u32 s76, s82, 16512
    buffer_load_dwordx4 v33, s[40:43], s76 offen lds
    s_add_u32 m0, s37, 72704
    s_add_u32 s76, s82, 24704
    buffer_load_dwordx4 v33, s[40:43], s76 offen lds
    s_add_u32 m0, s37, 73728
    s_add_u32 s76, s46, 0
    buffer_load_dwordx4 v32, s[20:23], s76 offen lds
    s_add_u32 m0, s37, 74752
    s_add_u32 s76, s46, 28672
    buffer_load_dwordx4 v32, s[20:23], s76 offen lds
    s_add_u32 m0, s37, 75776
    s_add_u32 s76, s46, 57344
    buffer_load_dwordx4 v32, s[20:23], s76 offen lds
    s_add_u32 m0, s37, 76800
    s_add_u32 s76, s46, 86016
    buffer_load_dwordx4 v32, s[20:23], s76 offen lds
    s_add_u32 m0, s37, 77824
    s_add_u32 s76, s46, 0
    buffer_load_dwordx4 v32, s[24:27], s76 offen lds
    s_add_u32 m0, s37, 78848
    s_add_u32 s76, s46, 28672
    buffer_load_dwordx4 v32, s[24:27], s76 offen lds
    s_add_u32 m0, s37, 79872
    s_add_u32 s76, s46, 57344
    buffer_load_dwordx4 v32, s[24:27], s76 offen lds
    s_add_u32 m0, s37, 80896
    s_add_u32 s76, s46, 86016
    buffer_load_dwordx4 v32, s[24:27], s76 offen lds
    s_waitcnt vmcnt(0)
    v_mov_b32 v27, 4
    ds_write_b32 v4, v27 offset:0
    ds_read_b128 v[24:27], v3 offset:0
    s_waitcnt lgkmcnt(0)
    v_min3_u32 v24, v24, v25, v26
    v_min_u32 v24, v24, v27
    s_nop 0
    v_readfirstlane_b32 s89, v24
    s_nop 0
    s_cmp_ge_u32 s89, 4
    s_cbranch_scc1 L_bk_52
L_sl_51:
    s_mov_b32 s100, 0
L_sp_53:
    s_sleep 1
    ds_read_b128 v[24:27], v3 offset:0
    s_waitcnt lgkmcnt(0)
    v_min3_u32 v24, v24, v25, v26
    v_min_u32 v24, v24, v27
    s_nop 0
    v_readfirstlane_b32 s89, v24
    s_nop 0
    s_cmp_ge_u32 s89, 4
    s_cbranch_scc1 L_bk_52
    s_add_u32 s100, s100, 1
    s_cmp_lt_u32 s100, 8388608
    s_cbranch_scc1 L_sp_53
L_bk_52:
    buffer_load_dwordx4 v[64:67], v37, s[12:15], s32 offen sc1
    buffer_load_dwordx2 v[68:69], v38, s[12:15], s33 offen offset:0 sc1
    buffer_load_dwordx2 v[70:71], v38, s[12:15], s33 offen offset:512 sc1
    buffer_load_dwordx2 v[72:73], v38, s[12:15], s33 offen offset:1024 sc1
    buffer_load_dwordx2 v[74:75], v38, s[12:15], s33 offen offset:1536 sc1
    buffer_load_dwordx2 v[76:77], v38, s[12:15], s33 offen offset:2048 sc1
    buffer_load_dwordx2 v[78:79], v38, s[12:15], s33 offen offset:2560 sc1
    buffer_load_dwordx2 v[80:81], v38, s[12:15], s33 offen offset:3072 sc1
    buffer_load_dwordx2 v[82:83], v38, s[12:15], s33 offen offset:3584 sc1
    s_add_u32 s76, s84, 524288
    s_mov_b32 s77, 540672
    buffer_load_dwordx4 v[128:131], v2, s[40:43], s76 offen offset:0
    buffer_load_dwordx4 v[136:139], v2, s[40:43], s76 offen offset:2048
    buffer_load_dwordx4 v[152:155], v2, s[40:43], s77 offen offset:0
    buffer_load_dwordx4 v[160:163], v2, s[40:43], s77 offen offset:2048
    buffer_load_dwordx4 v[132:135], v2, s[40:43], s76 offen offset:1024
    buffer_load_dwordx4 v[140:143], v2, s[40:43], s76 offen offset:3072
    buffer_load_dwordx4 v[156:159], v2, s[40:43], s77 offen offset:1024
    buffer_load_dwordx4 v[164:167], v2, s[40:43], s77 offen offset:3072
    s_waitcnt vmcnt(16)
    v_xor_b32 v8, s68, v66
    v_xor_b32 v9, s68, v67
    v_or_b32 v8, v8, v9
    v_cmp_ne_u32 vcc, 0, v8
    s_nop 4
    s_cbranch_vccz L_back_55
L_slow_54:
    s_mov_b32 s89, 0
L_spin_56:
    s_sleep 6
    buffer_load_dwordx4 v[64:67], v37, s[12:15], s32 offen sc1
    s_waitcnt vmcnt(0)
    v_xor_b32 v8, s68, v66
    v_xor_b32 v9, s68, v67
    v_or_b32 v8, v8, v9
    v_cmp_ne_u32 vcc, 0, v8
    s_nop 4
    s_cbranch_vccz L_back_55
    s_add_u32 s89, s89, 1
    s_cmp_lt_u32 s89, 1048576
    s_cbranch_scc1 L_spin_56
L_back_55:
    v_lshlrev_b32 v8, 3, v36
    v_add_u32 v8, 159744, v8
    ds_write_b64 v8, v[64:65]
    v_lshlrev_b32 v9, 2, v36
    v_add_u32 v9, 160768, v9
    ds_write_b32 v9, v65
    s_waitcnt vmcnt(8)
    v_xor_b32 v8, s68, v69
    v_xor_b32 v9, s68, v71
    v_or_b32 v8, v8, v9
    v_xor_b32 v9, s68, v73
    v_or_b32 v8, v8, v9
    v_xor_b32 v9, s68, v75
    v_or_b32 v8, v8, v9
    v_xor_b32 v9, s68, v77
    v_or_b32 v8, v8, v9
    v_xor_b32 v9, s68, v79
    v_or_b32 v8, v8, v9
    v_xor_b32 v9, s68, v81
    v_or_b32 v8, v8, v9
    v_xor_b32 v9, s68, v83
    v_or_b32 v8, v8, v9
    v_cmp_ne_u32 vcc, 0, v8
    s_nop 4
    s_cbranch_vccz L_back_58
L_slow_57:
    s_mov_b32 s89, 0
L_spin_59:
    s_sleep 6
    buffer_load_dwordx2 v[68:69], v38, s[12:15], s33 offen offset:0 sc1
    buffer_load_dwordx2 v[70:71], v38, s[12:15], s33 offen offset:512 sc1
    buffer_load_dwordx2 v[72:73], v38, s[12:15], s33 offen offset:1024 sc1
    buffer_load_dwordx2 v[74:75], v38, s[12:15], s33 offen offset:1536 sc1
    buffer_load_dwordx2 v[76:77], v38, s[12:15], s33 offen offset:2048 sc1
    buffer_load_dwordx2 v[78:79], v38, s[12:15], s33 offen offset:2560 sc1
    buffer_load_dwordx2 v[80:81], v38, s[12:15], s33 offen offset:3072 sc1
    buffer_load_dwordx2 v[82:83], v38, s[12:15], s33 offen offset:3584 sc1
    s_waitcnt vmcnt(0)
    v_xor_b32 v8, s68, v69
    v_xor_b32 v9, s68, v71
    v_or_b32 v8, v8, v9
    v_xor_b32 v9, s68, v73
    v_or_b32 v8, v8, v9
    v_xor_b32 v9, s68, v75
    v_or_b32 v8, v8, v9
    v_xor_b32 v9, s68, v77
    v_or_b32 v8, v8, v9
    v_xor_b32 v9, s68, v79
    v_or_b32 v8, v8, v9
    v_xor_b32 v9, s68, v81
    v_or_b32 v8, v8, v9
    v_xor_b32 v9, s68, v83
    v_or_b32 v8, v8, v9
    v_cmp_ne_u32 vcc, 0, v8
    s_nop 4
    s_cbranch_vccz L_back_58
    s_add_u32 s89, s89, 1
    s_cmp_lt_u32 s89, 1048576
    s_cbranch_scc1 L_spin_59
L_back_58:
    v_add_f32 v68, v68, v70
    v_add_f32 v72, v72, v74
    v_add_f32 v76, v76, v78
    v_add_f32 v80, v80, v82
    v_add_f32 v68, v68, v72
    v_add_f32 v76, v76, v80
    v_add_f32 v68, v68, v76
    v_lshlrev_b32 v10, 2, v39
    v_add_u32 v10, 161792, v10
    ds_write_b32 v10, v68
    s_waitcnt lgkmcnt(0)
    v_mov_b32 v27, 2
    ds_write_b32 v4, v27 offset:32
    s_lshl_b32 s77, s88, 5
    s_add_u32 s77, s77, s47
    v_mov_b32 v24, 1
    s_mov_b64 exec, 1
    ds_add_rtn_u32 v25, v3, v24 offset:72
    s_mov_b64 exec, -1
    s_waitcnt lgkmcnt(0)
    v_readfirstlane_b32 s78, v25
    s_nop 0
    s_cmp_lg_u32 s78, 3
    s_cbranch_scc1 L_nl_60
    s_lshl_b32 s78, s77, 7
    s_add_u32 s78, s78, 458752
    v_mov_b32 v28, s68
    v_mov_b32 v29, 0
    s_mov_b64 exec, 1
    buffer_store_dword v28, v29, s[12:15], s78 offen sc1
    s_mov_b64 exec, -1
L_nl_60:
L_h_join:
    s_waitcnt vmcnt(0)
    s_waitcnt lgkmcnt(0)
    s_mov_b32 s24, s60
    s_mov_b32 s25, s61
    s_mov_b32 s26, 1835008
    s_mov_b32 s27, 0x00020000
    s_lshl_b32 s37, s88, 7
    s_lshl_b32 s90, s71, 15
    s_add_u32 s91, s90, 16384
    s_and_b32 s100, s87, 3
    s_lshl_b32 s100, s100, 2
    s_lshr_b32 s100, 0x5320, s100
    s_and_b32 s100, s100, 15
    s_add_u32 s100, s100, s88
    s_mul_i32 s76, s100, 43
    s_lshr_b32 s76, s76, 8
    s_mul_i32 s76, s76, 6
    s_sub_u32 s44, s100, s76
    s_mul_i32 s47, s71, 6
    ds_read_b128 v[24:27], v3 offset:16
    s_waitcnt lgkmcnt(0)
    v_min3_u32 v24, v24, v25, v26
    v_min_u32 v24, v24, v27
    s_nop 0
    v_readfirstlane_b32 s89, v24
    s_nop 0
    s_cmp_ge_u32 s89, 17
    s_cbranch_scc1 L_bk_62
L_sl_61:
    s_mov_b32 s100, 0
L_sp_63:
    s_sleep 1
    ds_read_b128 v[24:27], v3 offset:16
    s_waitcnt lgkmcnt(0)
    v_min3_u32 v24, v24, v25, v26
    v_min_u32 v24, v24, v27
    s_nop 0
    v_readfirstlane_b32 s89, v24
    s_nop 0
    s_cmp_ge_u32 s89, 17
    s_cbranch_scc1 L_bk_62
    s_add_u32 s100, s100, 1
    s_cmp_lt_u32 s100, 8388608
    s_cbranch_scc1 L_sp_63
L_bk_62:
    s_add_u32 s76, s44, 0
    s_sub_u32 s80, s76, 6
    s_cmp_ge_u32 s76, 6
    s_cselect_b32 s76, s80, s76
    s_add_u32 s76, s76, s47
    s_lshl_b32 s76, s76, 16
    s_add_u32 s76, s76, s37
    s_add_u32 m0, s90, 0
    s_add_u32 s77, s76, 0
    buffer_load_dwordx4 v33, s[24:27], s77 offen lds
    s_add_u32 m0, s90, 1024
    s_add_u32 s77, s76, 8192
    buffer_load_dwordx4 v33, s[24:27], s77 offen lds
    s_add_u32 m0, s90, 2048
    s_add_u32 s77, s76, 16384
    buffer_load_dwordx4 v33, s[24:27], s77 offen lds
    s_add_u32 m0, s90, 3072
    s_add_u32 s77, s76, 24576
    buffer_load_dwordx4 v33, s[24:27], s77 offen lds
    s_add_u32 m0, s90, 4096
    s_add_u32 s77, s76, 32768
    buffer_load_dwordx4 v33, s[24:27], s77 offen lds
    s_add_u32 m0, s90, 5120
    s_add_u32 s77, s76, 40960
    buffer_load_dwordx4 v33, s[24:27], s77 offen lds
    s_add_u32 m0, s90, 6144
    s_add_u32 s77, s76, 49152
    buffer_load_dwordx4 v33, s[24:27], s77 offen lds
    s_add_u32 m0, s90, 7168
    s_add_u32 s77, s76, 57344
    buffer_load_dwordx4 v33, s[24:27], s77 offen lds
    s_waitcnt vmcnt(0)
    v_mov_b32 v27, 1
    ds_write_b32 v4, v27 offset:80
    v_and_b32 v8, 15, v1
    v_lshlrev_b32 v42, 11, v8
    s_lshr_b32 s76, s2, 6
    s_lshl_b32 s76, s76, 7
    s_add_u32 s76, s76, 393216
    v_add_u32 v42, s76, v42
    v_and_b32 v9, 31, v1
    v_lshlrev_b32 v9, 7, v9
    s_lshr_b32 s76, s2, 5
    s_lshl_b32 s76, s76, 12
    s_add_u32 s76, s76, 458752
    v_add_u32 v9, s76, v9
    v_cmp_lt_u32 vcc, 31, v1
    s_nop 1
    v_cndmask_b32 v42, v42, v9, vcc
    v_xor_b32 v144, 0x80008000, v136
    v_xor_b32 v168, 0x80008000, v160
    v_xor_b32 v145, 0x80008000, v137
    v_xor_b32 v169, 0x80008000, v161
    v_xor_b32 v146, 0x80008000, v138
    v_xor_b32 v170, 0x80008000, v162
    v_xor_b32 v147, 0x80008000, v139
    v_xor_b32 v171, 0x80008000, v163
    v_xor_b32 v148, 0x80008000, v140
    v_xor_b32 v172, 0x80008000, v164
    v_xor_b32 v149, 0x80008000, v141
    v_xor_b32 v173, 0x80008000, v165
    v_xor_b32 v150, 0x80008000, v142
    v_xor_b32 v174, 0x80008000, v166
    v_xor_b32 v151, 0x80008000, v143
    v_xor_b32 v175, 0x80008000, v167
    v_and_b32 v9, 15, v1
    s_lshl_b32 s76, s71, 4
    v_add_u32 v9, s76, v9
    v_lshrrev_b32 v10, 4, v1
    v_lshlrev_b32 v10, 2, v10
    v_mov_b32 v13, 0x3a000000
    v_add_u32 v11, 0, v10
    v_mul_u32_u24 v11, v11, v9
    v_cvt_f32_u32 v11, v11
    v_mul_f32 v11, v11, v13
    v_cos_f32 v224, v11
    v_sin_f32 v232, v11
    v_add_u32 v12, 1, v10
    v_mul_u32_u24 v12, v12, v9
    v_cvt_f32_u32 v12, v12
    v_mul_f32 v12, v12, v13
    v_cos_f32 v225, v12
    v_sin_f32 v233, v12
    v_add_u32 v11, 2, v10
    v_mul_u32_u24 v11, v11, v9
    v_cvt_f32_u32 v11, v11
    v_mul_f32 v11, v11, v13
    v_cos_f32 v226, v11
    v_sin_f32 v234, v11
    v_add_u32 v12, 3, v10
    v_mul_u32_u24 v12, v12, v9
    v_cvt_f32_u32 v12, v12
    v_mul_f32 v12, v12, v13
    v_cos_f32 v227, v12
    v_sin_f32 v235, v12
    v_add_u32 v11, 16, v10
    v_mul_u32_u24 v11, v11, v9
    v_cvt_f32_u32 v11, v11
    v_mul_f32 v11, v11, v13
    v_cos_f32 v228, v11
    v_sin_f32 v236, v11
    v_add_u32 v12, 17, v10
    v_mul_u32_u24 v12, v12, v9
    v_cvt_f32_u32 v12, v12
    v_mul_f32 v12, v12, v13
    v_cos_f32 v229, v12
    v_sin_f32 v237, v12
    v_add_u32 v11, 18, v10
    v_mul_u32_u24 v11, v11, v9
    v_cvt_f32_u32 v11, v11
    v_mul_f32 v11, v11, v13
    v_cos_f32 v230, v11
    v_sin_f32 v238, v11
    v_add_u32 v12, 19, v10
    v_mul_u32_u24 v12, v12, v9
    v_cvt_f32_u32 v12, v12
    v_mul_f32 v12, v12, v13
    v_cos_f32 v231, v12
    v_sin_f32 v239, v12
    s_cmp_eq_u32 s2, 255
    s_mov_b32 s92, 0x36000000
    s_cselect_b32 s92, 0x35800000, s92
    v_and_b32 v9, 15, v1
    v_lshrrev_b32 v10, 3, v9
    v_lshlrev_b32 v10, 5, v10
    v_lshl_add_u32 v9, v9, 6, v10
    v_lshrrev_b32 v10, 4, v1
    v_lshl_add_u32 v9, v10, 3, v9
    s_lshl_b32 s76, s71, 10
    s_add_u32 s76, s76, 139264
    v_add_u32 v9, s76, v9
    v_xor_b32 v10, 32, v9
    v_lshrrev_b32 v11, 4, v1
    v_lshrrev_b32 v12, 2, v1
    v_and_b32 v12, 3, v12
    v_lshl_add_u32 v12, v11, 3, v12
    v_lshlrev_b32 v12, 6, v12
    v_and_b32 v11, 1, v11
    v_lshl_add_u32 v12, v11, 5, v12
    v_and_b32 v11, 3, v1
    v_lshl_add_u32 v12, v11, 3, v12
    v_add_u32 v12, 139264, v12
    v_xor_b32 v13, 32, v12
    v_add_u32 v14, 131072, v2
    v_lshrrev_b32 v11, 4, v1
    v_and_b32 v15, 1, v11
    v_lshlrev_b32 v15, 11, v15
    v_lshrrev_b32 v11, 1, v11
    v_lshl_add_u32 v15, v11, 8, v15
    v_and_b32 v11, 15, v1
    v_lshl_add_u32 v15, v11, 4, v15
    ds_read_b128 v[24:27], v3 offset:16
    s_waitcnt lgkmcnt(0)
    v_min3_u32 v24, v24, v25, v26
    v_min_u32 v24, v24, v27
    s_nop 0
    v_readfirstlane_b32 s89, v24
    s_nop 0
    s_cmp_ge_u32 s89, 17
    s_cbranch_scc1 L_bk_65
L_sl_64:
    s_mov_b32 s100, 0
L_sp_66:
    s_sleep 1
    ds_read_b128 v[24:27], v3 offset:16
    s_waitcnt lgkmcnt(0)
    v_min3_u32 v24, v24, v25, v26
    v_min_u32 v24, v24, v27
    s_nop 0
    v_readfirstlane_b32 s89, v24
    s_nop 0
    s_cmp_ge_u32 s89, 17
    s_cbranch_scc1 L_bk_65
    s_add_u32 s100, s100, 1
    s_cmp_lt_u32 s100, 8388608
    s_cbranch_scc1 L_sp_66
L_bk_65:
    s_cmp_eq_u32 s71, 0
    s_cbranch_scc0 L_on_67
    buffer_load_dword v43, v42, s[12:15], 0 offen sc1
    s_waitcnt vmcnt(0)
    v_cmp_ne_u32 vcc, s68, v43
    s_nop 4
    s_cbranch_vccz L_back_69
L_slow_68:
    s_mov_b32 s89, 0
L_spin_70:
    s_sleep 6
    buffer_load_dword v43, v42, s[12:15], 0 offen sc1
    s_waitcnt vmcnt(0)
    v_cmp_ne_u32 vcc, s68, v43
    s_nop 4
    s_cbranch_vccz L_back_69
    s_add_u32 s89, s89, 1
    s_cmp_lt_u32 s89, 1048576
    s_cbranch_scc1 L_spin_70
L_back_69:
    v_mov_b32 v27, 1
    ds_write_b32 v3, v27 offset:104
L_on_67:
    ds_read_b32 v24, v3 offset:104
    s_waitcnt lgkmcnt(0)
    v_readfirstlane_b32 s89, v24
    s_nop 0
    s_cmp_ge_u32 s89, 1
    s_cbranch_scc1 L_bk_72
L_sl_71:
    s_mov_b32 s100, 0
L_sp_73:
    s_sleep 1
    ds_read_b32 v24, v3 offset:104
    s_waitcnt lgkmcnt(0)
    v_readfirstlane_b32 s89, v24
    s_nop 0
    s_cmp_ge_u32 s89, 1
    s_cbranch_scc1 L_bk_72
    s_add_u32 s100, s100, 1
    s_cmp_lt_u32 s100, 8388608
    s_cbranch_scc1 L_sp_73
L_bk_72:
    s_setprio 2
    s_lshl_b32 s76, s2, 13
    s_lshl_b32 s77, s71, 11
    s_add_u32 s76, s76, s77
    s_add_u32 s78, s76, 9437184
    s_add_u32 m0, s77, 131072
    s_nop 0
    buffer_load_dwordx4 v2, s[12:15], s78 offen sc1 lds
    buffer_load_dwordx4 v2, s[12:15], s78 offen offset:1024 sc1 lds
    s_add_u32 s78, s76, 13631488
    buffer_load_dwordx4 v[240:243], v2, s[12:15], s78 offen sc1
    buffer_load_dwordx4 v[244:247], v2, s[12:15], s78 offen offset:1024 sc1
    s_waitcnt vmcnt(2)
    s_waitcnt lgkmcnt(0)
    v_mov_b32 v27, 2
    ds_write_b32 v4, v27 offset:48
    ds_read_b128 v[24:27], v3 offset:48
    s_waitcnt lgkmcnt(0)
    v_min3_u32 v24, v24, v25, v26
    v_min_u32 v24, v24, v27
    s_nop 0
    v_readfirstlane_b32 s89, v24
    s_nop 0
    s_cmp_ge_u32 s89, 2
    s_cbranch_scc1 L_bk_75
L_sl_74:
    s_mov_b32 s100, 0
L_sp_76:
    s_sleep 1
    ds_read_b128 v[24:27], v3 offset:48
    s_waitcnt lgkmcnt(0)
    v_min3_u32 v24, v24, v25, v26
    v_min_u32 v24, v24, v27
    s_nop 0
    v_readfirstlane_b32 s89, v24
    s_nop 0
    s_cmp_ge_u32 s89, 2
    s_cbranch_scc1 L_bk_75
    s_add_u32 s100, s100, 1
    s_cmp_lt_u32 s100, 8388608
    s_cbranch_scc1 L_sp_76
L_bk_75:
    ds_read_b128 v[176:179], v14 offset:0
    ds_read_b128 v[180:183], v14 offset:1024
    ds_read_b128 v[184:187], v14 offset:2048
    ds_read_b128 v[188:191], v14 offset:3072
    ds_read_b128 v[192:195], v14 offset:4096
    ds_read_b128 v[196:199], v14 offset:5120
    ds_read_b128 v[200:203], v14 offset:6144
    ds_read_b128 v[204:207], v14 offset:7168
    s_waitcnt lgkmcnt(0)
    v_mfma_f32_16x16x32_bf16 v[208:211], v[176:179], v[128:131], 0
    v_mfma_f32_16x16x32_bf16 v[216:219], v[192:195], v[128:131], 0
    v_mfma_f32_16x16x32_bf16 v[208:211], v[180:183], v[132:135], v[208:211]
    v_mfma_f32_16x16x32_bf16 v[216:219], v[196:199], v[132:135], v[216:219]
    v_mfma_f32_16x16x32_bf16 v[208:211], v[192:195], v[136:139], v[208:211]
    v_mfma_f32_16x16x32_bf16 v[216:219], v[176:179], v[144:147], v[216:219]
    v_mfma_f32_16x16x32_bf16 v[208:211], v[196:199], v[140:143], v[208:211]
    v_mfma_f32_16x16x32_bf16 v[216:219], v[180:183], v[148:151], v[216:219]
    v_mfma_f32_16x16x32_bf16 v[212:215], v[184:187], v[128:131], 0
    v_mfma_f32_16x16x32_bf16 v[220:223], v[200:203], v[128:131], 0
    v_mfma_f32_16x16x32_bf16 v[212:215], v[188:191], v[132:135], v[212:215]
    v_mfma_f32_16x16x32_bf16 v[220:223], v[204:207], v[132:135], v[220:223]
    v_mfma_f32_16x16x32_bf16 v[212:215], v[200:203], v[136:139], v[212:215]
    v_mfma_f32_16x16x32_bf16 v[220:223], v[184:187], v[144:147], v[220:223]
    v_mfma_f32_16x16x32_bf16 v[212:215], v[204:207], v[140:143], v[212:215]
    v_mfma_f32_16x16x32_bf16 v[220:223], v[188:191], v[148:151], v[220:223]
    s_waitcnt vmcnt(0)
    v_lshlrev_b32 v80, 16, v240
    v_and_b32 v88, 0xffff0000, v240
    v_mul_f32 v80, s92, v80
    v_mul_f32 v88, s92, v88
    v_lshlrev_b32 v81, 16, v241
    v_and_b32 v89, 0xffff0000, v241
    v_mul_f32 v81, s92, v81
    v_mul_f32 v89, s92, v89
    v_lshlrev_b32 v82, 16, v242
    v_and_b32 v90, 0xffff0000, v242
    v_mul_f32 v82, s92, v82
    v_mul_f32 v90, s92, v90
    v_lshlrev_b32 v83, 16, v243
    v_and_b32 v91, 0xffff0000, v243
    v_mul_f32 v83, s92, v83
    v_mul_f32 v91, s92, v91
    v_lshlrev_b32 v84, 16, v244
    v_and_b32 v92, 0xffff0000, v244
    v_mul_f32 v84, s92, v84
    v_mul_f32 v92, s92, v92
    v_lshlrev_b32 v85, 16, v245
    v_and_b32 v93, 0xffff0000, v245
    v_mul_f32 v85, s92, v85
    v_mul_f32 v93, s92, v93
    v_lshlrev_b32 v86, 16, v246
    v_and_b32 v94, 0xffff0000, v246
    v_mul_f32 v86, s92, v86
    v_mul_f32 v94, s92, v94
    v_lshlrev_b32 v87, 16, v247
    v_and_b32 v95, 0xffff0000, v247
    v_mul_f32 v87, s92, v87
    v_mul_f32 v95, s92, v95
    v_mul_f32 v64, v208, v224
    v_mul_f32 v72, v216, v224
    v_fma_f32 v64, v216, v232, v64
    v_fma_f32 v72, -v208, v232, v72
    v_mul_f32 v65, v209, v225
    v_mul_f32 v73, v217, v225
    v_fma_f32 v65, v217, v233, v65
    v_fma_f32 v73, -v209, v233, v73
    v_mul_f32 v66, v210, v226
    v_mul_f32 v74, v218, v226
    v_fma_f32 v66, v218, v234, v66
    v_fma_f32 v74, -v210, v234, v74
    v_mul_f32 v67, v211, v227
    v_mul_f32 v75, v219, v227
    v_fma_f32 v67, v219, v235, v67
    v_fma_f32 v75, -v211, v235, v75
    v_mul_f32 v68, v212, v228
    v_mul_f32 v76, v220, v228
    v_fma_f32 v68, v220, v236, v68
    v_fma_f32 v76, -v212, v236, v76
    v_mul_f32 v69, v213, v229
    v_mul_f32 v77, v221, v229
    v_fma_f32 v69, v221, v237, v69
    v_fma_f32 v77, -v213, v237, v77
    v_mul_f32 v70, v214, v230
    v_mul_f32 v78, v222, v230
    v_fma_f32 v70, v222, v238, v70
    v_fma_f32 v78, -v214, v238, v78
    v_mul_f32 v71, v215, v231
    v_mul_f32 v79, v223, v231
    v_fma_f32 v71, v223, v239, v71
    v_fma_f32 v79, -v215, v239, v79
    v_cvt_pk_bf16_f32 v248, v64, v65
    v_cvt_pk_bf16_f32 v249, v66, v67
    v_cvt_pk_bf16_f32 v250, v68, v69
    v_cvt_pk_bf16_f32 v251, v70, v71
    v_cvt_pk_bf16_f32 v252, v72, v73
    v_cvt_pk_bf16_f32 v253, v74, v75
    v_cvt_pk_bf16_f32 v254, v76, v77
    v_cvt_pk_bf16_f32 v255, v78, v79
    v_mfma_f32_16x16x32_bf16 v[208:211], v[152:155], v[248:251], 0
    s_nop 0
    v_mfma_f32_16x16x32_bf16 v[216:219], v[152:155], v[252:255], 0
    v_mfma_f32_16x16x32_bf16 v[212:215], v[156:159], v[248:251], 0
    v_mfma_f32_16x16x32_bf16 v[220:223], v[156:159], v[252:255], 0
    v_mfma_f32_16x16x32_bf16 v[208:211], v[160:163], v[252:255], v[208:211]
    v_mfma_f32_16x16x32_bf16 v[216:219], v[168:171], v[248:251], v[216:219]
    v_mfma_f32_16x16x32_bf16 v[212:215], v[164:167], v[252:255], v[212:215]
    v_mfma_f32_16x16x32_bf16 v[220:223], v[172:175], v[248:251], v[220:223]
    s_nop 4
    v_mul_f32 v64, v208, v80
    v_mul_f32 v72, v216, v80
    v_fma_f32 v64, -v216, v88, v64
    v_fma_f32 v72, v208, v88, v72
    v_mul_f32 v65, v209, v81
    v_mul_f32 v73, v217, v81
    v_fma_f32 v65, -v217, v89, v65
    v_fma_f32 v73, v209, v89, v73
    v_mul_f32 v66, v210, v82
    v_mul_f32 v74, v218, v82
    v_fma_f32 v66, -v218, v90, v66
    v_fma_f32 v74, v210, v90, v74
    v_mul_f32 v67, v211, v83
    v_mul_f32 v75, v219, v83
    v_fma_f32 v67, -v219, v91, v67
    v_fma_f32 v75, v211, v91, v75
    v_mul_f32 v68, v212, v84
    v_mul_f32 v76, v220, v84
    v_fma_f32 v68, -v220, v92, v68
    v_fma_f32 v76, v212, v92, v76
    v_mul_f32 v69, v213, v85
    v_mul_f32 v77, v221, v85
    v_fma_f32 v69, -v221, v93, v69
    v_fma_f32 v77, v213, v93, v77
    v_mul_f32 v70, v214, v86
    v_mul_f32 v78, v222, v86
    v_fma_f32 v70, -v222, v94, v70
    v_fma_f32 v78, v214, v94, v78
    v_mul_f32 v71, v215, v87
    v_mul_f32 v79, v223, v87
    v_fma_f32 v71, -v223, v95, v71
    v_fma_f32 v79, v215, v95, v79
    v_cvt_pk_bf16_f32 v248, v64, v65
    v_cvt_pk_bf16_f32 v249, v66, v67
    v_cvt_pk_bf16_f32 v250, v68, v69
    v_cvt_pk_bf16_f32 v251, v70, v71
    v_cvt_pk_bf16_f32 v252, v72, v73
    v_cvt_pk_bf16_f32 v253, v74, v75
    v_cvt_pk_bf16_f32 v254, v76, v77
    v_cvt_pk_bf16_f32 v255, v78, v79
    v_mfma_f32_16x16x32_bf16 v[208:211], v[152:155], v[248:251], 0
    s_nop 0
    v_mfma_f32_16x16x32_bf16 v[216:219], v[152:155], v[252:255], 0
    v_mfma_f32_16x16x32_bf16 v[212:215], v[156:159], v[248:251], 0
    v_mfma_f32_16x16x32_bf16 v[220:223], v[156:159], v[252:255], 0
    v_mfma_f32_16x16x32_bf16 v[208:211], v[168:171], v[252:255], v[208:211]
    v_mfma_f32_16x16x32_bf16 v[216:219], v[160:163], v[248:251], v[216:219]
    v_mfma_f32_16x16x32_bf16 v[212:215], v[172:175], v[252:255], v[212:215]
    v_mfma_f32_16x16x32_bf16 v[220:223], v[164:167], v[248:251], v[220:223]
    s_nop 4
    v_mul_f32 v64, v208, v224
    v_mul_f32 v72, v216, v224
    v_fma_f32 v64, -v216, v232, v64
    v_fma_f32 v72, v208, v232, v72
    v_mul_f32 v65, v209, v225
    v_mul_f32 v73, v217, v225
    v_fma_f32 v65, -v217, v233, v65
    v_fma_f32 v73, v209, v233, v73
    v_mul_f32 v66, v210, v226
    v_mul_f32 v74, v218, v226
    v_fma_f32 v66, -v218, v234, v66
    v_fma_f32 v74, v210, v234, v74
    v_mul_f32 v67, v211, v227
    v_mul_f32 v75, v219, v227
    v_fma_f32 v67, -v219, v235, v67
    v_fma_f32 v75, v211, v235, v75
    v_mul_f32 v68, v212, v228
    v_mul_f32 v76, v220, v228
    v_fma_f32 v68, -v220, v236, v68
    v_fma_f32 v76, v212, v236, v76
    v_mul_f32 v69, v213, v229
    v_mul_f32 v77, v221, v229
    v_fma_f32 v69, -v221, v237, v69
    v_fma_f32 v77, v213, v237, v77
    v_mul_f32 v70, v214, v230
    v_mul_f32 v78, v222, v230
    v_fma_f32 v70, -v222, v238, v70
    v_fma_f32 v78, v214, v238, v78
    v_mul_f32 v71, v215, v231
    v_mul_f32 v79, v223, v231
    v_fma_f32 v71, -v223, v239, v71
    v_fma_f32 v79, v215, v239, v79
    v_cvt_pk_bf16_f32 v248, v64, v65
    v_cvt_pk_bf16_f32 v249, v66, v67
    v_cvt_pk_bf16_f32 v250, v68, v69
    v_cvt_pk_bf16_f32 v251, v70, v71
    v_cvt_pk_bf16_f32 v252, v72, v73
    v_cvt_pk_bf16_f32 v253, v74, v75
    v_cvt_pk_bf16_f32 v254, v76, v77
    v_cvt_pk_bf16_f32 v255, v78, v79
    ds_write_b64 v9, v[248:249] offset:0
    ds_write_b64 v10, v[250:251] offset:0
    ds_write_b64 v9, v[252:253] offset:4096
    ds_write_b64 v10, v[254:255] offset:4096
    s_waitcnt lgkmcnt(0)
    v_mov_b32 v27, 3
    ds_write_b32 v4, v27 offset:48
    ds_read_b128 v[24:27], v3 offset:48
    s_waitcnt lgkmcnt(0)
    v_min3_u32 v24, v24, v25, v26
    v_min_u32 v24, v24, v27
    s_nop 0
    v_readfirstlane_b32 s89, v24
    s_nop 0
    s_cmp_ge_u32 s89, 3
    s_cbranch_scc1 L_bk_78
L_sl_77:
    s_mov_b32 s100, 0
L_sp_79:
    s_sleep 1
    ds_read_b128 v[24:27], v3 offset:48
    s_waitcnt lgkmcnt(0)
    v_min3_u32 v24, v24, v25, v26
    v_min_u32 v24, v24, v27
    s_nop 0
    v_readfirstlane_b32 s89, v24
    s_nop 0
    s_cmp_ge_u32 s89, 3
    s_cbranch_scc1 L_bk_78
    s_add_u32 s100, s100, 1
    s_cmp_lt_u32 s100, 8388608
    s_cbranch_scc1 L_sp_79
L_bk_78:
    ds_read_b64_tr_b16 v[176:177], v12 offset:0
    ds_read_b64_tr_b16 v[178:179], v12 offset:256
    ds_read_b64_tr_b16 v[180:181], v12 offset:2048
    ds_read_b64_tr_b16 v[182:183], v12 offset:2304
    ds_read_b64_tr_b16 v[184:185], v13 offset:0
    ds_read_b64_tr_b16 v[186:187], v13 offset:256
    ds_read_b64_tr_b16 v[188:189], v13 offset:2048
    ds_read_b64_tr_b16 v[190:191], v13 offset:2304
    ds_read_b64_tr_b16 v[192:193], v12 offset:4096
    ds_read_b64_tr_b16 v[194:195], v12 offset:4352
    ds_read_b64_tr_b16 v[196:197], v12 offset:6144
    ds_read_b64_tr_b16 v[198:199], v12 offset:6400
    ds_read_b64_tr_b16 v[200:201], v13 offset:4096
    ds_read_b64_tr_b16 v[202:203], v13 offset:4352
    ds_read_b64_tr_b16 v[204:205], v13 offset:6144
    ds_read_b64_tr_b16 v[206:207], v13 offset:6400
    s_lshl_b32 s76, s2, 13
    s_lshl_b32 s77, s71, 9
    s_add_u32 s76, s76, s77
    s_add_u32 s76, s76, 11534336
    s_add_u32 s77, s76, 4096
    s_waitcnt lgkmcnt(0)
    v_mfma_f32_16x16x32_bf16 v[208:211], v[128:131], v[176:179], 0
    v_mfma_f32_16x16x32_bf16 v[216:219], v[128:131], v[192:195], 0
    v_mfma_f32_16x16x32_bf16 v[208:211], v[132:135], v[180:183], v[208:211]
    v_mfma_f32_16x16x32_bf16 v[216:219], v[132:135], v[196:199], v[216:219]
    v_mfma_f32_16x16x32_bf16 v[208:211], v[144:147], v[192:195], v[208:211]
    v_mfma_f32_16x16x32_bf16 v[216:219], v[136:139], v[176:179], v[216:219]
    v_mfma_f32_16x16x32_bf16 v[208:211], v[148:151], v[196:199], v[208:211]
    v_mfma_f32_16x16x32_bf16 v[216:219], v[140:143], v[180:183], v[216:219]
    v_mfma_f32_16x16x32_bf16 v[212:215], v[128:131], v[184:187], 0
    v_mfma_f32_16x16x32_bf16 v[220:223], v[128:131], v[200:203], 0
    v_mfma_f32_16x16x32_bf16 v[212:215], v[132:135], v[188:191], v[212:215]
    v_mfma_f32_16x16x32_bf16 v[220:223], v[132:135], v[204:207], v[220:223]
    v_mfma_f32_16x16x32_bf16 v[212:215], v[144:147], v[200:203], v[212:215]
    v_mfma_f32_16x16x32_bf16 v[220:223], v[136:139], v[184:187], v[220:223]
    v_mfma_f32_16x16x32_bf16 v[212:215], v[148:151], v[204:207], v[212:215]
    v_mfma_f32_16x16x32_bf16 v[220:223], v[140:143], v[188:191], v[220:223]
    v_cvt_pk_bf16_f32 v248, v208, v209
    v_cvt_pk_bf16_f32 v249, v210, v211
    s_nop 4
    v_cvt_pk_bf16_f32 v250, v212, v213
    v_cvt_pk_bf16_f32 v251, v214, v215
    v_cvt_pk_bf16_f32 v252, v216, v217
    v_cvt_pk_bf16_f32 v253, v218, v219
    v_cvt_pk_bf16_f32 v254, v220, v221
    v_cvt_pk_bf16_f32 v255, v222, v223
    v_permlane16_swap_b32 v248, v250
    v_permlane16_swap_b32 v249, v251
    buffer_store_dwordx4 v[248:251], v15, s[12:15], s76 offen sc1
    v_permlane16_swap_b32 v252, v254
    v_permlane16_swap_b32 v253, v255
    buffer_store_dwordx4 v[252:255], v15, s[12:15], s77 offen sc1
    s_waitcnt vmcnt(0)
    s_mov_b32 s79, s2
    v_mov_b32 v24, 1
    s_mov_b64 exec, 1
    ds_add_rtn_u32 v25, v3, v24 offset:76
    s_mov_b64 exec, -1
    s_waitcnt lgkmcnt(0)
    v_readfirstlane_b32 s80, v25
    s_nop 0
    s_cmp_lg_u32 s80, 3
    s_cbranch_scc1 L_nl_80
    s_lshl_b32 s80, s79, 7
    s_add_u32 s80, s80, 491520
    v_mov_b32 v28, s68
    v_mov_b32 v29, 0
    s_mov_b64 exec, 1
    buffer_store_dword v28, v29, s[12:15], s80 offen sc1
    s_mov_b64 exec, -1
L_nl_80:
    s_endpgm
L_compute:
    s_waitcnt lgkmcnt(0)
    s_add_u32 s68, s68, 1
    s_mov_b32 s24, s60
    s_mov_b32 s25, s61
    s_mov_b32 s26, 1835008
    s_mov_b32 s27, 0x00020000
    s_mov_b32 s28, s62
    s_mov_b32 s29, s63
    s_mov_b32 s30, 2097152
    s_mov_b32 s31, 0x00020000
    v_and_b32 v8, 31, v1
    v_lshrrev_b32 v9, 5, v1
    v_lshrrev_b32 v10, 1, v8
    v_and_b32 v10, 7, v10
    v_xor_b32 v10, v10, v9
    s_lshl_b32 s76, s72, 13
    v_lshlrev_b32 v11, 7, v8
    v_add_u32 v11, s76, v11
    v_xor_b32 v12, 0, v10
    v_lshl_add_u32 v30, v12, 4, v11
    v_xor_b32 v12, 2, v10
    v_lshl_add_u32 v31, v12, 4, v11
    v_xor_b32 v12, 4, v10
    v_lshl_add_u32 v32, v12, 4, v11
    v_xor_b32 v12, 6, v10
    v_lshl_add_u32 v33, v12, 4, v11
    v_lshrrev_b32 v8, 2, v1
    v_and_b32 v8, 3, v8
    v_lshrrev_b32 v9, 5, v1
    v_lshlrev_b32 v9, 3, v9
    v_add_u32 v9, v9, v8
    v_lshlrev_b32 v9, 7, v9
    v_lshrrev_b32 v8, 1, v8
    v_xor_b32 v8, s73, v8
    v_lshl_add_u32 v9, v8, 6, v9
    v_and_b32 v8, 16, v1
    v_lshl_add_u32 v9, v8, 1, v9
    v_and_b32 v8, 3, v1
    v_lshl_add_u32 v9, v8, 3, v9
    v_add_u32 v34, 65536, v9
    s_sub_u32 s35, s3, s44
    s_cmp_lt_u32 s70, 4
    s_cbranch_scc1 L_c_dft
    v_and_b32 v16, 31, v1
    v_mov_b32 v17, 0x3f803f80
    v_cmp_eq_u32 vcc, 0, v16
    s_nop 1
    v_cndmask_b32 v8, 0, v17, vcc
    v_cndmask_b32 v9, 0, v17, vcc
    v_cndmask_b32 v10, 0, v17, vcc
    v_cndmask_b32 v11, 0, v17, vcc
    v_cmp_eq_u32 vcc, 1, v16
    s_nop 1
    v_cndmask_b32 v12, 0, v17, vcc
    v_cndmask_b32 v13, 0, v17, vcc
    v_cndmask_b32 v14, 0, v17, vcc
    v_cndmask_b32 v15, 0, v17, vcc
    ds_read_b64 v[24:25], v3 offset:96
    s_waitcnt lgkmcnt(0)
    v_min_u32 v24, v24, v25
    s_nop 0
    v_readfirstlane_b32 s89, v24
    s_nop 0
    s_cmp_ge_u32 s89, 1
    s_cbranch_scc1 L_bk_82
L_sl_81:
    s_mov_b32 s100, 0
L_sp_83:
    ds_read_b64 v[24:25], v3 offset:96
    s_waitcnt lgkmcnt(0)
    v_min_u32 v24, v24, v25
    s_nop 0
    v_readfirstlane_b32 s89, v24
    s_nop 0
    s_cmp_ge_u32 s89, 1
    s_cbranch_scc1 L_bk_82
    s_add_u32 s100, s100, 1
    s_cmp_lt_u32 s100, 8388608
    s_cbranch_scc1 L_sp_83
L_bk_82:
    ds_read_b128 v[40:43], v30 offset:0
    ds_read_b128 v[44:47], v30 offset:4096
    ds_read_b64_tr_b16 v[48:49], v34 offset:0
    ds_read_b64_tr_b16 v[50:51], v34 offset:512
    ds_read_b64_tr_b16 v[52:53], v34 offset:4096
    ds_read_b64_tr_b16 v[54:55], v34 offset:4608
    ds_read_b64_tr_b16 v[56:57], v34 offset:8192
    ds_read_b64_tr_b16 v[58:59], v34 offset:8704
    ds_read_b64_tr_b16 v[60:61], v34 offset:12288
    ds_read_b64_tr_b16 v[62:63], v34 offset:12800
    s_waitcnt lgkmcnt(0)
    v_mfma_f32_32x32x16_bf16 v[128:143], v[48:51], v[40:43], 0
    ds_read_b128 v[64:67], v31 offset:0
    ds_read_b128 v[68:71], v31 offset:4096
    v_mfma_f32_32x32x16_bf16 v[144:159], v[48:51], v[44:47], 0
    ds_read_b64_tr_b16 v[72:73], v34 offset:2048
    ds_read_b64_tr_b16 v[74:75], v34 offset:2560
    v_mfma_f32_32x32x16_bf16 v[160:175], v[52:55], v[40:43], 0
    ds_read_b64_tr_b16 v[76:77], v34 offset:6144
    ds_read_b64_tr_b16 v[78:79], v34 offset:6656
    v_mfma_f32_32x32x16_bf16 v[176:191], v[52:55], v[44:47], 0
    ds_read_b64_tr_b16 v[80:81], v34 offset:10240
    ds_read_b64_tr_b16 v[82:83], v34 offset:10752
    v_mfma_f32_32x32x16_bf16 v[192:207], v[56:59], v[40:43], 0
    ds_read_b64_tr_b16 v[84:85], v34 offset:14336
    ds_read_b64_tr_b16 v[86:87], v34 offset:14848
    v_mfma_f32_32x32x16_bf16 v[208:223], v[56:59], v[44:47], 0
    ds_read_b64 v[24:25], v3 offset:96
    v_mfma_f32_32x32x16_bf16 v[224:239], v[60:63], v[40:43], 0
    v_mfma_f32_32x32x16_bf16 v[240:255], v[60:63], v[44:47], 0
    s_cmp_lg_u32 s35, 0
    s_cbranch_scc1 L_cj_85
    s_cmp_eq_u32 s72, 0
    s_cbranch_scc0 L_cw_84
    v_mfma_f32_32x32x16_bf16 v[112:127], v[8:11], v[48:51], 0
    v_mfma_f32_32x32x16_bf16 v[112:127], v[12:15], v[52:55], v[112:127]
    s_branch L_cj_85
L_cw_84:
    v_mfma_f32_32x32x16_bf16 v[112:127], v[8:11], v[56:59], 0
    v_mfma_f32_32x32x16_bf16 v[112:127], v[12:15], v[60:63], v[112:127]
L_cj_85:
    s_waitcnt lgkmcnt(1)
    v_mfma_f32_32x32x16_bf16 v[128:143], v[72:75], v[64:67], v[128:143]
    v_mov_b32 v23, 1
    ds_write_b32 v4, v23 offset:16
    v_mfma_f32_32x32x16_bf16 v[144:159], v[72:75], v[68:71], v[144:159]
    s_waitcnt lgkmcnt(1)
    v_min_u32 v24, v24, v25
    s_nop 0
    v_readfirstlane_b32 s89, v24
    s_nop 0
    s_cmp_ge_u32 s89, 2
    s_cbranch_scc1 L_bk_87
L_sl_86:
    s_mov_b32 s100, 0
L_sp_88:
    ds_read_b64 v[24:25], v3 offset:96
    s_waitcnt lgkmcnt(0)
    v_min_u32 v24, v24, v25
    s_nop 0
    v_readfirstlane_b32 s89, v24
    s_nop 0
    s_cmp_ge_u32 s89, 2
    s_cbranch_scc1 L_bk_87
    s_add_u32 s100, s100, 1
    s_cmp_lt_u32 s100, 8388608
    s_cbranch_scc1 L_sp_88
L_bk_87:
    v_mfma_f32_32x32x16_bf16 v[160:175], v[76:79], v[64:67], v[160:175]
    ds_read_b128 v[88:91], v32 offset:0
    ds_read_b128 v[92:95], v32 offset:4096
    v_mfma_f32_32x32x16_bf16 v[176:191], v[76:79], v[68:71], v[176:191]
    ds_read_b64_tr_b16 v[96:97], v34 offset:16384
    ds_read_b64_tr_b16 v[98:99], v34 offset:16896
    v_mfma_f32_32x32x16_bf16 v[192:207], v[80:83], v[64:67], v[192:207]
    ds_read_b64_tr_b16 v[100:101], v34 offset:20480
    ds_read_b64_tr_b16 v[102:103], v34 offset:20992
    v_mfma_f32_32x32x16_bf16 v[208:223], v[80:83], v[68:71], v[208:223]
    ds_read_b64_tr_b16 v[104:105], v34 offset:24576
    ds_read_b64_tr_b16 v[106:107], v34 offset:25088
    v_mfma_f32_32x32x16_bf16 v[224:239], v[84:87], v[64:67], v[224:239]
    ds_read_b64_tr_b16 v[108:109], v34 offset:28672
    ds_read_b64_tr_b16 v[110:111], v34 offset:29184
    v_mfma_f32_32x32x16_bf16 v[240:255], v[84:87], v[68:71], v[240:255]
    s_cmp_lg_u32 s35, 0
    s_cbranch_scc1 L_cj_90
    s_cmp_eq_u32 s72, 0
    s_cbranch_scc0 L_cw_89
    v_mfma_f32_32x32x16_bf16 v[112:127], v[8:11], v[72:75], v[112:127]
    v_mfma_f32_32x32x16_bf16 v[112:127], v[12:15], v[76:79], v[112:127]
    s_branch L_cj_90
L_cw_89:
    v_mfma_f32_32x32x16_bf16 v[112:127], v[8:11], v[80:83], v[112:127]
    v_mfma_f32_32x32x16_bf16 v[112:127], v[12:15], v[84:87], v[112:127]
L_cj_90:
    s_waitcnt lgkmcnt(0)
    v_mfma_f32_32x32x16_bf16 v[128:143], v[96:99], v[88:91], v[128:143]
    ds_read_b128 v[40:43], v33 offset:0
    ds_read_b128 v[44:47], v33 offset:4096
    v_mfma_f32_32x32x16_bf16 v[144:159], v[96:99], v[92:95], v[144:159]
    ds_read_b64_tr_b16 v[48:49], v34 offset:18432
    ds_read_b64_tr_b16 v[50:51], v34 offset:18944
    v_mfma_f32_32x32x16_bf16 v[160:175], v[100:103], v[88:91], v[160:175]
    ds_read_b64_tr_b16 v[52:53], v34 offset:22528
    ds_read_b64_tr_b16 v[54:55], v34 offset:23040
    v_mfma_f32_32x32x16_bf16 v[176:191], v[100:103], v[92:95], v[176:191]
    ds_read_b64_tr_b16 v[56:57], v34 offset:26624
    ds_read_b64_tr_b16 v[58:59], v34 offset:27136
    v_mfma_f32_32x32x16_bf16 v[192:207], v[104:107], v[88:91], v[192:207]
    ds_read_b64_tr_b16 v[60:61], v34 offset:30720
    ds_read_b64_tr_b16 v[62:63], v34 offset:31232
    v_mfma_f32_32x32x16_bf16 v[208:223], v[104:107], v[92:95], v[208:223]
    ds_read_b32 v24, v3 offset:8
    v_mfma_f32_32x32x16_bf16 v[224:239], v[108:111], v[88:91], v[224:239]
    v_mfma_f32_32x32x16_bf16 v[240:255], v[108:111], v[92:95], v[240:255]
    s_cmp_lg_u32 s35, 0
    s_cbranch_scc1 L_cj_92
    s_cmp_eq_u32 s72, 0
    s_cbranch_scc0 L_cw_91
    v_mfma_f32_32x32x16_bf16 v[112:127], v[8:11], v[96:99], v[112:127]
    v_mfma_f32_32x32x16_bf16 v[112:127], v[12:15], v[100:103], v[112:127]
    s_branch L_cj_92
L_cw_91:
    v_mfma_f32_32x32x16_bf16 v[112:127], v[8:11], v[104:107], v[112:127]
    v_mfma_f32_32x32x16_bf16 v[112:127], v[12:15], v[108:111], v[112:127]
L_cj_92:
    s_waitcnt lgkmcnt(1)
    v_mfma_f32_32x32x16_bf16 v[128:143], v[48:51], v[40:43], v[128:143]
    v_mov_b32 v23, 2
    ds_write_b32 v4, v23 offset:16
    v_mfma_f32_32x32x16_bf16 v[144:159], v[48:51], v[44:47], v[144:159]
    s_waitcnt lgkmcnt(1)
    v_readfirstlane_b32 s89, v24
    s_nop 0
    s_cmp_ge_u32 s89, 1
    s_cbranch_scc1 L_bk_94
L_sl_93:
    s_mov_b32 s100, 0
L_sp_95:
    s_sleep 1
    ds_read_b32 v24, v3 offset:8
    s_waitcnt lgkmcnt(0)
    v_readfirstlane_b32 s89, v24
    s_nop 0
    s_cmp_ge_u32 s89, 1
    s_cbranch_scc1 L_bk_94
    s_add_u32 s100, s100, 1
    s_cmp_lt_u32 s100, 8388608
    s_cbranch_scc1 L_sp_95
L_bk_94:
    v_mfma_f32_32x32x16_bf16 v[160:175], v[52:55], v[40:43], v[160:175]
    ds_read_b128 v[64:67], v30 offset:16384
    ds_read_b128 v[68:71], v30 offset:20480
    v_mfma_f32_32x32x16_bf16 v[176:191], v[52:55], v[44:47], v[176:191]
    ds_read_b64_tr_b16 v[72:73], v34 offset:32768
    ds_read_b64_tr_b16 v[74:75], v34 offset:33280
    v_mfma_f32_32x32x16_bf16 v[192:207], v[56:59], v[40:43], v[192:207]
    ds_read_b64_tr_b16 v[76:77], v34 offset:36864
    ds_read_b64_tr_b16 v[78:79], v34 offset:37376
    v_mfma_f32_32x32x16_bf16 v[208:223], v[56:59], v[44:47], v[208:223]
    ds_read_b64_tr_b16 v[80:81], v34 offset:40960
    ds_read_b64_tr_b16 v[82:83], v34 offset:41472
    v_mfma_f32_32x32x16_bf16 v[224:239], v[60:63], v[40:43], v[224:239]
    ds_read_b64_tr_b16 v[84:85], v34 offset:45056
    ds_read_b64_tr_b16 v[86:87], v34 offset:45568
    v_mfma_f32_32x32x16_bf16 v[240:255], v[60:63], v[44:47], v[240:255]
    s_cmp_lg_u32 s35, 0
    s_cbranch_scc1 L_cj_97
    s_cmp_eq_u32 s72, 0
    s_cbranch_scc0 L_cw_96
    v_mfma_f32_32x32x16_bf16 v[112:127], v[8:11], v[48:51], v[112:127]
    v_mfma_f32_32x32x16_bf16 v[112:127], v[12:15], v[52:55], v[112:127]
    s_branch L_cj_97
L_cw_96:
    v_mfma_f32_32x32x16_bf16 v[112:127], v[8:11], v[56:59], v[112:127]
    v_mfma_f32_32x32x16_bf16 v[112:127], v[12:15], v[60:63], v[112:127]
L_cj_97:
    s_waitcnt lgkmcnt(0)
    v_mfma_f32_32x32x16_bf16 v[128:143], v[72:75], v[64:67], v[128:143]
    ds_read_b128 v[88:91], v31 offset:16384
    ds_read_b128 v[92:95], v31 offset:20480
    v_mfma_f32_32x32x16_bf16 v[144:159], v[72:75], v[68:71], v[144:159]
    ds_read_b64_tr_b16 v[96:97], v34 offset:34816
    ds_read_b64_tr_b16 v[98:99], v34 offset:35328
    v_mfma_f32_32x32x16_bf16 v[160:175], v[76:79], v[64:67], v[160:175]
    ds_read_b64_tr_b16 v[100:101], v34 offset:38912
    ds_read_b64_tr_b16 v[102:103], v34 offset:39424
    v_mfma_f32_32x32x16_bf16 v[176:191], v[76:79], v[68:71], v[176:191]
    ds_read_b64_tr_b16 v[104:105], v34 offset:43008
    ds_read_b64_tr_b16 v[106:107], v34 offset:43520
    v_mfma_f32_32x32x16_bf16 v[192:207], v[80:83], v[64:67], v[192:207]
    ds_read_b64_tr_b16 v[108:109], v34 offset:47104
    ds_read_b64_tr_b16 v[110:111], v34 offset:47616
    v_mfma_f32_32x32x16_bf16 v[208:223], v[80:83], v[68:71], v[208:223]
    ds_read_b32 v24, v3 offset:12
    v_mfma_f32_32x32x16_bf16 v[224:239], v[84:87], v[64:67], v[224:239]
    v_mfma_f32_32x32x16_bf16 v[240:255], v[84:87], v[68:71], v[240:255]
    s_cmp_lg_u32 s35, 1
    s_cbranch_scc1 L_cj_99
    s_cmp_eq_u32 s72, 0
    s_cbranch_scc0 L_cw_98
    v_mfma_f32_32x32x16_bf16 v[112:127], v[8:11], v[72:75], 0
    v_mfma_f32_32x32x16_bf16 v[112:127], v[12:15], v[76:79], v[112:127]
    s_branch L_cj_99
L_cw_98:
    v_mfma_f32_32x32x16_bf16 v[112:127], v[8:11], v[80:83], 0
    v_mfma_f32_32x32x16_bf16 v[112:127], v[12:15], v[84:87], v[112:127]
L_cj_99:
    s_waitcnt lgkmcnt(1)
    v_mfma_f32_32x32x16_bf16 v[128:143], v[96:99], v[88:91], v[128:143]
    v_mov_b32 v23, 3
    ds_write_b32 v4, v23 offset:16
    v_mfma_f32_32x32x16_bf16 v[144:159], v[96:99], v[92:95], v[144:159]
    s_waitcnt lgkmcnt(1)
    v_readfirstlane_b32 s89, v24
    s_nop 0
    s_cmp_ge_u32 s89, 1
    s_cbranch_scc1 L_bk_101
L_sl_100:
    s_mov_b32 s100, 0
L_sp_102:
    s_sleep 1
    ds_read_b32 v24, v3 offset:12
    s_waitcnt lgkmcnt(0)
    v_readfirstlane_b32 s89, v24
    s_nop 0
    s_cmp_ge_u32 s89, 1
    s_cbranch_scc1 L_bk_101
    s_add_u32 s100, s100, 1
    s_cmp_lt_u32 s100, 8388608
    s_cbranch_scc1 L_sp_102
L_bk_101:
    v_mfma_f32_32x32x16_bf16 v[160:175], v[100:103], v[88:91], v[160:175]
    ds_read_b128 v[40:43], v32 offset:16384
    ds_read_b128 v[44:47], v32 offset:20480
    v_mfma_f32_32x32x16_bf16 v[176:191], v[100:103], v[92:95], v[176:191]
    ds_read_b64_tr_b16 v[48:49], v34 offset:49152
    ds_read_b64_tr_b16 v[50:51], v34 offset:49664
    v_mfma_f32_32x32x16_bf16 v[192:207], v[104:107], v[88:91], v[192:207]
    ds_read_b64_tr_b16 v[52:53], v34 offset:53248
    ds_read_b64_tr_b16 v[54:55], v34 offset:53760
    v_mfma_f32_32x32x16_bf16 v[208:223], v[104:107], v[92:95], v[208:223]
    ds_read_b64_tr_b16 v[56:57], v34 offset:57344
    ds_read_b64_tr_b16 v[58:59], v34 offset:57856
    v_mfma_f32_32x32x16_bf16 v[224:239], v[108:111], v[88:91], v[224:239]
    ds_read_b64_tr_b16 v[60:61], v34 offset:61440
    ds_read_b64_tr_b16 v[62:63], v34 offset:61952
    v_mfma_f32_32x32x16_bf16 v[240:255], v[108:111], v[92:95], v[240:255]
    s_cmp_lg_u32 s35, 1
    s_cbranch_scc1 L_cj_104
    s_cmp_eq_u32 s72, 0
    s_cbranch_scc0 L_cw_103
    v_mfma_f32_32x32x16_bf16 v[112:127], v[8:11], v[96:99], v[112:127]
    v_mfma_f32_32x32x16_bf16 v[112:127], v[12:15], v[100:103], v[112:127]
    s_branch L_cj_104
L_cw_103:
    v_mfma_f32_32x32x16_bf16 v[112:127], v[8:11], v[104:107], v[112:127]
    v_mfma_f32_32x32x16_bf16 v[112:127], v[12:15], v[108:111], v[112:127]
L_cj_104:
    s_cmp_lg_u32 s35, 0
    s_cbranch_scc1 L_cp_105
    s_add_u32 s76, s85, s72
    s_lshl_b32 s76, s76, 1
    s_lshl_b32 s76, s76, 3
    s_add_u32 s76, s76, s3
    s_lshl_b32 s76, s76, 9
    s_lshl_b32 s77, s73, 8
    s_add_u32 s76, s76, s77
    s_add_u32 s76, s76, 131072
    s_add_u32 s77, s76, 4096
    v_lshlrev_b32 v18, 3, v1
    v_mov_b32 v114, v113
    v_mov_b32 v113, s68
    v_mov_b32 v115, s68
    s_mov_b32 exec_hi, 0
    buffer_store_dwordx2 v[112:113], v18, s[12:15], s76 offen sc1
    buffer_store_dwordx2 v[114:115], v18, s[12:15], s77 offen sc1
    s_mov_b32 exec_hi, -1
L_cp_105:
    s_waitcnt lgkmcnt(0)
    v_mfma_f32_32x32x16_bf16 v[128:143], v[48:51], v[40:43], v[128:143]
    ds_read_b128 v[64:67], v33 offset:16384
    ds_read_b128 v[68:71], v33 offset:20480
    v_mfma_f32_32x32x16_bf16 v[144:159], v[48:51], v[44:47], v[144:159]
    ds_read_b64_tr_b16 v[72:73], v34 offset:51200
    ds_read_b64_tr_b16 v[74:75], v34 offset:51712
    v_mfma_f32_32x32x16_bf16 v[160:175], v[52:55], v[40:43], v[160:175]
    ds_read_b64_tr_b16 v[76:77], v34 offset:55296
    ds_read_b64_tr_b16 v[78:79], v34 offset:55808
    v_mfma_f32_32x32x16_bf16 v[176:191], v[52:55], v[44:47], v[176:191]
    ds_read_b64_tr_b16 v[80:81], v34 offset:59392
    ds_read_b64_tr_b16 v[82:83], v34 offset:59904
    v_mfma_f32_32x32x16_bf16 v[192:207], v[56:59], v[40:43], v[192:207]
    ds_read_b64_tr_b16 v[84:85], v34 offset:63488
    ds_read_b64_tr_b16 v[86:87], v34 offset:64000
    v_mfma_f32_32x32x16_bf16 v[208:223], v[56:59], v[44:47], v[208:223]
    ds_read_b32 v24, v3 offset:0
    v_mfma_f32_32x32x16_bf16 v[224:239], v[60:63], v[40:43], v[224:239]
    v_mfma_f32_32x32x16_bf16 v[240:255], v[60:63], v[44:47], v[240:255]
    s_cmp_lg_u32 s35, 1
    s_cbranch_scc1 L_cj_107
    s_cmp_eq_u32 s72, 0
    s_cbranch_scc0 L_cw_106
    v_mfma_f32_32x32x16_bf16 v[112:127], v[8:11], v[48:51], v[112:127]
    v_mfma_f32_32x32x16_bf16 v[112:127], v[12:15], v[52:55], v[112:127]
    s_branch L_cj_107
L_cw_106:
    v_mfma_f32_32x32x16_bf16 v[112:127], v[8:11], v[56:59], v[112:127]
    v_mfma_f32_32x32x16_bf16 v[112:127], v[12:15], v[60:63], v[112:127]
L_cj_107:
    s_waitcnt lgkmcnt(1)
    v_mfma_f32_32x32x16_bf16 v[128:143], v[72:75], v[64:67], v[128:143]
    v_mov_b32 v23, 4
    ds_write_b32 v4, v23 offset:16
    v_mfma_f32_32x32x16_bf16 v[144:159], v[72:75], v[68:71], v[144:159]
    s_waitcnt lgkmcnt(1)
    v_readfirstlane_b32 s89, v24
    s_nop 0
    s_cmp_ge_u32 s89, 2
    s_cbranch_scc1 L_bk_109
L_sl_108:
    s_mov_b32 s100, 0
L_sp_110:
    s_sleep 1
    ds_read_b32 v24, v3 offset:0
    s_waitcnt lgkmcnt(0)
    v_readfirstlane_b32 s89, v24
    s_nop 0
    s_cmp_ge_u32 s89, 2
    s_cbranch_scc1 L_bk_109
    s_add_u32 s100, s100, 1
    s_cmp_lt_u32 s100, 8388608
    s_cbranch_scc1 L_sp_110
L_bk_109:
    ds_read_b32 v24, v3 offset:124
    s_waitcnt lgkmcnt(0)
    v_readfirstlane_b32 s89, v24
    s_nop 0
    s_cmp_ge_u32 s89, 1
    s_cbranch_scc1 L_bk_112
L_sl_111:
    s_mov_b32 s100, 0
L_sp_113:
    s_sleep 1
    ds_read_b32 v24, v3 offset:124
    s_waitcnt lgkmcnt(0)
    v_readfirstlane_b32 s89, v24
    s_nop 0
    s_cmp_ge_u32 s89, 1
    s_cbranch_scc1 L_bk_112
    s_add_u32 s100, s100, 1
    s_cmp_lt_u32 s100, 8388608
    s_cbranch_scc1 L_sp_113
L_bk_112:
    v_mfma_f32_32x32x16_bf16 v[160:175], v[76:79], v[64:67], v[160:175]
    ds_read_b128 v[88:91], v30 offset:32768
    ds_read_b128 v[92:95], v30 offset:36864
    v_mfma_f32_32x32x16_bf16 v[176:191], v[76:79], v[68:71], v[176:191]
    ds_read_b64_tr_b16 v[96:97], v34 offset:0
    ds_read_b64_tr_b16 v[98:99], v34 offset:512
    v_mfma_f32_32x32x16_bf16 v[192:207], v[80:83], v[64:67], v[192:207]
    ds_read_b64_tr_b16 v[100:101], v34 offset:4096
    ds_read_b64_tr_b16 v[102:103], v34 offset:4608
    v_mfma_f32_32x32x16_bf16 v[208:223], v[80:83], v[68:71], v[208:223]
    ds_read_b64_tr_b16 v[104:105], v34 offset:8192
    ds_read_b64_tr_b16 v[106:107], v34 offset:8704
    v_mfma_f32_32x32x16_bf16 v[224:239], v[84:87], v[64:67], v[224:239]
    ds_read_b64_tr_b16 v[108:109], v34 offset:12288
    ds_read_b64_tr_b16 v[110:111], v34 offset:12800
    v_mfma_f32_32x32x16_bf16 v[240:255], v[84:87], v[68:71], v[240:255]
    s_cmp_lg_u32 s35, 1
    s_cbranch_scc1 L_cj_115
    s_cmp_eq_u32 s72, 0
    s_cbranch_scc0 L_cw_114
    v_mfma_f32_32x32x16_bf16 v[112:127], v[8:11], v[72:75], v[112:127]
    v_mfma_f32_32x32x16_bf16 v[112:127], v[12:15], v[76:79], v[112:127]
    s_branch L_cj_115
L_cw_114:
    v_mfma_f32_32x32x16_bf16 v[112:127], v[8:11], v[80:83], v[112:127]
    v_mfma_f32_32x32x16_bf16 v[112:127], v[12:15], v[84:87], v[112:127]
L_cj_115:
    s_waitcnt lgkmcnt(0)
    v_mfma_f32_32x32x16_bf16 v[128:143], v[96:99], v[88:91], v[128:143]
    ds_read_b128 v[40:43], v31 offset:32768
    ds_read_b128 v[44:47], v31 offset:36864
    v_mfma_f32_32x32x16_bf16 v[144:159], v[96:99], v[92:95], v[144:159]
    ds_read_b64_tr_b16 v[48:49], v34 offset:2048
    ds_read_b64_tr_b16 v[50:51], v34 offset:2560
    v_mfma_f32_32x32x16_bf16 v[160:175], v[100:103], v[88:91], v[160:175]
    ds_read_b64_tr_b16 v[52:53], v34 offset:6144
    ds_read_b64_tr_b16 v[54:55], v34 offset:6656
    v_mfma_f32_32x32x16_bf16 v[176:191], v[100:103], v[92:95], v[176:191]
    ds_read_b64_tr_b16 v[56:57], v34 offset:10240
    ds_read_b64_tr_b16 v[58:59], v34 offset:10752
    v_mfma_f32_32x32x16_bf16 v[192:207], v[104:107], v[88:91], v[192:207]
    ds_read_b64_tr_b16 v[60:61], v34 offset:14336
    ds_read_b64_tr_b16 v[62:63], v34 offset:14848
    v_mfma_f32_32x32x16_bf16 v[208:223], v[104:107], v[92:95], v[208:223]
    ds_read_b32 v24, v3 offset:4
    v_mfma_f32_32x32x16_bf16 v[224:239], v[108:111], v[88:91], v[224:239]
    v_mfma_f32_32x32x16_bf16 v[240:255], v[108:111], v[92:95], v[240:255]
    s_waitcnt lgkmcnt(1)
    v_mfma_f32_32x32x16_bf16 v[128:143], v[48:51], v[40:43], v[128:143]
    v_mov_b32 v23, 5
    ds_write_b32 v4, v23 offset:16
    v_mfma_f32_32x32x16_bf16 v[144:159], v[48:51], v[44:47], v[144:159]
    s_waitcnt lgkmcnt(1)
    v_readfirstlane_b32 s89, v24
    s_nop 0
    s_cmp_ge_u32 s89, 2
    s_cbranch_scc1 L_bk_117
L_sl_116:
    s_mov_b32 s100, 0
L_sp_118:
    s_sleep 1
    ds_read_b32 v24, v3 offset:4
    s_waitcnt lgkmcnt(0)
    v_readfirstlane_b32 s89, v24
    s_nop 0
    s_cmp_ge_u32 s89, 2
    s_cbranch_scc1 L_bk_117
    s_add_u32 s100, s100, 1
    s_cmp_lt_u32 s100, 8388608
    s_cbranch_scc1 L_sp_118
L_bk_117:
    v_mfma_f32_32x32x16_bf16 v[160:175], v[52:55], v[40:43], v[160:175]
    ds_read_b128 v[64:67], v32 offset:32768
    ds_read_b128 v[68:71], v32 offset:36864
    v_mfma_f32_32x32x16_bf16 v[176:191], v[52:55], v[44:47], v[176:191]
    ds_read_b64_tr_b16 v[72:73], v34 offset:16384
    ds_read_b64_tr_b16 v[74:75], v34 offset:16896
    v_mfma_f32_32x32x16_bf16 v[192:207], v[56:59], v[40:43], v[192:207]
    ds_read_b64_tr_b16 v[76:77], v34 offset:20480
    ds_read_b64_tr_b16 v[78:79], v34 offset:20992
    v_mfma_f32_32x32x16_bf16 v[208:223], v[56:59], v[44:47], v[208:223]
    ds_read_b64_tr_b16 v[80:81], v34 offset:24576
    ds_read_b64_tr_b16 v[82:83], v34 offset:25088
    v_mfma_f32_32x32x16_bf16 v[224:239], v[60:63], v[40:43], v[224:239]
    ds_read_b64_tr_b16 v[84:85], v34 offset:28672
    ds_read_b64_tr_b16 v[86:87], v34 offset:29184
    v_mfma_f32_32x32x16_bf16 v[240:255], v[60:63], v[44:47], v[240:255]
    s_cmp_lg_u32 s35, 1
    s_cbranch_scc1 L_cp_119
    s_add_u32 s76, s85, s72
    s_lshl_b32 s76, s76, 1
    s_lshl_b32 s76, s76, 3
    s_add_u32 s76, s76, s3
    s_lshl_b32 s76, s76, 9
    s_lshl_b32 s77, s73, 8
    s_add_u32 s76, s76, s77
    s_add_u32 s76, s76, 131072
    s_add_u32 s77, s76, 4096
    v_lshlrev_b32 v18, 3, v1
    v_mov_b32 v114, v113
    v_mov_b32 v113, s68
    v_mov_b32 v115, s68
    s_mov_b32 exec_hi, 0
    buffer_store_dwordx2 v[112:113], v18, s[12:15], s76 offen sc1
    buffer_store_dwordx2 v[114:115], v18, s[12:15], s77 offen sc1
    s_mov_b32 exec_hi, -1
L_cp_119:
    s_waitcnt lgkmcnt(0)
    v_mfma_f32_32x32x16_bf16 v[128:143], v[72:75], v[64:67], v[128:143]
    ds_read_b128 v[88:91], v33 offset:32768
    ds_read_b128 v[92:95], v33 offset:36864
    v_mfma_f32_32x32x16_bf16 v[144:159], v[72:75], v[68:71], v[144:159]
    ds_read_b64_tr_b16 v[96:97], v34 offset:18432
    ds_read_b64_tr_b16 v[98:99], v34 offset:18944
    v_mfma_f32_32x32x16_bf16 v[160:175], v[76:79], v[64:67], v[160:175]
    ds_read_b64_tr_b16 v[100:101], v34 offset:22528
    ds_read_b64_tr_b16 v[102:103], v34 offset:23040
    v_mfma_f32_32x32x16_bf16 v[176:191], v[76:79], v[68:71], v[176:191]
    ds_read_b64_tr_b16 v[104:105], v34 offset:26624
    ds_read_b64_tr_b16 v[106:107], v34 offset:27136
    v_mfma_f32_32x32x16_bf16 v[192:207], v[80:83], v[64:67], v[192:207]
    ds_read_b64_tr_b16 v[108:109], v34 offset:30720
    ds_read_b64_tr_b16 v[110:111], v34 offset:31232
    v_mfma_f32_32x32x16_bf16 v[208:223], v[80:83], v[68:71], v[208:223]
    ds_read_b32 v24, v3 offset:8
    v_mfma_f32_32x32x16_bf16 v[224:239], v[84:87], v[64:67], v[224:239]
    v_mfma_f32_32x32x16_bf16 v[240:255], v[84:87], v[68:71], v[240:255]
    s_waitcnt lgkmcnt(1)
    v_mfma_f32_32x32x16_bf16 v[128:143], v[96:99], v[88:91], v[128:143]
    v_mov_b32 v23, 6
    ds_write_b32 v4, v23 offset:16
    v_mfma_f32_32x32x16_bf16 v[144:159], v[96:99], v[92:95], v[144:159]
    s_waitcnt lgkmcnt(1)
    v_readfirstlane_b32 s89, v24
    s_nop 0
    s_cmp_ge_u32 s89, 2
    s_cbranch_scc1 L_bk_121
L_sl_120:
    s_mov_b32 s100, 0
L_sp_122:
    s_sleep 1
    ds_read_b32 v24, v3 offset:8
    s_waitcnt lgkmcnt(0)
    v_readfirstlane_b32 s89, v24
    s_nop 0
    s_cmp_ge_u32 s89, 2
    s_cbranch_scc1 L_bk_121
    s_add_u32 s100, s100, 1
    s_cmp_lt_u32 s100, 8388608
    s_cbranch_scc1 L_sp_122
L_bk_121:
    v_mfma_f32_32x32x16_bf16 v[160:175], v[100:103], v[88:91], v[160:175]
    ds_read_b128 v[40:43], v30 offset:49152
    ds_read_b128 v[44:47], v30 offset:53248
    v_mfma_f32_32x32x16_bf16 v[176:191], v[100:103], v[92:95], v[176:191]
    ds_read_b64_tr_b16 v[48:49], v34 offset:32768
    ds_read_b64_tr_b16 v[50:51], v34 offset:33280
    v_mfma_f32_32x32x16_bf16 v[192:207], v[104:107], v[88:91], v[192:207]
    ds_read_b64_tr_b16 v[52:53], v34 offset:36864
    ds_read_b64_tr_b16 v[54:55], v34 offset:37376
    v_mfma_f32_32x32x16_bf16 v[208:223], v[104:107], v[92:95], v[208:223]
    ds_read_b64_tr_b16 v[56:57], v34 offset:40960
    ds_read_b64_tr_b16 v[58:59], v34 offset:41472
    v_mfma_f32_32x32x16_bf16 v[224:239], v[108:111], v[88:91], v[224:239]
    ds_read_b64_tr_b16 v[60:61], v34 offset:45056
    ds_read_b64_tr_b16 v[62:63], v34 offset:45568
    v_mfma_f32_32x32x16_bf16 v[240:255], v[108:111], v[92:95], v[240:255]
    s_waitcnt lgkmcnt(0)
    v_mfma_f32_32x32x16_bf16 v[128:143], v[48:51], v[40:43], v[128:143]
    ds_read_b128 v[64:67], v31 offset:49152
    ds_read_b128 v[68:71], v31 offset:53248
    v_mfma_f32_32x32x16_bf16 v[144:159], v[48:51], v[44:47], v[144:159]
    ds_read_b64_tr_b16 v[72:73], v34 offset:34816
    ds_read_b64_tr_b16 v[74:75], v34 offset:35328
    v_mfma_f32_32x32x16_bf16 v[160:175], v[52:55], v[40:43], v[160:175]
    ds_read_b64_tr_b16 v[76:77], v34 offset:38912
    ds_read_b64_tr_b16 v[78:79], v34 offset:39424
    v_mfma_f32_32x32x16_bf16 v[176:191], v[52:55], v[44:47], v[176:191]
    ds_read_b64_tr_b16 v[80:81], v34 offset:43008
    ds_read_b64_tr_b16 v[82:83], v34 offset:43520
    v_mfma_f32_32x32x16_bf16 v[192:207], v[56:59], v[40:43], v[192:207]
    ds_read_b64_tr_b16 v[84:85], v34 offset:47104
    ds_read_b64_tr_b16 v[86:87], v34 offset:47616
    v_mfma_f32_32x32x16_bf16 v[208:223], v[56:59], v[44:47], v[208:223]
    ds_read_b32 v24, v3 offset:12
    v_mfma_f32_32x32x16_bf16 v[224:239], v[60:63], v[40:43], v[224:239]
    v_mfma_f32_32x32x16_bf16 v[240:255], v[60:63], v[44:47], v[240:255]
    s_waitcnt lgkmcnt(1)
    v_mfma_f32_32x32x16_bf16 v[128:143], v[72:75], v[64:67], v[128:143]
    v_mov_b32 v23, 7
    ds_write_b32 v4, v23 offset:16
    v_mfma_f32_32x32x16_bf16 v[144:159], v[72:75], v[68:71], v[144:159]
    s_waitcnt lgkmcnt(1)
    v_readfirstlane_b32 s89, v24
    s_nop 0
    s_cmp_ge_u32 s89, 2
    s_cbranch_scc1 L_bk_124
L_sl_123:
    s_mov_b32 s100, 0
L_sp_125:
    s_sleep 1
    ds_read_b32 v24, v3 offset:12
    s_waitcnt lgkmcnt(0)
    v_readfirstlane_b32 s89, v24
    s_nop 0
    s_cmp_ge_u32 s89, 2
    s_cbranch_scc1 L_bk_124
    s_add_u32 s100, s100, 1
    s_cmp_lt_u32 s100, 8388608
    s_cbranch_scc1 L_sp_125
L_bk_124:
    v_mfma_f32_32x32x16_bf16 v[160:175], v[76:79], v[64:67], v[160:175]
    ds_read_b128 v[88:91], v32 offset:49152
    ds_read_b128 v[92:95], v32 offset:53248
    v_mfma_f32_32x32x16_bf16 v[176:191], v[76:79], v[68:71], v[176:191]
    ds_read_b64_tr_b16 v[96:97], v34 offset:49152
    ds_read_b64_tr_b16 v[98:99], v34 offset:49664
    v_mfma_f32_32x32x16_bf16 v[192:207], v[80:83], v[64:67], v[192:207]
    ds_read_b64_tr_b16 v[100:101], v34 offset:53248
    ds_read_b64_tr_b16 v[102:103], v34 offset:53760
    v_mfma_f32_32x32x16_bf16 v[208:223], v[80:83], v[68:71], v[208:223]
    ds_read_b64_tr_b16 v[104:105], v34 offset:57344
    ds_read_b64_tr_b16 v[106:107], v34 offset:57856
    v_mfma_f32_32x32x16_bf16 v[224:239], v[84:87], v[64:67], v[224:239]
    ds_read_b64_tr_b16 v[108:109], v34 offset:61440
    ds_read_b64_tr_b16 v[110:111], v34 offset:61952
    v_mfma_f32_32x32x16_bf16 v[240:255], v[84:87], v[68:71], v[240:255]
    s_waitcnt lgkmcnt(0)
    v_mfma_f32_32x32x16_bf16 v[128:143], v[96:99], v[88:91], v[128:143]
    ds_read_b128 v[40:43], v33 offset:49152
    ds_read_b128 v[44:47], v33 offset:53248
    v_mfma_f32_32x32x16_bf16 v[144:159], v[96:99], v[92:95], v[144:159]
    ds_read_b64_tr_b16 v[48:49], v34 offset:51200
    ds_read_b64_tr_b16 v[50:51], v34 offset:51712
    v_mfma_f32_32x32x16_bf16 v[160:175], v[100:103], v[88:91], v[160:175]
    ds_read_b64_tr_b16 v[52:53], v34 offset:55296
    ds_read_b64_tr_b16 v[54:55], v34 offset:55808
    v_mfma_f32_32x32x16_bf16 v[176:191], v[100:103], v[92:95], v[176:191]
    ds_read_b64_tr_b16 v[56:57], v34 offset:59392
    ds_read_b64_tr_b16 v[58:59], v34 offset:59904
    v_mfma_f32_32x32x16_bf16 v[192:207], v[104:107], v[88:91], v[192:207]
    ds_read_b64_tr_b16 v[60:61], v34 offset:63488
    ds_read_b64_tr_b16 v[62:63], v34 offset:64000
    v_mfma_f32_32x32x16_bf16 v[208:223], v[104:107], v[92:95], v[208:223]
    ds_read_b32 v24, v3 offset:0
    v_mfma_f32_32x32x16_bf16 v[224:239], v[108:111], v[88:91], v[224:239]
    v_mfma_f32_32x32x16_bf16 v[240:255], v[108:111], v[92:95], v[240:255]
    s_waitcnt lgkmcnt(1)
    v_mfma_f32_32x32x16_bf16 v[128:143], v[48:51], v[40:43], v[128:143]
    v_mov_b32 v23, 8
    ds_write_b32 v4, v23 offset:16
    v_mfma_f32_32x32x16_bf16 v[144:159], v[48:51], v[44:47], v[144:159]
    s_waitcnt lgkmcnt(1)
    v_readfirstlane_b32 s89, v24
    s_nop 0
    s_cmp_ge_u32 s89, 3
    s_cbranch_scc1 L_bk_127
L_sl_126:
    s_mov_b32 s100, 0
L_sp_128:
    s_sleep 1
    ds_read_b32 v24, v3 offset:0
    s_waitcnt lgkmcnt(0)
    v_readfirstlane_b32 s89, v24
    s_nop 0
    s_cmp_ge_u32 s89, 3
    s_cbranch_scc1 L_bk_127
    s_add_u32 s100, s100, 1
    s_cmp_lt_u32 s100, 8388608
    s_cbranch_scc1 L_sp_128
L_bk_127:
    v_mfma_f32_32x32x16_bf16 v[160:175], v[52:55], v[40:43], v[160:175]
    ds_read_b128 v[64:67], v30 offset:0
    ds_read_b128 v[68:71], v30 offset:4096
    v_mfma_f32_32x32x16_bf16 v[176:191], v[52:55], v[44:47], v[176:191]
    ds_read_b64_tr_b16 v[72:73], v34 offset:0
    ds_read_b64_tr_b16 v[74:75], v34 offset:512
    v_mfma_f32_32x32x16_bf16 v[192:207], v[56:59], v[40:43], v[192:207]
    ds_read_b64_tr_b16 v[76:77], v34 offset:4096
    ds_read_b64_tr_b16 v[78:79], v34 offset:4608
    v_mfma_f32_32x32x16_bf16 v[208:223], v[56:59], v[44:47], v[208:223]
    ds_read_b64_tr_b16 v[80:81], v34 offset:8192
    ds_read_b64_tr_b16 v[82:83], v34 offset:8704
    v_mfma_f32_32x32x16_bf16 v[224:239], v[60:63], v[40:43], v[224:239]
    ds_read_b64_tr_b16 v[84:85], v34 offset:12288
    ds_read_b64_tr_b16 v[86:87], v34 offset:12800
    v_mfma_f32_32x32x16_bf16 v[240:255], v[60:63], v[44:47], v[240:255]
    s_waitcnt lgkmcnt(0)
    v_mfma_f32_32x32x16_bf16 v[128:143], v[72:75], v[64:67], v[128:143]
    ds_read_b128 v[88:91], v31 offset:0
    ds_read_b128 v[92:95], v31 offset:4096
    v_mfma_f32_32x32x16_bf16 v[144:159], v[72:75], v[68:71], v[144:159]
    ds_read_b64_tr_b16 v[96:97], v34 offset:2048
    ds_read_b64_tr_b16 v[98:99], v34 offset:2560
    v_mfma_f32_32x32x16_bf16 v[160:175], v[76:79], v[64:67], v[160:175]
    ds_read_b64_tr_b16 v[100:101], v34 offset:6144
    ds_read_b64_tr_b16 v[102:103], v34 offset:6656
    v_mfma_f32_32x32x16_bf16 v[176:191], v[76:79], v[68:71], v[176:191]
    ds_read_b64_tr_b16 v[104:105], v34 offset:10240
    ds_read_b64_tr_b16 v[106:107], v34 offset:10752
    v_mfma_f32_32x32x16_bf16 v[192:207], v[80:83], v[64:67], v[192:207]
    ds_read_b64_tr_b16 v[108:109], v34 offset:14336
    ds_read_b64_tr_b16 v[110:111], v34 offset:14848
    v_mfma_f32_32x32x16_bf16 v[208:223], v[80:83], v[68:71], v[208:223]
    ds_read_b32 v24, v3 offset:4
    v_mfma_f32_32x32x16_bf16 v[224:239], v[84:87], v[64:67], v[224:239]
    v_mfma_f32_32x32x16_bf16 v[240:255], v[84:87], v[68:71], v[240:255]
    s_waitcnt lgkmcnt(1)
    v_mfma_f32_32x32x16_bf16 v[128:143], v[96:99], v[88:91], v[128:143]
    v_mov_b32 v23, 9
    ds_write_b32 v4, v23 offset:16
    v_mfma_f32_32x32x16_bf16 v[144:159], v[96:99], v[92:95], v[144:159]
    s_waitcnt lgkmcnt(1)
    v_readfirstlane_b32 s89, v24
    s_nop 0
    s_cmp_ge_u32 s89, 3
    s_cbranch_scc1 L_bk_130
L_sl_129:
    s_mov_b32 s100, 0
L_sp_131:
    s_sleep 1
    ds_read_b32 v24, v3 offset:4
    s_waitcnt lgkmcnt(0)
    v_readfirstlane_b32 s89, v24
    s_nop 0
    s_cmp_ge_u32 s89, 3
    s_cbranch_scc1 L_bk_130
    s_add_u32 s100, s100, 1
    s_cmp_lt_u32 s100, 8388608
    s_cbranch_scc1 L_sp_131
L_bk_130:
    v_mfma_f32_32x32x16_bf16 v[160:175], v[100:103], v[88:91], v[160:175]
    ds_read_b128 v[40:43], v32 offset:0
    ds_read_b128 v[44:47], v32 offset:4096
    v_mfma_f32_32x32x16_bf16 v[176:191], v[100:103], v[92:95], v[176:191]
    ds_read_b64_tr_b16 v[48:49], v34 offset:16384
    ds_read_b64_tr_b16 v[50:51], v34 offset:16896
    v_mfma_f32_32x32x16_bf16 v[192:207], v[104:107], v[88:91], v[192:207]
    ds_read_b64_tr_b16 v[52:53], v34 offset:20480
    ds_read_b64_tr_b16 v[54:55], v34 offset:20992
    v_mfma_f32_32x32x16_bf16 v[208:223], v[104:107], v[92:95], v[208:223]
    ds_read_b64_tr_b16 v[56:57], v34 offset:24576
    ds_read_b64_tr_b16 v[58:59], v34 offset:25088
    v_mfma_f32_32x32x16_bf16 v[224:239], v[108:111], v[88:91], v[224:239]
    ds_read_b64_tr_b16 v[60:61], v34 offset:28672
    ds_read_b64_tr_b16 v[62:63], v34 offset:29184
    v_mfma_f32_32x32x16_bf16 v[240:255], v[108:111], v[92:95], v[240:255]
    s_waitcnt lgkmcnt(0)
    v_mfma_f32_32x32x16_bf16 v[128:143], v[48:51], v[40:43], v[128:143]
    ds_read_b128 v[64:67], v33 offset:0
    ds_read_b128 v[68:71], v33 offset:4096
    v_mfma_f32_32x32x16_bf16 v[144:159], v[48:51], v[44:47], v[144:159]
    ds_read_b64_tr_b16 v[72:73], v34 offset:18432
    ds_read_b64_tr_b16 v[74:75], v34 offset:18944
    v_mfma_f32_32x32x16_bf16 v[160:175], v[52:55], v[40:43], v[160:175]
    ds_read_b64_tr_b16 v[76:77], v34 offset:22528
    ds_read_b64_tr_b16 v[78:79], v34 offset:23040
    v_mfma_f32_32x32x16_bf16 v[176:191], v[52:55], v[44:47], v[176:191]
    ds_read_b64_tr_b16 v[80:81], v34 offset:26624
    ds_read_b64_tr_b16 v[82:83], v34 offset:27136
    v_mfma_f32_32x32x16_bf16 v[192:207], v[56:59], v[40:43], v[192:207]
    ds_read_b64_tr_b16 v[84:85], v34 offset:30720
    ds_read_b64_tr_b16 v[86:87], v34 offset:31232
    v_mfma_f32_32x32x16_bf16 v[208:223], v[56:59], v[44:47], v[208:223]
    ds_read_b32 v24, v3 offset:8
    v_mfma_f32_32x32x16_bf16 v[224:239], v[60:63], v[40:43], v[224:239]
    v_mfma_f32_32x32x16_bf16 v[240:255], v[60:63], v[44:47], v[240:255]
    s_waitcnt lgkmcnt(1)
    v_mfma_f32_32x32x16_bf16 v[128:143], v[72:75], v[64:67], v[128:143]
    v_mov_b32 v23, 10
    ds_write_b32 v4, v23 offset:16
    v_mfma_f32_32x32x16_bf16 v[144:159], v[72:75], v[68:71], v[144:159]
    s_waitcnt lgkmcnt(1)
    v_readfirstlane_b32 s89, v24
    s_nop 0
    s_cmp_ge_u32 s89, 3
    s_cbranch_scc1 L_bk_133
L_sl_132:
    s_mov_b32 s100, 0
L_sp_134:
    s_sleep 1
    ds_read_b32 v24, v3 offset:8
    s_waitcnt lgkmcnt(0)
    v_readfirstlane_b32 s89, v24
    s_nop 0
    s_cmp_ge_u32 s89, 3
    s_cbranch_scc1 L_bk_133
    s_add_u32 s100, s100, 1
    s_cmp_lt_u32 s100, 8388608
    s_cbranch_scc1 L_sp_134
L_bk_133:
    v_mfma_f32_32x32x16_bf16 v[160:175], v[76:79], v[64:67], v[160:175]
    ds_read_b128 v[88:91], v30 offset:16384
    ds_read_b128 v[92:95], v30 offset:20480
    v_mfma_f32_32x32x16_bf16 v[176:191], v[76:79], v[68:71], v[176:191]
    ds_read_b64_tr_b16 v[96:97], v34 offset:32768
    ds_read_b64_tr_b16 v[98:99], v34 offset:33280
    v_mfma_f32_32x32x16_bf16 v[192:207], v[80:83], v[64:67], v[192:207]
    ds_read_b64_tr_b16 v[100:101], v34 offset:36864
    ds_read_b64_tr_b16 v[102:103], v34 offset:37376
    v_mfma_f32_32x32x16_bf16 v[208:223], v[80:83], v[68:71], v[208:223]
    ds_read_b64_tr_b16 v[104:105], v34 offset:40960
    ds_read_b64_tr_b16 v[106:107], v34 offset:41472
    v_mfma_f32_32x32x16_bf16 v[224:239], v[84:87], v[64:67], v[224:239]
    ds_read_b64_tr_b16 v[108:109], v34 offset:45056
    ds_read_b64_tr_b16 v[110:111], v34 offset:45568
    v_mfma_f32_32x32x16_bf16 v[240:255], v[84:87], v[68:71], v[240:255]
    s_waitcnt lgkmcnt(0)
    v_mfma_f32_32x32x16_bf16 v[128:143], v[96:99], v[88:91], v[128:143]
    ds_read_b128 v[40:43], v31 offset:16384
    ds_read_b128 v[44:47], v31 offset:20480
    v_mfma_f32_32x32x16_bf16 v[144:159], v[96:99], v[92:95], v[144:159]
    ds_read_b64_tr_b16 v[48:49], v34 offset:34816
    ds_read_b64_tr_b16 v[50:51], v34 offset:35328
    v_mfma_f32_32x32x16_bf16 v[160:175], v[100:103], v[88:91], v[160:175]
    ds_read_b64_tr_b16 v[52:53], v34 offset:38912
    ds_read_b64_tr_b16 v[54:55], v34 offset:39424
    v_mfma_f32_32x32x16_bf16 v[176:191], v[100:103], v[92:95], v[176:191]
    ds_read_b64_tr_b16 v[56:57], v34 offset:43008
    ds_read_b64_tr_b16 v[58:59], v34 offset:43520
    v_mfma_f32_32x32x16_bf16 v[192:207], v[104:107], v[88:91], v[192:207]
    ds_read_b64_tr_b16 v[60:61], v34 offset:47104
    ds_read_b64_tr_b16 v[62:63], v34 offset:47616
    v_mfma_f32_32x32x16_bf16 v[208:223], v[104:107], v[92:95], v[208:223]
    ds_read_b32 v24, v3 offset:12
    v_mfma_f32_32x32x16_bf16 v[224:239], v[108:111], v[88:91], v[224:239]
    v_mfma_f32_32x32x16_bf16 v[240:255], v[108:111], v[92:95], v[240:255]
    s_waitcnt lgkmcnt(1)
    v_mfma_f32_32x32x16_bf16 v[128:143], v[48:51], v[40:43], v[128:143]
    v_mov_b32 v23, 11
    ds_write_b32 v4, v23 offset:16
    v_mfma_f32_32x32x16_bf16 v[144:159], v[48:51], v[44:47], v[144:159]
    s_waitcnt lgkmcnt(1)
    v_readfirstlane_b32 s89, v24
    s_nop 0
    s_cmp_ge_u32 s89, 3
    s_cbranch_scc1 L_bk_136
L_sl_135:
    s_mov_b32 s100, 0
L_sp_137:
    s_sleep 1
    ds_read_b32 v24, v3 offset:12
    s_waitcnt lgkmcnt(0)
    v_readfirstlane_b32 s89, v24
    s_nop 0
    s_cmp_ge_u32 s89, 3
    s_cbranch_scc1 L_bk_136
    s_add_u32 s100, s100, 1
    s_cmp_lt_u32 s100, 8388608
    s_cbranch_scc1 L_sp_137
L_bk_136:
    v_mfma_f32_32x32x16_bf16 v[160:175], v[52:55], v[40:43], v[160:175]
    ds_read_b128 v[64:67], v32 offset:16384
    ds_read_b128 v[68:71], v32 offset:20480
    v_mfma_f32_32x32x16_bf16 v[176:191], v[52:55], v[44:47], v[176:191]
    ds_read_b64_tr_b16 v[72:73], v34 offset:49152
    ds_read_b64_tr_b16 v[74:75], v34 offset:49664
    v_mfma_f32_32x32x16_bf16 v[192:207], v[56:59], v[40:43], v[192:207]
    ds_read_b64_tr_b16 v[76:77], v34 offset:53248
    ds_read_b64_tr_b16 v[78:79], v34 offset:53760
    v_mfma_f32_32x32x16_bf16 v[208:223], v[56:59], v[44:47], v[208:223]
    ds_read_b64_tr_b16 v[80:81], v34 offset:57344
    ds_read_b64_tr_b16 v[82:83], v34 offset:57856
    v_mfma_f32_32x32x16_bf16 v[224:239], v[60:63], v[40:43], v[224:239]
    ds_read_b64_tr_b16 v[84:85], v34 offset:61440
    ds_read_b64_tr_b16 v[86:87], v34 offset:61952
    v_mfma_f32_32x32x16_bf16 v[240:255], v[60:63], v[44:47], v[240:255]
    s_waitcnt lgkmcnt(0)
    v_mfma_f32_32x32x16_bf16 v[128:143], v[72:75], v[64:67], v[128:143]
    ds_read_b128 v[88:91], v33 offset:16384
    ds_read_b128 v[92:95], v33 offset:20480
    v_mfma_f32_32x32x16_bf16 v[144:159], v[72:75], v[68:71], v[144:159]
    ds_read_b64_tr_b16 v[96:97], v34 offset:51200
    ds_read_b64_tr_b16 v[98:99], v34 offset:51712
    v_mfma_f32_32x32x16_bf16 v[160:175], v[76:79], v[64:67], v[160:175]
    ds_read_b64_tr_b16 v[100:101], v34 offset:55296
    ds_read_b64_tr_b16 v[102:103], v34 offset:55808
    v_mfma_f32_32x32x16_bf16 v[176:191], v[76:79], v[68:71], v[176:191]
    ds_read_b64_tr_b16 v[104:105], v34 offset:59392
    ds_read_b64_tr_b16 v[106:107], v34 offset:59904
    v_mfma_f32_32x32x16_bf16 v[192:207], v[80:83], v[64:67], v[192:207]
    ds_read_b64_tr_b16 v[108:109], v34 offset:63488
    ds_read_b64_tr_b16 v[110:111], v34 offset:64000
    v_mfma_f32_32x32x16_bf16 v[208:223], v[80:83], v[68:71], v[208:223]
    ds_read_b32 v24, v3 offset:0
    v_mfma_f32_32x32x16_bf16 v[224:239], v[84:87], v[64:67], v[224:239]
    v_mfma_f32_32x32x16_bf16 v[240:255], v[84:87], v[68:71], v[240:255]
    s_waitcnt lgkmcnt(1)
    v_mfma_f32_32x32x16_bf16 v[128:143], v[96:99], v[88:91], v[128:143]
    v_mov_b32 v23, 12
    ds_write_b32 v4, v23 offset:16
    v_mfma_f32_32x32x16_bf16 v[144:159], v[96:99], v[92:95], v[144:159]
    s_waitcnt lgkmcnt(1)
    v_readfirstlane_b32 s89, v24
    s_nop 0
    s_cmp_ge_u32 s89, 4
    s_cbranch_scc1 L_bk_139
L_sl_138:
    s_mov_b32 s100, 0
L_sp_140:
    s_sleep 1
    ds_read_b32 v24, v3 offset:0
    s_waitcnt lgkmcnt(0)
    v_readfirstlane_b32 s89, v24
    s_nop 0
    s_cmp_ge_u32 s89, 4
    s_cbranch_scc1 L_bk_139
    s_add_u32 s100, s100, 1
    s_cmp_lt_u32 s100, 8388608
    s_cbranch_scc1 L_sp_140
L_bk_139:
    v_mfma_f32_32x32x16_bf16 v[160:175], v[100:103], v[88:91], v[160:175]
    ds_read_b128 v[40:43], v30 offset:32768
    ds_read_b128 v[44:47], v30 offset:36864
    v_mfma_f32_32x32x16_bf16 v[176:191], v[100:103], v[92:95], v[176:191]
    ds_read_b64_tr_b16 v[48:49], v34 offset:0
    ds_read_b64_tr_b16 v[50:51], v34 offset:512
    v_mfma_f32_32x32x16_bf16 v[192:207], v[104:107], v[88:91], v[192:207]
    ds_read_b64_tr_b16 v[52:53], v34 offset:4096
    ds_read_b64_tr_b16 v[54:55], v34 offset:4608
    v_mfma_f32_32x32x16_bf16 v[208:223], v[104:107], v[92:95], v[208:223]
    ds_read_b64_tr_b16 v[56:57], v34 offset:8192
    ds_read_b64_tr_b16 v[58:59], v34 offset:8704
    v_mfma_f32_32x32x16_bf16 v[224:239], v[108:111], v[88:91], v[224:239]
    ds_read_b64_tr_b16 v[60:61], v34 offset:12288
    ds_read_b64_tr_b16 v[62:63], v34 offset:12800
    v_mfma_f32_32x32x16_bf16 v[240:255], v[108:111], v[92:95], v[240:255]
    s_waitcnt lgkmcnt(0)
    v_mfma_f32_32x32x16_bf16 v[128:143], v[48:51], v[40:43], v[128:143]
    ds_read_b128 v[64:67], v31 offset:32768
    ds_read_b128 v[68:71], v31 offset:36864
    v_mfma_f32_32x32x16_bf16 v[144:159], v[48:51], v[44:47], v[144:159]
    ds_read_b64_tr_b16 v[72:73], v34 offset:2048
    ds_read_b64_tr_b16 v[74:75], v34 offset:2560
    v_mfma_f32_32x32x16_bf16 v[160:175], v[52:55], v[40:43], v[160:175]
    ds_read_b64_tr_b16 v[76:77], v34 offset:6144
    ds_read_b64_tr_b16 v[78:79], v34 offset:6656
    v_mfma_f32_32x32x16_bf16 v[176:191], v[52:55], v[44:47], v[176:191]
    ds_read_b64_tr_b16 v[80:81], v34 offset:10240
    ds_read_b64_tr_b16 v[82:83], v34 offset:10752
    v_mfma_f32_32x32x16_bf16 v[192:207], v[56:59], v[40:43], v[192:207]
    ds_read_b64_tr_b16 v[84:85], v34 offset:14336
    ds_read_b64_tr_b16 v[86:87], v34 offset:14848
    v_mfma_f32_32x32x16_bf16 v[208:223], v[56:59], v[44:47], v[208:223]
    ds_read_b32 v24, v3 offset:4
    v_mfma_f32_32x32x16_bf16 v[224:239], v[60:63], v[40:43], v[224:239]
    v_mfma_f32_32x32x16_bf16 v[240:255], v[60:63], v[44:47], v[240:255]
    s_waitcnt lgkmcnt(1)
    v_mfma_f32_32x32x16_bf16 v[128:143], v[72:75], v[64:67], v[128:143]
    v_mov_b32 v23, 13
    ds_write_b32 v4, v23 offset:16
    v_mfma_f32_32x32x16_bf16 v[144:159], v[72:75], v[68:71], v[144:159]
    s_waitcnt lgkmcnt(1)
    v_readfirstlane_b32 s89, v24
    s_nop 0
    s_cmp_ge_u32 s89, 4
    s_cbranch_scc1 L_bk_142
L_sl_141:
    s_mov_b32 s100, 0
L_sp_143:
    s_sleep 1
    ds_read_b32 v24, v3 offset:4
    s_waitcnt lgkmcnt(0)
    v_readfirstlane_b32 s89, v24
    s_nop 0
    s_cmp_ge_u32 s89, 4
    s_cbranch_scc1 L_bk_142
    s_add_u32 s100, s100, 1
    s_cmp_lt_u32 s100, 8388608
    s_cbranch_scc1 L_sp_143
L_bk_142:
    v_mfma_f32_32x32x16_bf16 v[160:175], v[76:79], v[64:67], v[160:175]
    ds_read_b128 v[88:91], v32 offset:32768
    ds_read_b128 v[92:95], v32 offset:36864
    v_mfma_f32_32x32x16_bf16 v[176:191], v[76:79], v[68:71], v[176:191]
    ds_read_b64_tr_b16 v[96:97], v34 offset:16384
    ds_read_b64_tr_b16 v[98:99], v34 offset:16896
    v_mfma_f32_32x32x16_bf16 v[192:207], v[80:83], v[64:67], v[192:207]
    ds_read_b64_tr_b16 v[100:101], v34 offset:20480
    ds_read_b64_tr_b16 v[102:103], v34 offset:20992
    v_mfma_f32_32x32x16_bf16 v[208:223], v[80:83], v[68:71], v[208:223]
    ds_read_b64_tr_b16 v[104:105], v34 offset:24576
    ds_read_b64_tr_b16 v[106:107], v34 offset:25088
    v_mfma_f32_32x32x16_bf16 v[224:239], v[84:87], v[64:67], v[224:239]
    ds_read_b64_tr_b16 v[108:109], v34 offset:28672
    ds_read_b64_tr_b16 v[110:111], v34 offset:29184
    v_mfma_f32_32x32x16_bf16 v[240:255], v[84:87], v[68:71], v[240:255]
    s_waitcnt lgkmcnt(0)
    v_mfma_f32_32x32x16_bf16 v[128:143], v[96:99], v[88:91], v[128:143]
    ds_read_b128 v[40:43], v33 offset:32768
    ds_read_b128 v[44:47], v33 offset:36864
    v_mfma_f32_32x32x16_bf16 v[144:159], v[96:99], v[92:95], v[144:159]
    ds_read_b64_tr_b16 v[48:49], v34 offset:18432
    ds_read_b64_tr_b16 v[50:51], v34 offset:18944
    v_mfma_f32_32x32x16_bf16 v[160:175], v[100:103], v[88:91], v[160:175]
    ds_read_b64_tr_b16 v[52:53], v34 offset:22528
    ds_read_b64_tr_b16 v[54:55], v34 offset:23040
    v_mfma_f32_32x32x16_bf16 v[176:191], v[100:103], v[92:95], v[176:191]
    ds_read_b64_tr_b16 v[56:57], v34 offset:26624
    ds_read_b64_tr_b16 v[58:59], v34 offset:27136
    v_mfma_f32_32x32x16_bf16 v[192:207], v[104:107], v[88:91], v[192:207]
    ds_read_b64_tr_b16 v[60:61], v34 offset:30720
    ds_read_b64_tr_b16 v[62:63], v34 offset:31232
    v_mfma_f32_32x32x16_bf16 v[208:223], v[104:107], v[92:95], v[208:223]
    ds_read_b32 v24, v3 offset:8
    v_mfma_f32_32x32x16_bf16 v[224:239], v[108:111], v[88:91], v[224:239]
    v_mfma_f32_32x32x16_bf16 v[240:255], v[108:111], v[92:95], v[240:255]
    s_waitcnt lgkmcnt(1)
    v_mfma_f32_32x32x16_bf16 v[128:143], v[48:51], v[40:43], v[128:143]
    v_mov_b32 v23, 14
    ds_write_b32 v4, v23 offset:16
    v_mfma_f32_32x32x16_bf16 v[144:159], v[48:51], v[44:47], v[144:159]
    s_waitcnt lgkmcnt(1)
    v_readfirstlane_b32 s89, v24
    s_nop 0
    s_cmp_ge_u32 s89, 4
    s_cbranch_scc1 L_bk_145
L_sl_144:
    s_mov_b32 s100, 0
L_sp_146:
    s_sleep 1
    ds_read_b32 v24, v3 offset:8
    s_waitcnt lgkmcnt(0)
    v_readfirstlane_b32 s89, v24
    s_nop 0
    s_cmp_ge_u32 s89, 4
    s_cbranch_scc1 L_bk_145
    s_add_u32 s100, s100, 1
    s_cmp_lt_u32 s100, 8388608
    s_cbranch_scc1 L_sp_146
L_bk_145:
    v_mfma_f32_32x32x16_bf16 v[160:175], v[52:55], v[40:43], v[160:175]
    ds_read_b128 v[64:67], v30 offset:49152
    ds_read_b128 v[68:71], v30 offset:53248
    v_mfma_f32_32x32x16_bf16 v[176:191], v[52:55], v[44:47], v[176:191]
    ds_read_b64_tr_b16 v[72:73], v34 offset:32768
    ds_read_b64_tr_b16 v[74:75], v34 offset:33280
    v_mfma_f32_32x32x16_bf16 v[192:207], v[56:59], v[40:43], v[192:207]
    ds_read_b64_tr_b16 v[76:77], v34 offset:36864
    ds_read_b64_tr_b16 v[78:79], v34 offset:37376
    v_mfma_f32_32x32x16_bf16 v[208:223], v[56:59], v[44:47], v[208:223]
    ds_read_b64_tr_b16 v[80:81], v34 offset:40960
    ds_read_b64_tr_b16 v[82:83], v34 offset:41472
    v_mfma_f32_32x32x16_bf16 v[224:239], v[60:63], v[40:43], v[224:239]
    ds_read_b64_tr_b16 v[84:85], v34 offset:45056
    ds_read_b64_tr_b16 v[86:87], v34 offset:45568
    v_mfma_f32_32x32x16_bf16 v[240:255], v[60:63], v[44:47], v[240:255]
    s_waitcnt lgkmcnt(0)
    v_mfma_f32_32x32x16_bf16 v[128:143], v[72:75], v[64:67], v[128:143]
    ds_read_b128 v[88:91], v31 offset:49152
    ds_read_b128 v[92:95], v31 offset:53248
    v_mfma_f32_32x32x16_bf16 v[144:159], v[72:75], v[68:71], v[144:159]
    ds_read_b64_tr_b16 v[96:97], v34 offset:34816
    ds_read_b64_tr_b16 v[98:99], v34 offset:35328
    v_mfma_f32_32x32x16_bf16 v[160:175], v[76:79], v[64:67], v[160:175]
    ds_read_b64_tr_b16 v[100:101], v34 offset:38912
    ds_read_b64_tr_b16 v[102:103], v34 offset:39424
    v_mfma_f32_32x32x16_bf16 v[176:191], v[76:79], v[68:71], v[176:191]
    ds_read_b64_tr_b16 v[104:105], v34 offset:43008
    ds_read_b64_tr_b16 v[106:107], v34 offset:43520
    v_mfma_f32_32x32x16_bf16 v[192:207], v[80:83], v[64:67], v[192:207]
    ds_read_b64_tr_b16 v[108:109], v34 offset:47104
    ds_read_b64_tr_b16 v[110:111], v34 offset:47616
    v_mfma_f32_32x32x16_bf16 v[208:223], v[80:83], v[68:71], v[208:223]
    ds_read_b32 v24, v3 offset:12
    v_mfma_f32_32x32x16_bf16 v[224:239], v[84:87], v[64:67], v[224:239]
    v_mfma_f32_32x32x16_bf16 v[240:255], v[84:87], v[68:71], v[240:255]
    s_waitcnt lgkmcnt(1)
    v_mfma_f32_32x32x16_bf16 v[128:143], v[96:99], v[88:91], v[128:143]
    v_mov_b32 v23, 15
    ds_write_b32 v4, v23 offset:16
    v_mfma_f32_32x32x16_bf16 v[144:159], v[96:99], v[92:95], v[144:159]
    s_waitcnt lgkmcnt(1)
    v_readfirstlane_b32 s89, v24
    s_nop 0
    s_cmp_ge_u32 s89, 4
    s_cbranch_scc1 L_bk_148
L_sl_147:
    s_mov_b32 s100, 0
L_sp_149:
    s_sleep 1
    ds_read_b32 v24, v3 offset:12
    s_waitcnt lgkmcnt(0)
    v_readfirstlane_b32 s89, v24
    s_nop 0
    s_cmp_ge_u32 s89, 4
    s_cbranch_scc1 L_bk_148
    s_add_u32 s100, s100, 1
    s_cmp_lt_u32 s100, 8388608
    s_cbranch_scc1 L_sp_149
L_bk_148:
    v_mfma_f32_32x32x16_bf16 v[160:175], v[100:103], v[88:91], v[160:175]
    ds_read_b128 v[40:43], v32 offset:49152
    ds_read_b128 v[44:47], v32 offset:53248
    v_mfma_f32_32x32x16_bf16 v[176:191], v[100:103], v[92:95], v[176:191]
    ds_read_b64_tr_b16 v[48:49], v34 offset:49152
    ds_read_b64_tr_b16 v[50:51], v34 offset:49664
    v_mfma_f32_32x32x16_bf16 v[192:207], v[104:107], v[88:91], v[192:207]
    ds_read_b64_tr_b16 v[52:53], v34 offset:53248
    ds_read_b64_tr_b16 v[54:55], v34 offset:53760
    v_mfma_f32_32x32x16_bf16 v[208:223], v[104:107], v[92:95], v[208:223]
    ds_read_b64_tr_b16 v[56:57], v34 offset:57344
    ds_read_b64_tr_b16 v[58:59], v34 offset:57856
    v_mfma_f32_32x32x16_bf16 v[224:239], v[108:111], v[88:91], v[224:239]
    ds_read_b64_tr_b16 v[60:61], v34 offset:61440
    ds_read_b64_tr_b16 v[62:63], v34 offset:61952
    v_mfma_f32_32x32x16_bf16 v[240:255], v[108:111], v[92:95], v[240:255]
    s_waitcnt lgkmcnt(0)
    v_mfma_f32_32x32x16_bf16 v[128:143], v[48:51], v[40:43], v[128:143]
    ds_read_b128 v[64:67], v33 offset:49152
    ds_read_b128 v[68:71], v33 offset:53248
    v_mfma_f32_32x32x16_bf16 v[144:159], v[48:51], v[44:47], v[144:159]
    ds_read_b64_tr_b16 v[72:73], v34 offset:51200
    ds_read_b64_tr_b16 v[74:75], v34 offset:51712
    v_mfma_f32_32x32x16_bf16 v[160:175], v[52:55], v[40:43], v[160:175]
    ds_read_b64_tr_b16 v[76:77], v34 offset:55296
    ds_read_b64_tr_b16 v[78:79], v34 offset:55808
    v_mfma_f32_32x32x16_bf16 v[176:191], v[52:55], v[44:47], v[176:191]
    ds_read_b64_tr_b16 v[80:81], v34 offset:59392
    ds_read_b64_tr_b16 v[82:83], v34 offset:59904
    v_mfma_f32_32x32x16_bf16 v[192:207], v[56:59], v[40:43], v[192:207]
    ds_read_b64_tr_b16 v[84:85], v34 offset:63488
    ds_read_b64_tr_b16 v[86:87], v34 offset:64000
    v_mfma_f32_32x32x16_bf16 v[208:223], v[56:59], v[44:47], v[208:223]
    v_mfma_f32_32x32x16_bf16 v[224:239], v[60:63], v[40:43], v[224:239]
    v_mfma_f32_32x32x16_bf16 v[240:255], v[60:63], v[44:47], v[240:255]
    s_waitcnt lgkmcnt(0)
    v_mfma_f32_32x32x16_bf16 v[128:143], v[72:75], v[64:67], v[128:143]
    v_mov_b32 v23, 16
    ds_write_b32 v4, v23 offset:16
    v_mfma_f32_32x32x16_bf16 v[144:159], v[72:75], v[68:71], v[144:159]
    v_mfma_f32_32x32x16_bf16 v[160:175], v[76:79], v[64:67], v[160:175]
    v_mfma_f32_32x32x16_bf16 v[176:191], v[76:79], v[68:71], v[176:191]
    v_mfma_f32_32x32x16_bf16 v[192:207], v[80:83], v[64:67], v[192:207]
    v_mfma_f32_32x32x16_bf16 v[208:223], v[80:83], v[68:71], v[208:223]
    v_mfma_f32_32x32x16_bf16 v[224:239], v[84:87], v[64:67], v[224:239]
    v_mfma_f32_32x32x16_bf16 v[240:255], v[84:87], v[68:71], v[240:255]
    ds_read_b128 v[24:27], v3 offset:32
    s_waitcnt lgkmcnt(0)
    v_min3_u32 v24, v24, v25, v26
    v_min_u32 v24, v24, v27
    s_nop 0
    v_readfirstlane_b32 s89, v24
    s_nop 0
    s_cmp_ge_u32 s89, 2
    s_cbranch_scc1 L_bk_151
L_sl_150:
    s_mov_b32 s100, 0
L_sp_152:
    s_sleep 1
    ds_read_b128 v[24:27], v3 offset:32
    s_waitcnt lgkmcnt(0)
    v_min3_u32 v24, v24, v25, v26
    v_min_u32 v24, v24, v27
    s_nop 0
    v_readfirstlane_b32 s89, v24
    s_nop 0
    s_cmp_ge_u32 s89, 2
    s_cbranch_scc1 L_bk_151
    s_add_u32 s100, s100, 1
    s_cmp_lt_u32 s100, 8388608
    s_cbranch_scc1 L_sp_152
L_bk_151:
    v_and_b32 v8, 31, v1
    v_lshlrev_b32 v8, 3, v8
    s_lshl_b32 s76, s72, 9
    s_add_u32 s76, s76, 159744
    v_add_u32 v8, s76, v8
    ds_read_b64 v[20:21], v8
    ds_read_b64 v[22:23], v8 offset:256
    s_waitcnt lgkmcnt(0)
    v_sub_f32 v12, 0, v20
    v_sub_f32 v13, 0, v20
    v_mul_f32 v14, v21, v21
    v_mul_f32 v15, v21, v21
    v_sub_f32 v16, 0, v22
    v_sub_f32 v17, 0, v22
    v_mul_f32 v18, v23, v23
    v_mul_f32 v19, v23, v23
    v_lshrrev_b32 v9, 5, v1
    v_lshlrev_b32 v9, 4, v9
    s_lshl_b32 s76, s73, 7
    s_add_u32 s76, s76, 161792
    v_add_u32 v9, s76, v9
    ds_read_b128 v[40:43], v9 offset:0
    ds_read_b128 v[44:47], v9 offset:32
    ds_read_b128 v[48:51], v9 offset:64
    ds_read_b128 v[52:55], v9 offset:96
    ds_read_b128 v[56:59], v9 offset:256
    ds_read_b128 v[60:63], v9 offset:288
    ds_read_b128 v[64:67], v9 offset:320
    ds_read_b128 v[68:71], v9 offset:352
    s_lshl_b32 s76, s69, 2
    s_lshl_b32 s77, s72, 1
    s_add_u32 s76, s76, s77
    s_mul_i32 s76, s76, 56
    s_lshl_b32 s77, s85, 1
    s_add_u32 s76, s76, s77
    s_add_u32 s76, s76, s73
    s_lshl_b32 s76, s76, 11
    s_add_u32 s76, s76, 1048576
    s_add_u32 s77, s76, 114688
    s_waitcnt lgkmcnt(0)
    v_pk_fma_f32 v[128:129], v[12:13], v[40:41], v[128:129]
    v_pk_fma_f32 v[130:131], v[12:13], v[42:43], v[130:131]
    v_pk_fma_f32 v[132:133], v[12:13], v[44:45], v[132:133]
    v_pk_fma_f32 v[134:135], v[12:13], v[46:47], v[134:135]
    v_pk_fma_f32 v[160:161], v[12:13], v[56:57], v[160:161]
    v_pk_fma_f32 v[162:163], v[12:13], v[58:59], v[162:163]
    v_pk_fma_f32 v[164:165], v[12:13], v[60:61], v[164:165]
    v_pk_fma_f32 v[166:167], v[12:13], v[62:63], v[166:167]
    v_max_f32 v128, 0, v128
    v_max_f32 v129, 0, v129
    v_max_f32 v130, 0, v130
    v_max_f32 v131, 0, v131
    v_max_f32 v132, 0, v132
    v_max_f32 v133, 0, v133
    v_max_f32 v134, 0, v134
    v_max_f32 v135, 0, v135
    v_pk_mul_f32 v[160:161], v[160:161], v[14:15]
    v_pk_mul_f32 v[162:163], v[162:163], v[14:15]
    v_pk_mul_f32 v[164:165], v[164:165], v[14:15]
    v_pk_mul_f32 v[166:167], v[166:167], v[14:15]
    v_pk_mul_f32 v[128:129], v[128:129], v[160:161]
    v_pk_mul_f32 v[130:131], v[130:131], v[162:163]
    v_pk_mul_f32 v[132:133], v[132:133], v[164:165]
    v_pk_mul_f32 v[134:135], v[134:135], v[166:167]
    v_cvt_pk_bf16_f32 v72, v128, v129
    v_cvt_pk_bf16_f32 v73, v130, v131
    v_cvt_pk_bf16_f32 v74, v132, v133
    v_cvt_pk_bf16_f32 v75, v134, v135
    buffer_store_dwordx4 v[72:75], v2, s[12:15], s76 offen offset:0 sc1
    v_pk_fma_f32 v[136:137], v[12:13], v[48:49], v[136:137]
    v_pk_fma_f32 v[138:139], v[12:13], v[50:51], v[138:139]
    v_pk_fma_f32 v[140:141], v[12:13], v[52:53], v[140:141]
    v_pk_fma_f32 v[142:143], v[12:13], v[54:55], v[142:143]
    v_pk_fma_f32 v[168:169], v[12:13], v[64:65], v[168:169]
    v_pk_fma_f32 v[170:171], v[12:13], v[66:67], v[170:171]
    v_pk_fma_f32 v[172:173], v[12:13], v[68:69], v[172:173]
    v_pk_fma_f32 v[174:175], v[12:13], v[70:71], v[174:175]
    v_max_f32 v136, 0, v136
    v_max_f32 v137, 0, v137
    v_max_f32 v138, 0, v138
    v_max_f32 v139, 0, v139
    v_max_f32 v140, 0, v140
    v_max_f32 v141, 0, v141
    v_max_f32 v142, 0, v142
    v_max_f32 v143, 0, v143
    v_pk_mul_f32 v[168:169], v[168:169], v[14:15]
    v_pk_mul_f32 v[170:171], v[170:171], v[14:15]
    v_pk_mul_f32 v[172:173], v[172:173], v[14:15]
    v_pk_mul_f32 v[174:175], v[174:175], v[14:15]
    v_pk_mul_f32 v[136:137], v[136:137], v[168:169]
    v_pk_mul_f32 v[138:139], v[138:139], v[170:171]
    v_pk_mul_f32 v[140:141], v[140:141], v[172:173]
    v_pk_mul_f32 v[142:143], v[142:143], v[174:175]
    v_cvt_pk_bf16_f32 v76, v136, v137
    v_cvt_pk_bf16_f32 v77, v138, v139
    v_cvt_pk_bf16_f32 v78, v140, v141
    v_cvt_pk_bf16_f32 v79, v142, v143
    buffer_store_dwordx4 v[76:79], v2, s[12:15], s76 offen offset:1024 sc1
    v_pk_fma_f32 v[144:145], v[16:17], v[40:41], v[144:145]
    v_pk_fma_f32 v[146:147], v[16:17], v[42:43], v[146:147]
    v_pk_fma_f32 v[148:149], v[16:17], v[44:45], v[148:149]
    v_pk_fma_f32 v[150:151], v[16:17], v[46:47], v[150:151]
    v_pk_fma_f32 v[176:177], v[16:17], v[56:57], v[176:177]
    v_pk_fma_f32 v[178:179], v[16:17], v[58:59], v[178:179]
    v_pk_fma_f32 v[180:181], v[16:17], v[60:61], v[180:181]
    v_pk_fma_f32 v[182:183], v[16:17], v[62:63], v[182:183]
    v_max_f32 v144, 0, v144
    v_max_f32 v145, 0, v145
    v_max_f32 v146, 0, v146
    v_max_f32 v147, 0, v147
    v_max_f32 v148, 0, v148
    v_max_f32 v149, 0, v149
    v_max_f32 v150, 0, v150
    v_max_f32 v151, 0, v151
    v_pk_mul_f32 v[176:177], v[176:177], v[18:19]
    v_pk_mul_f32 v[178:179], v[178:179], v[18:19]
    v_pk_mul_f32 v[180:181], v[180:181], v[18:19]
    v_pk_mul_f32 v[182:183], v[182:183], v[18:19]
    v_pk_mul_f32 v[144:145], v[144:145], v[176:177]
    v_pk_mul_f32 v[146:147], v[146:147], v[178:179]
    v_pk_mul_f32 v[148:149], v[148:149], v[180:181]
    v_pk_mul_f32 v[150:151], v[150:151], v[182:183]
    v_cvt_pk_bf16_f32 v80, v144, v145
    v_cvt_pk_bf16_f32 v81, v146, v147
    v_cvt_pk_bf16_f32 v82, v148, v149
    v_cvt_pk_bf16_f32 v83, v150, v151
    buffer_store_dwordx4 v[80:83], v2, s[12:15], s77 offen offset:0 sc1
    v_pk_fma_f32 v[152:153], v[16:17], v[48:49], v[152:153]
    v_pk_fma_f32 v[154:155], v[16:17], v[50:51], v[154:155]
    v_pk_fma_f32 v[156:157], v[16:17], v[52:53], v[156:157]
    v_pk_fma_f32 v[158:159], v[16:17], v[54:55], v[158:159]
    v_pk_fma_f32 v[184:185], v[16:17], v[64:65], v[184:185]
    v_pk_fma_f32 v[186:187], v[16:17], v[66:67], v[186:187]
    v_pk_fma_f32 v[188:189], v[16:17], v[68:69], v[188:189]
    v_pk_fma_f32 v[190:191], v[16:17], v[70:71], v[190:191]
    v_max_f32 v152, 0, v152
    v_max_f32 v153, 0, v153
    v_max_f32 v154, 0, v154
    v_max_f32 v155, 0, v155
    v_max_f32 v156, 0, v156
    v_max_f32 v157, 0, v157
    v_max_f32 v158, 0, v158
    v_max_f32 v159, 0, v159
    v_pk_mul_f32 v[184:185], v[184:185], v[18:19]
    v_pk_mul_f32 v[186:187], v[186:187], v[18:19]
    v_pk_mul_f32 v[188:189], v[188:189], v[18:19]
    v_pk_mul_f32 v[190:191], v[190:191], v[18:19]
    v_pk_mul_f32 v[152:153], v[152:153], v[184:185]
    v_pk_mul_f32 v[154:155], v[154:155], v[186:187]
    v_pk_mul_f32 v[156:157], v[156:157], v[188:189]
    v_pk_mul_f32 v[158:159], v[158:159], v[190:191]
    v_cvt_pk_bf16_f32 v84, v152, v153
    v_cvt_pk_bf16_f32 v85, v154, v155
    v_cvt_pk_bf16_f32 v86, v156, v157
    v_cvt_pk_bf16_f32 v87, v158, v159
    buffer_store_dwordx4 v[84:87], v2, s[12:15], s77 offen offset:1024 sc1
    v_lshrrev_b32 v9, 5, v1
    v_lshlrev_b32 v9, 4, v9
    s_lshl_b32 s76, s73, 7
    s_add_u32 s76, s76, 162304
    v_add_u32 v9, s76, v9
    ds_read_b128 v[40:43], v9 offset:0
    ds_read_b128 v[44:47], v9 offset:32
    ds_read_b128 v[48:51], v9 offset:64
    ds_read_b128 v[52:55], v9 offset:96
    ds_read_b128 v[56:59], v9 offset:256
    ds_read_b128 v[60:63], v9 offset:288
    ds_read_b128 v[64:67], v9 offset:320
    ds_read_b128 v[68:71], v9 offset:352
    s_lshl_b32 s76, s69, 2
    s_lshl_b32 s77, s72, 1
    s_add_u32 s76, s76, s77
    s_mul_i32 s76, s76, 56
    s_lshl_b32 s77, s86, 1
    s_add_u32 s76, s76, s77
    s_add_u32 s76, s76, s73
    s_lshl_b32 s76, s76, 11
    s_add_u32 s76, s76, 1048576
    s_add_u32 s77, s76, 114688
    s_waitcnt lgkmcnt(0)
    v_pk_fma_f32 v[192:193], v[12:13], v[40:41], v[192:193]
    v_pk_fma_f32 v[194:195], v[12:13], v[42:43], v[194:195]
    v_pk_fma_f32 v[196:197], v[12:13], v[44:45], v[196:197]
    v_pk_fma_f32 v[198:199], v[12:13], v[46:47], v[198:199]
    v_pk_fma_f32 v[224:225], v[12:13], v[56:57], v[224:225]
    v_pk_fma_f32 v[226:227], v[12:13], v[58:59], v[226:227]
    v_pk_fma_f32 v[228:229], v[12:13], v[60:61], v[228:229]
    v_pk_fma_f32 v[230:231], v[12:13], v[62:63], v[230:231]
    v_max_f32 v192, 0, v192
    v_max_f32 v193, 0, v193
    v_max_f32 v194, 0, v194
    v_max_f32 v195, 0, v195
    v_max_f32 v196, 0, v196
    v_max_f32 v197, 0, v197
    v_max_f32 v198, 0, v198
    v_max_f32 v199, 0, v199
    v_pk_mul_f32 v[224:225], v[224:225], v[14:15]
    v_pk_mul_f32 v[226:227], v[226:227], v[14:15]
    v_pk_mul_f32 v[228:229], v[228:229], v[14:15]
    v_pk_mul_f32 v[230:231], v[230:231], v[14:15]
    v_pk_mul_f32 v[192:193], v[192:193], v[224:225]
    v_pk_mul_f32 v[194:195], v[194:195], v[226:227]
    v_pk_mul_f32 v[196:197], v[196:197], v[228:229]
    v_pk_mul_f32 v[198:199], v[198:199], v[230:231]
    v_cvt_pk_bf16_f32 v88, v192, v193
    v_cvt_pk_bf16_f32 v89, v194, v195
    v_cvt_pk_bf16_f32 v90, v196, v197
    v_cvt_pk_bf16_f32 v91, v198, v199
    buffer_store_dwordx4 v[88:91], v2, s[12:15], s76 offen offset:0 sc1
    v_pk_fma_f32 v[200:201], v[12:13], v[48:49], v[200:201]
    v_pk_fma_f32 v[202:203], v[12:13], v[50:51], v[202:203]
    v_pk_fma_f32 v[204:205], v[12:13], v[52:53], v[204:205]
    v_pk_fma_f32 v[206:207], v[12:13], v[54:55], v[206:207]
    v_pk_fma_f32 v[232:233], v[12:13], v[64:65], v[232:233]
    v_pk_fma_f32 v[234:235], v[12:13], v[66:67], v[234:235]
    v_pk_fma_f32 v[236:237], v[12:13], v[68:69], v[236:237]
    v_pk_fma_f32 v[238:239], v[12:13], v[70:71], v[238:239]
    v_max_f32 v200, 0, v200
    v_max_f32 v201, 0, v201
    v_max_f32 v202, 0, v202
    v_max_f32 v203, 0, v203
    v_max_f32 v204, 0, v204
    v_max_f32 v205, 0, v205
    v_max_f32 v206, 0, v206
    v_max_f32 v207, 0, v207
    v_pk_mul_f32 v[232:233], v[232:233], v[14:15]
    v_pk_mul_f32 v[234:235], v[234:235], v[14:15]
    v_pk_mul_f32 v[236:237], v[236:237], v[14:15]
    v_pk_mul_f32 v[238:239], v[238:239], v[14:15]
    v_pk_mul_f32 v[200:201], v[200:201], v[232:233]
    v_pk_mul_f32 v[202:203], v[202:203], v[234:235]
    v_pk_mul_f32 v[204:205], v[204:205], v[236:237]
    v_pk_mul_f32 v[206:207], v[206:207], v[238:239]
    v_cvt_pk_bf16_f32 v92, v200, v201
    v_cvt_pk_bf16_f32 v93, v202, v203
    v_cvt_pk_bf16_f32 v94, v204, v205
    v_cvt_pk_bf16_f32 v95, v206, v207
    buffer_store_dwordx4 v[92:95], v2, s[12:15], s76 offen offset:1024 sc1
    v_pk_fma_f32 v[208:209], v[16:17], v[40:41], v[208:209]
    v_pk_fma_f32 v[210:211], v[16:17], v[42:43], v[210:211]
    v_pk_fma_f32 v[212:213], v[16:17], v[44:45], v[212:213]
    v_pk_fma_f32 v[214:215], v[16:17], v[46:47], v[214:215]
    v_pk_fma_f32 v[240:241], v[16:17], v[56:57], v[240:241]
    v_pk_fma_f32 v[242:243], v[16:17], v[58:59], v[242:243]
    v_pk_fma_f32 v[244:245], v[16:17], v[60:61], v[244:245]
    v_pk_fma_f32 v[246:247], v[16:17], v[62:63], v[246:247]
    v_max_f32 v208, 0, v208
    v_max_f32 v209, 0, v209
    v_max_f32 v210, 0, v210
    v_max_f32 v211, 0, v211
    v_max_f32 v212, 0, v212
    v_max_f32 v213, 0, v213
    v_max_f32 v214, 0, v214
    v_max_f32 v215, 0, v215
    v_pk_mul_f32 v[240:241], v[240:241], v[18:19]
    v_pk_mul_f32 v[242:243], v[242:243], v[18:19]
    v_pk_mul_f32 v[244:245], v[244:245], v[18:19]
    v_pk_mul_f32 v[246:247], v[246:247], v[18:19]
    v_pk_mul_f32 v[208:209], v[208:209], v[240:241]
    v_pk_mul_f32 v[210:211], v[210:211], v[242:243]
    v_pk_mul_f32 v[212:213], v[212:213], v[244:245]
    v_pk_mul_f32 v[214:215], v[214:215], v[246:247]
    v_cvt_pk_bf16_f32 v96, v208, v209
    v_cvt_pk_bf16_f32 v97, v210, v211
    v_cvt_pk_bf16_f32 v98, v212, v213
    v_cvt_pk_bf16_f32 v99, v214, v215
    buffer_store_dwordx4 v[96:99], v2, s[12:15], s77 offen offset:0 sc1
    v_pk_fma_f32 v[216:217], v[16:17], v[48:49], v[216:217]
    v_pk_fma_f32 v[218:219], v[16:17], v[50:51], v[218:219]
    v_pk_fma_f32 v[220:221], v[16:17], v[52:53], v[220:221]
    v_pk_fma_f32 v[222:223], v[16:17], v[54:55], v[222:223]
    v_pk_fma_f32 v[248:249], v[16:17], v[64:65], v[248:249]
    v_pk_fma_f32 v[250:251], v[16:17], v[66:67], v[250:251]
    v_pk_fma_f32 v[252:253], v[16:17], v[68:69], v[252:253]
    v_pk_fma_f32 v[254:255], v[16:17], v[70:71], v[254:255]
    v_max_f32 v216, 0, v216
    v_max_f32 v217, 0, v217
    v_max_f32 v218, 0, v218
    v_max_f32 v219, 0, v219
    v_max_f32 v220, 0, v220
    v_max_f32 v221, 0, v221
    v_max_f32 v222, 0, v222
    v_max_f32 v223, 0, v223
    v_pk_mul_f32 v[248:249], v[248:249], v[18:19]
    v_pk_mul_f32 v[250:251], v[250:251], v[18:19]
    v_pk_mul_f32 v[252:253], v[252:253], v[18:19]
    v_pk_mul_f32 v[254:255], v[254:255], v[18:19]
    v_pk_mul_f32 v[216:217], v[216:217], v[248:249]
    v_pk_mul_f32 v[218:219], v[218:219], v[250:251]
    v_pk_mul_f32 v[220:221], v[220:221], v[252:253]
    v_pk_mul_f32 v[222:223], v[222:223], v[254:255]
    v_cvt_pk_bf16_f32 v100, v216, v217
    v_cvt_pk_bf16_f32 v101, v218, v219
    v_cvt_pk_bf16_f32 v102, v220, v221
    v_cvt_pk_bf16_f32 v103, v222, v223
    buffer_store_dwordx4 v[100:103], v2, s[12:15], s77 offen offset:1024 sc1
    v_mov_b32 v27, 17
    ds_write_b32 v4, v27 offset:16
    s_branch L_c_join
L_c_dft:
    v_and_b32 v16, 31, v1
    v_mov_b32 v17, 0x3f803f80
    v_cmp_eq_u32 vcc, 0, v16
    s_nop 1
    v_cndmask_b32 v8, 0, v17, vcc
    v_cndmask_b32 v9, 0, v17, vcc
    v_cndmask_b32 v10, 0, v17, vcc
    v_cndmask_b32 v11, 0, v17, vcc
    v_cmp_eq_u32 vcc, 1, v16
    s_nop 1
    v_cndmask_b32 v12, 0, v17, vcc
    v_cndmask_b32 v13, 0, v17, vcc
    v_cndmask_b32 v14, 0, v17, vcc
    v_cndmask_b32 v15, 0, v17, vcc
    ds_read_b64 v[24:25], v3 offset:96
    s_waitcnt lgkmcnt(0)
    v_min_u32 v24, v24, v25
    s_nop 0
    v_readfirstlane_b32 s89, v24
    s_nop 0
    s_cmp_ge_u32 s89, 1
    s_cbranch_scc1 L_bk_154
L_sl_153:
    s_mov_b32 s100, 0
L_sp_155:
    ds_read_b64 v[24:25], v3 offset:96
    s_waitcnt lgkmcnt(0)
    v_min_u32 v24, v24, v25
    s_nop 0
    v_readfirstlane_b32 s89, v24
    s_nop 0
    s_cmp_ge_u32 s89, 1
    s_cbranch_scc1 L_bk_154
    s_add_u32 s100, s100, 1
    s_cmp_lt_u32 s100, 8388608
    s_cbranch_scc1 L_sp_155
L_bk_154:
    ds_read_b128 v[40:43], v30 offset:0
    ds_read_b128 v[44:47], v30 offset:4096
    ds_read_b64_tr_b16 v[48:49], v34 offset:0
    ds_read_b64_tr_b16 v[50:51], v34 offset:512
    ds_read_b64_tr_b16 v[52:53], v34 offset:4096
    ds_read_b64_tr_b16 v[54:55], v34 offset:4608
    ds_read_b64_tr_b16 v[56:57], v34 offset:8192
    ds_read_b64_tr_b16 v[58:59], v34 offset:8704
    ds_read_b64_tr_b16 v[60:61], v34 offset:12288
    ds_read_b64_tr_b16 v[62:63], v34 offset:12800
    s_waitcnt lgkmcnt(0)
    v_mfma_f32_32x32x16_bf16 v[128:143], v[40:43], v[48:51], 0
    ds_read_b128 v[64:67], v31 offset:0
    ds_read_b128 v[68:71], v31 offset:4096
    v_mfma_f32_32x32x16_bf16 v[144:159], v[44:47], v[48:51], 0
    ds_read_b64_tr_b16 v[72:73], v34 offset:2048
    ds_read_b64_tr_b16 v[74:75], v34 offset:2560
    v_mfma_f32_32x32x16_bf16 v[160:175], v[40:43], v[52:55], 0
    ds_read_b64_tr_b16 v[76:77], v34 offset:6144
    ds_read_b64_tr_b16 v[78:79], v34 offset:6656
    v_mfma_f32_32x32x16_bf16 v[176:191], v[44:47], v[52:55], 0
    ds_read_b64_tr_b16 v[80:81], v34 offset:10240
    ds_read_b64_tr_b16 v[82:83], v34 offset:10752
    v_mfma_f32_32x32x16_bf16 v[192:207], v[56:59], v[40:43], 0
    ds_read_b64_tr_b16 v[84:85], v34 offset:14336
    ds_read_b64_tr_b16 v[86:87], v34 offset:14848
    v_mfma_f32_32x32x16_bf16 v[208:223], v[56:59], v[44:47], 0
    ds_read_b64 v[24:25], v3 offset:96
    v_mfma_f32_32x32x16_bf16 v[224:239], v[60:63], v[40:43], 0
    v_mfma_f32_32x32x16_bf16 v[240:255], v[60:63], v[44:47], 0
    s_cmp_lg_u32 s35, 0
    s_cbranch_scc1 L_cj_157
    s_cmp_eq_u32 s72, 0
    s_cbranch_scc0 L_cw_156
    v_mfma_f32_32x32x16_bf16 v[112:127], v[8:11], v[56:59], 0
    s_branch L_cj_157
L_cw_156:
    v_mfma_f32_32x32x16_bf16 v[112:127], v[8:11], v[60:63], 0
L_cj_157:
    s_waitcnt lgkmcnt(1)
    v_mfma_f32_32x32x16_bf16 v[128:143], v[64:67], v[72:75], v[128:143]
    v_mov_b32 v23, 1
    ds_write_b32 v4, v23 offset:16
    v_mfma_f32_32x32x16_bf16 v[144:159], v[68:71], v[72:75], v[144:159]
    s_waitcnt lgkmcnt(1)
    v_min_u32 v24, v24, v25
    s_nop 0
    v_readfirstlane_b32 s89, v24
    s_nop 0
    s_cmp_ge_u32 s89, 2
    s_cbranch_scc1 L_bk_159
L_sl_158:
    s_mov_b32 s100, 0
L_sp_160:
    ds_read_b64 v[24:25], v3 offset:96
    s_waitcnt lgkmcnt(0)
    v_min_u32 v24, v24, v25
    s_nop 0
    v_readfirstlane_b32 s89, v24
    s_nop 0
    s_cmp_ge_u32 s89, 2
    s_cbranch_scc1 L_bk_159
    s_add_u32 s100, s100, 1
    s_cmp_lt_u32 s100, 8388608
    s_cbranch_scc1 L_sp_160
L_bk_159:
    v_mfma_f32_32x32x16_bf16 v[160:175], v[64:67], v[76:79], v[160:175]
    ds_read_b128 v[88:91], v32 offset:0
    ds_read_b128 v[92:95], v32 offset:4096
    v_mfma_f32_32x32x16_bf16 v[176:191], v[68:71], v[76:79], v[176:191]
    ds_read_b64_tr_b16 v[96:97], v34 offset:16384
    ds_read_b64_tr_b16 v[98:99], v34 offset:16896
    v_mfma_f32_32x32x16_bf16 v[192:207], v[80:83], v[64:67], v[192:207]
    ds_read_b64_tr_b16 v[100:101], v34 offset:20480
    ds_read_b64_tr_b16 v[102:103], v34 offset:20992
    v_mfma_f32_32x32x16_bf16 v[208:223], v[80:83], v[68:71], v[208:223]
    ds_read_b64_tr_b16 v[104:105], v34 offset:24576
    ds_read_b64_tr_b16 v[106:107], v34 offset:25088
    v_mfma_f32_32x32x16_bf16 v[224:239], v[84:87], v[64:67], v[224:239]
    ds_read_b64_tr_b16 v[108:109], v34 offset:28672
    ds_read_b64_tr_b16 v[110:111], v34 offset:29184
    v_mfma_f32_32x32x16_bf16 v[240:255], v[84:87], v[68:71], v[240:255]
    s_cmp_lg_u32 s35, 0
    s_cbranch_scc1 L_cj_162
    s_cmp_eq_u32 s72, 0
    s_cbranch_scc0 L_cw_161
    v_mfma_f32_32x32x16_bf16 v[112:127], v[8:11], v[80:83], v[112:127]
    s_branch L_cj_162
L_cw_161:
    v_mfma_f32_32x32x16_bf16 v[112:127], v[8:11], v[84:87], v[112:127]
L_cj_162:
    s_waitcnt lgkmcnt(0)
    v_mfma_f32_32x32x16_bf16 v[128:143], v[88:91], v[96:99], v[128:143]
    ds_read_b128 v[40:43], v33 offset:0
    ds_read_b128 v[44:47], v33 offset:4096
    v_mfma_f32_32x32x16_bf16 v[144:159], v[92:95], v[96:99], v[144:159]
    ds_read_b64_tr_b16 v[48:49], v34 offset:18432
    ds_read_b64_tr_b16 v[50:51], v34 offset:18944
    v_mfma_f32_32x32x16_bf16 v[160:175], v[88:91], v[100:103], v[160:175]
    ds_read_b64_tr_b16 v[52:53], v34 offset:22528
    ds_read_b64_tr_b16 v[54:55], v34 offset:23040
    v_mfma_f32_32x32x16_bf16 v[176:191], v[92:95], v[100:103], v[176:191]
    ds_read_b64_tr_b16 v[56:57], v34 offset:26624
    ds_read_b64_tr_b16 v[58:59], v34 offset:27136
    v_mfma_f32_32x32x16_bf16 v[192:207], v[104:107], v[88:91], v[192:207]
    ds_read_b64_tr_b16 v[60:61], v34 offset:30720
    ds_read_b64_tr_b16 v[62:63], v34 offset:31232
    v_mfma_f32_32x32x16_bf16 v[208:223], v[104:107], v[92:95], v[208:223]
    ds_read_b32 v24, v3 offset:8
    v_mfma_f32_32x32x16_bf16 v[224:239], v[108:111], v[88:91], v[224:239]
    v_mfma_f32_32x32x16_bf16 v[240:255], v[108:111], v[92:95], v[240:255]
    s_cmp_lg_u32 s35, 0
    s_cbranch_scc1 L_cj_164
    s_cmp_eq_u32 s72, 0
    s_cbranch_scc0 L_cw_163
    v_mfma_f32_32x32x16_bf16 v[112:127], v[8:11], v[104:107], v[112:127]
    s_branch L_cj_164
L_cw_163:
    v_mfma_f32_32x32x16_bf16 v[112:127], v[8:11], v[108:111], v[112:127]
L_cj_164:
    s_waitcnt lgkmcnt(1)
    v_mfma_f32_32x32x16_bf16 v[128:143], v[40:43], v[48:51], v[128:143]
    v_mov_b32 v23, 2
    ds_write_b32 v4, v23 offset:16
    v_mfma_f32_32x32x16_bf16 v[144:159], v[44:47], v[48:51], v[144:159]
    s_waitcnt lgkmcnt(1)
    v_readfirstlane_b32 s89, v24
    s_nop 0
    s_cmp_ge_u32 s89, 1
    s_cbranch_scc1 L_bk_166
L_sl_165:
    s_mov_b32 s100, 0
L_sp_167:
    s_sleep 1
    ds_read_b32 v24, v3 offset:8
    s_waitcnt lgkmcnt(0)
    v_readfirstlane_b32 s89, v24
    s_nop 0
    s_cmp_ge_u32 s89, 1
    s_cbranch_scc1 L_bk_166
    s_add_u32 s100, s100, 1
    s_cmp_lt_u32 s100, 8388608
    s_cbranch_scc1 L_sp_167
L_bk_166:
    v_mfma_f32_32x32x16_bf16 v[160:175], v[40:43], v[52:55], v[160:175]
    ds_read_b128 v[64:67], v30 offset:16384
    ds_read_b128 v[68:71], v30 offset:20480
    v_mfma_f32_32x32x16_bf16 v[176:191], v[44:47], v[52:55], v[176:191]
    ds_read_b64_tr_b16 v[72:73], v34 offset:32768
    ds_read_b64_tr_b16 v[74:75], v34 offset:33280
    v_mfma_f32_32x32x16_bf16 v[192:207], v[56:59], v[40:43], v[192:207]
    ds_read_b64_tr_b16 v[76:77], v34 offset:36864
    ds_read_b64_tr_b16 v[78:79], v34 offset:37376
    v_mfma_f32_32x32x16_bf16 v[208:223], v[56:59], v[44:47], v[208:223]
    ds_read_b64_tr_b16 v[80:81], v34 offset:40960
    ds_read_b64_tr_b16 v[82:83], v34 offset:41472
    v_mfma_f32_32x32x16_bf16 v[224:239], v[60:63], v[40:43], v[224:239]
    ds_read_b64_tr_b16 v[84:85], v34 offset:45056
    ds_read_b64_tr_b16 v[86:87], v34 offset:45568
    v_mfma_f32_32x32x16_bf16 v[240:255], v[60:63], v[44:47], v[240:255]
    s_cmp_lg_u32 s35, 0
    s_cbranch_scc1 L_cj_169
    s_cmp_eq_u32 s72, 0
    s_cbranch_scc0 L_cw_168
    v_mfma_f32_32x32x16_bf16 v[112:127], v[8:11], v[56:59], v[112:127]
    s_branch L_cj_169
L_cw_168:
    v_mfma_f32_32x32x16_bf16 v[112:127], v[8:11], v[60:63], v[112:127]
L_cj_169:
    s_waitcnt lgkmcnt(0)
    v_mfma_f32_32x32x16_bf16 v[128:143], v[64:67], v[72:75], v[128:143]
    ds_read_b128 v[88:91], v31 offset:16384
    ds_read_b128 v[92:95], v31 offset:20480
    v_mfma_f32_32x32x16_bf16 v[144:159], v[68:71], v[72:75], v[144:159]
    ds_read_b64_tr_b16 v[96:97], v34 offset:34816
    ds_read_b64_tr_b16 v[98:99], v34 offset:35328
    v_mfma_f32_32x32x16_bf16 v[160:175], v[64:67], v[76:79], v[160:175]
    ds_read_b64_tr_b16 v[100:101], v34 offset:38912
    ds_read_b64_tr_b16 v[102:103], v34 offset:39424
    v_mfma_f32_32x32x16_bf16 v[176:191], v[68:71], v[76:79], v[176:191]
    ds_read_b64_tr_b16 v[104:105], v34 offset:43008
    ds_read_b64_tr_b16 v[106:107], v34 offset:43520
    v_mfma_f32_32x32x16_bf16 v[192:207], v[80:83], v[64:67], v[192:207]
    ds_read_b64_tr_b16 v[108:109], v34 offset:47104
    ds_read_b64_tr_b16 v[110:111], v34 offset:47616
    v_mfma_f32_32x32x16_bf16 v[208:223], v[80:83], v[68:71], v[208:223]
    ds_read_b32 v24, v3 offset:12
    v_mfma_f32_32x32x16_bf16 v[224:239], v[84:87], v[64:67], v[224:239]
    v_mfma_f32_32x32x16_bf16 v[240:255], v[84:87], v[68:71], v[240:255]
    s_cmp_lg_u32 s35, 1
    s_cbranch_scc1 L_cj_171
    s_cmp_eq_u32 s72, 0
    s_cbranch_scc0 L_cw_170
    v_mfma_f32_32x32x16_bf16 v[112:127], v[8:11], v[80:83], 0
    s_branch L_cj_171
L_cw_170:
    v_mfma_f32_32x32x16_bf16 v[112:127], v[8:11], v[84:87], 0
L_cj_171:
    s_waitcnt lgkmcnt(1)
    v_mfma_f32_32x32x16_bf16 v[128:143], v[88:91], v[96:99], v[128:143]
    v_mov_b32 v23, 3
    ds_write_b32 v4, v23 offset:16
    v_mfma_f32_32x32x16_bf16 v[144:159], v[92:95], v[96:99], v[144:159]
    s_waitcnt lgkmcnt(1)
    v_readfirstlane_b32 s89, v24
    s_nop 0
    s_cmp_ge_u32 s89, 1
    s_cbranch_scc1 L_bk_173
L_sl_172:
    s_mov_b32 s100, 0
L_sp_174:
    s_sleep 1
    ds_read_b32 v24, v3 offset:12
    s_waitcnt lgkmcnt(0)
    v_readfirstlane_b32 s89, v24
    s_nop 0
    s_cmp_ge_u32 s89, 1
    s_cbranch_scc1 L_bk_173
    s_add_u32 s100, s100, 1
    s_cmp_lt_u32 s100, 8388608
    s_cbranch_scc1 L_sp_174
L_bk_173:
    v_mfma_f32_32x32x16_bf16 v[160:175], v[88:91], v[100:103], v[160:175]
    ds_read_b128 v[40:43], v32 offset:16384
    ds_read_b128 v[44:47], v32 offset:20480
    v_mfma_f32_32x32x16_bf16 v[176:191], v[92:95], v[100:103], v[176:191]
    ds_read_b64_tr_b16 v[48:49], v34 offset:49152
    ds_read_b64_tr_b16 v[50:51], v34 offset:49664
    v_mfma_f32_32x32x16_bf16 v[192:207], v[104:107], v[88:91], v[192:207]
    ds_read_b64_tr_b16 v[52:53], v34 offset:53248
    ds_read_b64_tr_b16 v[54:55], v34 offset:53760
    v_mfma_f32_32x32x16_bf16 v[208:223], v[104:107], v[92:95], v[208:223]
    ds_read_b64_tr_b16 v[56:57], v34 offset:57344
    ds_read_b64_tr_b16 v[58:59], v34 offset:57856
    v_mfma_f32_32x32x16_bf16 v[224:239], v[108:111], v[88:91], v[224:239]
    ds_read_b64_tr_b16 v[60:61], v34 offset:61440
    ds_read_b64_tr_b16 v[62:63], v34 offset:61952
    v_mfma_f32_32x32x16_bf16 v[240:255], v[108:111], v[92:95], v[240:255]
    s_cmp_lg_u32 s35, 1
    s_cbranch_scc1 L_cj_176
    s_cmp_eq_u32 s72, 0
    s_cbranch_scc0 L_cw_175
    v_mfma_f32_32x32x16_bf16 v[112:127], v[8:11], v[104:107], v[112:127]
    s_branch L_cj_176
L_cw_175:
    v_mfma_f32_32x32x16_bf16 v[112:127], v[8:11], v[108:111], v[112:127]
L_cj_176:
    s_cmp_lg_u32 s35, 0
    s_cbranch_scc1 L_cp_177
    s_lshl_b32 s76, s86, 1
    s_add_u32 s76, s76, s72
    s_lshl_b32 s76, s76, 3
    s_add_u32 s76, s76, s3
    s_lshl_b32 s76, s76, 9
    s_lshl_b32 s77, s73, 8
    s_add_u32 s76, s76, s77
    s_add_u32 s76, s76, 131072
    s_add_u32 s77, s76, 4096
    v_lshlrev_b32 v18, 3, v1
    v_mov_b32 v114, v113
    v_mov_b32 v113, s68
    v_mov_b32 v115, s68
    s_mov_b32 exec_hi, 0
    buffer_store_dwordx2 v[112:113], v18, s[12:15], s76 offen sc1
    s_mov_b32 exec_hi, -1
L_cp_177:
    s_waitcnt lgkmcnt(0)
    v_mfma_f32_32x32x16_bf16 v[128:143], v[40:43], v[48:51], v[128:143]
    ds_read_b128 v[64:67], v33 offset:16384
    ds_read_b128 v[68:71], v33 offset:20480
    v_mfma_f32_32x32x16_bf16 v[144:159], v[44:47], v[48:51], v[144:159]
    ds_read_b64_tr_b16 v[72:73], v34 offset:51200
    ds_read_b64_tr_b16 v[74:75], v34 offset:51712
    v_mfma_f32_32x32x16_bf16 v[160:175], v[40:43], v[52:55], v[160:175]
    ds_read_b64_tr_b16 v[76:77], v34 offset:55296
    ds_read_b64_tr_b16 v[78:79], v34 offset:55808
    v_mfma_f32_32x32x16_bf16 v[176:191], v[44:47], v[52:55], v[176:191]
    ds_read_b64_tr_b16 v[80:81], v34 offset:59392
    ds_read_b64_tr_b16 v[82:83], v34 offset:59904
    v_mfma_f32_32x32x16_bf16 v[192:207], v[56:59], v[40:43], v[192:207]
    ds_read_b64_tr_b16 v[84:85], v34 offset:63488
    ds_read_b64_tr_b16 v[86:87], v34 offset:64000
    v_mfma_f32_32x32x16_bf16 v[208:223], v[56:59], v[44:47], v[208:223]
    ds_read_b32 v24, v3 offset:0
    v_mfma_f32_32x32x16_bf16 v[224:239], v[60:63], v[40:43], v[224:239]
    v_mfma_f32_32x32x16_bf16 v[240:255], v[60:63], v[44:47], v[240:255]
    s_cmp_lg_u32 s35, 1
    s_cbranch_scc1 L_cj_179
    s_cmp_eq_u32 s72, 0
    s_cbranch_scc0 L_cw_178
    v_mfma_f32_32x32x16_bf16 v[112:127], v[8:11], v[56:59], v[112:127]
    s_branch L_cj_179
L_cw_178:
    v_mfma_f32_32x32x16_bf16 v[112:127], v[8:11], v[60:63], v[112:127]
L_cj_179:
    s_waitcnt lgkmcnt(1)
    v_mfma_f32_32x32x16_bf16 v[128:143], v[64:67], v[72:75], v[128:143]
    v_mov_b32 v23, 4
    ds_write_b32 v4, v23 offset:16
    v_mfma_f32_32x32x16_bf16 v[144:159], v[68:71], v[72:75], v[144:159]
    s_waitcnt lgkmcnt(1)
    v_readfirstlane_b32 s89, v24
    s_nop 0
    s_cmp_ge_u32 s89, 2
    s_cbranch_scc1 L_bk_181
L_sl_180:
    s_mov_b32 s100, 0
L_sp_182:
    s_sleep 1
    ds_read_b32 v24, v3 offset:0
    s_waitcnt lgkmcnt(0)
    v_readfirstlane_b32 s89, v24
    s_nop 0
    s_cmp_ge_u32 s89, 2
    s_cbranch_scc1 L_bk_181
    s_add_u32 s100, s100, 1
    s_cmp_lt_u32 s100, 8388608
    s_cbranch_scc1 L_sp_182
L_bk_181:
    ds_read_b32 v24, v3 offset:124
    s_waitcnt lgkmcnt(0)
    v_readfirstlane_b32 s89, v24
    s_nop 0
    s_cmp_ge_u32 s89, 1
    s_cbranch_scc1 L_bk_184
L_sl_183:
    s_mov_b32 s100, 0
L_sp_185:
    s_sleep 1
    ds_read_b32 v24, v3 offset:124
    s_waitcnt lgkmcnt(0)
    v_readfirstlane_b32 s89, v24
    s_nop 0
    s_cmp_ge_u32 s89, 1
    s_cbranch_scc1 L_bk_184
    s_add_u32 s100, s100, 1
    s_cmp_lt_u32 s100, 8388608
    s_cbranch_scc1 L_sp_185
L_bk_184:
    v_mfma_f32_32x32x16_bf16 v[160:175], v[64:67], v[76:79], v[160:175]
    ds_read_b128 v[88:91], v30 offset:32768
    ds_read_b128 v[92:95], v30 offset:36864
    v_mfma_f32_32x32x16_bf16 v[176:191], v[68:71], v[76:79], v[176:191]
    ds_read_b64_tr_b16 v[96:97], v34 offset:0
    ds_read_b64_tr_b16 v[98:99], v34 offset:512
    v_mfma_f32_32x32x16_bf16 v[192:207], v[80:83], v[64:67], v[192:207]
    ds_read_b64_tr_b16 v[100:101], v34 offset:4096
    ds_read_b64_tr_b16 v[102:103], v34 offset:4608
    v_mfma_f32_32x32x16_bf16 v[208:223], v[80:83], v[68:71], v[208:223]
    ds_read_b64_tr_b16 v[104:105], v34 offset:8192
    ds_read_b64_tr_b16 v[106:107], v34 offset:8704
    v_mfma_f32_32x32x16_bf16 v[224:239], v[84:87], v[64:67], v[224:239]
    ds_read_b64_tr_b16 v[108:109], v34 offset:12288
    ds_read_b64_tr_b16 v[110:111], v34 offset:12800
    v_mfma_f32_32x32x16_bf16 v[240:255], v[84:87], v[68:71], v[240:255]
    s_cmp_lg_u32 s35, 1
    s_cbranch_scc1 L_cj_187
    s_cmp_eq_u32 s72, 0
    s_cbranch_scc0 L_cw_186
    v_mfma_f32_32x32x16_bf16 v[112:127], v[8:11], v[80:83], v[112:127]
    s_branch L_cj_187
L_cw_186:
    v_mfma_f32_32x32x16_bf16 v[112:127], v[8:11], v[84:87], v[112:127]
L_cj_187:
    s_waitcnt lgkmcnt(0)
    v_mfma_f32_32x32x16_bf16 v[128:143], v[88:91], v[96:99], v[128:143]
    ds_read_b128 v[40:43], v31 offset:32768
    ds_read_b128 v[44:47], v31 offset:36864
    v_mfma_f32_32x32x16_bf16 v[144:159], v[92:95], v[96:99], v[144:159]
    ds_read_b64_tr_b16 v[48:49], v34 offset:2048
    ds_read_b64_tr_b16 v[50:51], v34 offset:2560
    v_mfma_f32_32x32x16_bf16 v[160:175], v[88:91], v[100:103], v[160:175]
    ds_read_b64_tr_b16 v[52:53], v34 offset:6144
    ds_read_b64_tr_b16 v[54:55], v34 offset:6656
    v_mfma_f32_32x32x16_bf16 v[176:191], v[92:95], v[100:103], v[176:191]
    ds_read_b64_tr_b16 v[56:57], v34 offset:10240
    ds_read_b64_tr_b16 v[58:59], v34 offset:10752
    v_mfma_f32_32x32x16_bf16 v[192:207], v[104:107], v[88:91], v[192:207]
    ds_read_b64_tr_b16 v[60:61], v34 offset:14336
    ds_read_b64_tr_b16 v[62:63], v34 offset:14848
    v_mfma_f32_32x32x16_bf16 v[208:223], v[104:107], v[92:95], v[208:223]
    ds_read_b32 v24, v3 offset:4
    v_mfma_f32_32x32x16_bf16 v[224:239], v[108:111], v[88:91], v[224:239]
    v_mfma_f32_32x32x16_bf16 v[240:255], v[108:111], v[92:95], v[240:255]
    s_waitcnt lgkmcnt(1)
    v_mfma_f32_32x32x16_bf16 v[128:143], v[40:43], v[48:51], v[128:143]
    v_mov_b32 v23, 5
    ds_write_b32 v4, v23 offset:16
    v_mfma_f32_32x32x16_bf16 v[144:159], v[44:47], v[48:51], v[144:159]
    s_waitcnt lgkmcnt(1)
    v_readfirstlane_b32 s89, v24
    s_nop 0
    s_cmp_ge_u32 s89, 2
    s_cbranch_scc1 L_bk_189
L_sl_188:
    s_mov_b32 s100, 0
L_sp_190:
    s_sleep 1
    ds_read_b32 v24, v3 offset:4
    s_waitcnt lgkmcnt(0)
    v_readfirstlane_b32 s89, v24
    s_nop 0
    s_cmp_ge_u32 s89, 2
    s_cbranch_scc1 L_bk_189
    s_add_u32 s100, s100, 1
    s_cmp_lt_u32 s100, 8388608
    s_cbranch_scc1 L_sp_190
L_bk_189:
    v_mfma_f32_32x32x16_bf16 v[160:175], v[40:43], v[52:55], v[160:175]
    ds_read_b128 v[64:67], v32 offset:32768
    ds_read_b128 v[68:71], v32 offset:36864
    v_mfma_f32_32x32x16_bf16 v[176:191], v[44:47], v[52:55], v[176:191]
    ds_read_b64_tr_b16 v[72:73], v34 offset:16384
    ds_read_b64_tr_b16 v[74:75], v34 offset:16896
    v_mfma_f32_32x32x16_bf16 v[192:207], v[56:59], v[40:43], v[192:207]
    ds_read_b64_tr_b16 v[76:77], v34 offset:20480
    ds_read_b64_tr_b16 v[78:79], v34 offset:20992
    v_mfma_f32_32x32x16_bf16 v[208:223], v[56:59], v[44:47], v[208:223]
    ds_read_b64_tr_b16 v[80:81], v34 offset:24576
    ds_read_b64_tr_b16 v[82:83], v34 offset:25088
    v_mfma_f32_32x32x16_bf16 v[224:239], v[60:63], v[40:43], v[224:239]
    ds_read_b64_tr_b16 v[84:85], v34 offset:28672
    ds_read_b64_tr_b16 v[86:87], v34 offset:29184
    v_mfma_f32_32x32x16_bf16 v[240:255], v[60:63], v[44:47], v[240:255]
    s_cmp_lg_u32 s35, 1
    s_cbranch_scc1 L_cp_191
    s_lshl_b32 s76, s86, 1
    s_add_u32 s76, s76, s72
    s_lshl_b32 s76, s76, 3
    s_add_u32 s76, s76, s3
    s_lshl_b32 s76, s76, 9
    s_lshl_b32 s77, s73, 8
    s_add_u32 s76, s76, s77
    s_add_u32 s76, s76, 131072
    s_add_u32 s77, s76, 4096
    v_lshlrev_b32 v18, 3, v1
    v_mov_b32 v114, v113
    v_mov_b32 v113, s68
    v_mov_b32 v115, s68
    s_mov_b32 exec_hi, 0
    buffer_store_dwordx2 v[112:113], v18, s[12:15], s76 offen sc1
    s_mov_b32 exec_hi, -1
L_cp_191:
    s_waitcnt lgkmcnt(0)
    v_mfma_f32_32x32x16_bf16 v[128:143], v[64:67], v[72:75], v[128:143]
    ds_read_b128 v[88:91], v33 offset:32768
    ds_read_b128 v[92:95], v33 offset:36864
    v_mfma_f32_32x32x16_bf16 v[144:159], v[68:71], v[72:75], v[144:159]
    ds_read_b64_tr_b16 v[96:97], v34 offset:18432
    ds_read_b64_tr_b16 v[98:99], v34 offset:18944
    v_mfma_f32_32x32x16_bf16 v[160:175], v[64:67], v[76:79], v[160:175]
    ds_read_b64_tr_b16 v[100:101], v34 offset:22528
    ds_read_b64_tr_b16 v[102:103], v34 offset:23040
    v_mfma_f32_32x32x16_bf16 v[176:191], v[68:71], v[76:79], v[176:191]
    ds_read_b64_tr_b16 v[104:105], v34 offset:26624
    ds_read_b64_tr_b16 v[106:107], v34 offset:27136
    v_mfma_f32_32x32x16_bf16 v[192:207], v[80:83], v[64:67], v[192:207]
    ds_read_b64_tr_b16 v[108:109], v34 offset:30720
    ds_read_b64_tr_b16 v[110:111], v34 offset:31232
    v_mfma_f32_32x32x16_bf16 v[208:223], v[80:83], v[68:71], v[208:223]
    ds_read_b32 v24, v3 offset:8
    v_mfma_f32_32x32x16_bf16 v[224:239], v[84:87], v[64:67], v[224:239]
    v_mfma_f32_32x32x16_bf16 v[240:255], v[84:87], v[68:71], v[240:255]
    s_waitcnt lgkmcnt(1)
    v_mfma_f32_32x32x16_bf16 v[128:143], v[88:91], v[96:99], v[128:143]
    v_mov_b32 v23, 6
    ds_write_b32 v4, v23 offset:16
    v_mfma_f32_32x32x16_bf16 v[144:159], v[92:95], v[96:99], v[144:159]
    s_waitcnt lgkmcnt(1)
    v_readfirstlane_b32 s89, v24
    s_nop 0
    s_cmp_ge_u32 s89, 2
    s_cbranch_scc1 L_bk_193
L_sl_192:
    s_mov_b32 s100, 0
L_sp_194:
    s_sleep 1
    ds_read_b32 v24, v3 offset:8
    s_waitcnt lgkmcnt(0)
    v_readfirstlane_b32 s89, v24
    s_nop 0
    s_cmp_ge_u32 s89, 2
    s_cbranch_scc1 L_bk_193
    s_add_u32 s100, s100, 1
    s_cmp_lt_u32 s100, 8388608
    s_cbranch_scc1 L_sp_194
L_bk_193:
    v_mfma_f32_32x32x16_bf16 v[160:175], v[88:91], v[100:103], v[160:175]
    ds_read_b128 v[40:43], v30 offset:49152
    ds_read_b128 v[44:47], v30 offset:53248
    v_mfma_f32_32x32x16_bf16 v[176:191], v[92:95], v[100:103], v[176:191]
    ds_read_b64_tr_b16 v[48:49], v34 offset:32768
    ds_read_b64_tr_b16 v[50:51], v34 offset:33280
    v_mfma_f32_32x32x16_bf16 v[192:207], v[104:107], v[88:91], v[192:207]
    ds_read_b64_tr_b16 v[52:53], v34 offset:36864
    ds_read_b64_tr_b16 v[54:55], v34 offset:37376
    v_mfma_f32_32x32x16_bf16 v[208:223], v[104:107], v[92:95], v[208:223]
    ds_read_b64_tr_b16 v[56:57], v34 offset:40960
    ds_read_b64_tr_b16 v[58:59], v34 offset:41472
    v_mfma_f32_32x32x16_bf16 v[224:239], v[108:111], v[88:91], v[224:239]
    ds_read_b64_tr_b16 v[60:61], v34 offset:45056
    ds_read_b64_tr_b16 v[62:63], v34 offset:45568
    v_mfma_f32_32x32x16_bf16 v[240:255], v[108:111], v[92:95], v[240:255]
    s_waitcnt lgkmcnt(0)
    v_mfma_f32_32x32x16_bf16 v[128:143], v[40:43], v[48:51], v[128:143]
    ds_read_b128 v[64:67], v31 offset:49152
    ds_read_b128 v[68:71], v31 offset:53248
    v_mfma_f32_32x32x16_bf16 v[144:159], v[44:47], v[48:51], v[144:159]
    ds_read_b64_tr_b16 v[72:73], v34 offset:34816
    ds_read_b64_tr_b16 v[74:75], v34 offset:35328
    v_mfma_f32_32x32x16_bf16 v[160:175], v[40:43], v[52:55], v[160:175]
    ds_read_b64_tr_b16 v[76:77], v34 offset:38912
    ds_read_b64_tr_b16 v[78:79], v34 offset:39424
    v_mfma_f32_32x32x16_bf16 v[176:191], v[44:47], v[52:55], v[176:191]
    ds_read_b64_tr_b16 v[80:81], v34 offset:43008
    ds_read_b64_tr_b16 v[82:83], v34 offset:43520
    v_mfma_f32_32x32x16_bf16 v[192:207], v[56:59], v[40:43], v[192:207]
    ds_read_b64_tr_b16 v[84:85], v34 offset:47104
    ds_read_b64_tr_b16 v[86:87], v34 offset:47616
    v_mfma_f32_32x32x16_bf16 v[208:223], v[56:59], v[44:47], v[208:223]
    ds_read_b32 v24, v3 offset:12
    v_mfma_f32_32x32x16_bf16 v[224:239], v[60:63], v[40:43], v[224:239]
    v_mfma_f32_32x32x16_bf16 v[240:255], v[60:63], v[44:47], v[240:255]
    s_waitcnt lgkmcnt(1)
    v_mfma_f32_32x32x16_bf16 v[128:143], v[64:67], v[72:75], v[128:143]
    v_mov_b32 v23, 7
    ds_write_b32 v4, v23 offset:16
    v_mfma_f32_32x32x16_bf16 v[144:159], v[68:71], v[72:75], v[144:159]
    s_waitcnt lgkmcnt(1)
    v_readfirstlane_b32 s89, v24
    s_nop 0
    s_cmp_ge_u32 s89, 2
    s_cbranch_scc1 L_bk_196
L_sl_195:
    s_mov_b32 s100, 0
L_sp_197:
    s_sleep 1
    ds_read_b32 v24, v3 offset:12
    s_waitcnt lgkmcnt(0)
    v_readfirstlane_b32 s89, v24
    s_nop 0
    s_cmp_ge_u32 s89, 2
    s_cbranch_scc1 L_bk_196
    s_add_u32 s100, s100, 1
    s_cmp_lt_u32 s100, 8388608
    s_cbranch_scc1 L_sp_197
L_bk_196:
    v_mfma_f32_32x32x16_bf16 v[160:175], v[64:67], v[76:79], v[160:175]
    ds_read_b128 v[88:91], v32 offset:49152
    ds_read_b128 v[92:95], v32 offset:53248
    v_mfma_f32_32x32x16_bf16 v[176:191], v[68:71], v[76:79], v[176:191]
    ds_read_b64_tr_b16 v[96:97], v34 offset:49152
    ds_read_b64_tr_b16 v[98:99], v34 offset:49664
    v_mfma_f32_32x32x16_bf16 v[192:207], v[80:83], v[64:67], v[192:207]
    ds_read_b64_tr_b16 v[100:101], v34 offset:53248
    ds_read_b64_tr_b16 v[102:103], v34 offset:53760
    v_mfma_f32_32x32x16_bf16 v[208:223], v[80:83], v[68:71], v[208:223]
    ds_read_b64_tr_b16 v[104:105], v34 offset:57344
    ds_read_b64_tr_b16 v[106:107], v34 offset:57856
    v_mfma_f32_32x32x16_bf16 v[224:239], v[84:87], v[64:67], v[224:239]
    ds_read_b64_tr_b16 v[108:109], v34 offset:61440
    ds_read_b64_tr_b16 v[110:111], v34 offset:61952
    v_mfma_f32_32x32x16_bf16 v[240:255], v[84:87], v[68:71], v[240:255]
    s_waitcnt lgkmcnt(0)
    v_mfma_f32_32x32x16_bf16 v[128:143], v[88:91], v[96:99], v[128:143]
    ds_read_b128 v[40:43], v33 offset:49152
    ds_read_b128 v[44:47], v33 offset:53248
    v_mfma_f32_32x32x16_bf16 v[144:159], v[92:95], v[96:99], v[144:159]
    ds_read_b64_tr_b16 v[48:49], v34 offset:51200
    ds_read_b64_tr_b16 v[50:51], v34 offset:51712
    v_mfma_f32_32x32x16_bf16 v[160:175], v[88:91], v[100:103], v[160:175]
    ds_read_b64_tr_b16 v[52:53], v34 offset:55296
    ds_read_b64_tr_b16 v[54:55], v34 offset:55808
    v_mfma_f32_32x32x16_bf16 v[176:191], v[92:95], v[100:103], v[176:191]
    ds_read_b64_tr_b16 v[56:57], v34 offset:59392
    ds_read_b64_tr_b16 v[58:59], v34 offset:59904
    v_mfma_f32_32x32x16_bf16 v[192:207], v[104:107], v[88:91], v[192:207]
    ds_read_b64_tr_b16 v[60:61], v34 offset:63488
    ds_read_b64_tr_b16 v[62:63], v34 offset:64000
    v_mfma_f32_32x32x16_bf16 v[208:223], v[104:107], v[92:95], v[208:223]
    ds_read_b32 v24, v3 offset:0
    v_mfma_f32_32x32x16_bf16 v[224:239], v[108:111], v[88:91], v[224:239]
    v_mfma_f32_32x32x16_bf16 v[240:255], v[108:111], v[92:95], v[240:255]
    s_waitcnt lgkmcnt(1)
    v_mfma_f32_32x32x16_bf16 v[128:143], v[40:43], v[48:51], v[128:143]
    v_mov_b32 v23, 8
    ds_write_b32 v4, v23 offset:16
    v_mfma_f32_32x32x16_bf16 v[144:159], v[44:47], v[48:51], v[144:159]
    s_waitcnt lgkmcnt(1)
    v_readfirstlane_b32 s89, v24
    s_nop 0
    s_cmp_ge_u32 s89, 3
    s_cbranch_scc1 L_bk_199
L_sl_198:
    s_mov_b32 s100, 0
L_sp_200:
    s_sleep 1
    ds_read_b32 v24, v3 offset:0
    s_waitcnt lgkmcnt(0)
    v_readfirstlane_b32 s89, v24
    s_nop 0
    s_cmp_ge_u32 s89, 3
    s_cbranch_scc1 L_bk_199
    s_add_u32 s100, s100, 1
    s_cmp_lt_u32 s100, 8388608
    s_cbranch_scc1 L_sp_200
L_bk_199:
    v_mfma_f32_32x32x16_bf16 v[160:175], v[40:43], v[52:55], v[160:175]
    ds_read_b128 v[64:67], v30 offset:0
    ds_read_b128 v[68:71], v30 offset:4096
    v_mfma_f32_32x32x16_bf16 v[176:191], v[44:47], v[52:55], v[176:191]
    ds_read_b64_tr_b16 v[72:73], v34 offset:0
    ds_read_b64_tr_b16 v[74:75], v34 offset:512
    v_mfma_f32_32x32x16_bf16 v[192:207], v[56:59], v[40:43], v[192:207]
    ds_read_b64_tr_b16 v[76:77], v34 offset:4096
    ds_read_b64_tr_b16 v[78:79], v34 offset:4608
    v_mfma_f32_32x32x16_bf16 v[208:223], v[56:59], v[44:47], v[208:223]
    ds_read_b64_tr_b16 v[80:81], v34 offset:8192
    ds_read_b64_tr_b16 v[82:83], v34 offset:8704
    v_mfma_f32_32x32x16_bf16 v[224:239], v[60:63], v[40:43], v[224:239]
    ds_read_b64_tr_b16 v[84:85], v34 offset:12288
    ds_read_b64_tr_b16 v[86:87], v34 offset:12800
    v_mfma_f32_32x32x16_bf16 v[240:255], v[60:63], v[44:47], v[240:255]
    s_waitcnt lgkmcnt(0)
    v_mfma_f32_32x32x16_bf16 v[128:143], v[64:67], v[72:75], v[128:143]
    ds_read_b128 v[88:91], v31 offset:0
    ds_read_b128 v[92:95], v31 offset:4096
    v_mfma_f32_32x32x16_bf16 v[144:159], v[68:71], v[72:75], v[144:159]
    ds_read_b64_tr_b16 v[96:97], v34 offset:2048
    ds_read_b64_tr_b16 v[98:99], v34 offset:2560
    v_mfma_f32_32x32x16_bf16 v[160:175], v[64:67], v[76:79], v[160:175]
    ds_read_b64_tr_b16 v[100:101], v34 offset:6144
    ds_read_b64_tr_b16 v[102:103], v34 offset:6656
    v_mfma_f32_32x32x16_bf16 v[176:191], v[68:71], v[76:79], v[176:191]
    ds_read_b64_tr_b16 v[104:105], v34 offset:10240
    ds_read_b64_tr_b16 v[106:107], v34 offset:10752
    v_mfma_f32_32x32x16_bf16 v[192:207], v[80:83], v[64:67], v[192:207]
    ds_read_b64_tr_b16 v[108:109], v34 offset:14336
    ds_read_b64_tr_b16 v[110:111], v34 offset:14848
    v_mfma_f32_32x32x16_bf16 v[208:223], v[80:83], v[68:71], v[208:223]
    ds_read_b32 v24, v3 offset:4
    v_mfma_f32_32x32x16_bf16 v[224:239], v[84:87], v[64:67], v[224:239]
    v_mfma_f32_32x32x16_bf16 v[240:255], v[84:87], v[68:71], v[240:255]
    s_waitcnt lgkmcnt(1)
    v_mfma_f32_32x32x16_bf16 v[128:143], v[88:91], v[96:99], v[128:143]
    v_mov_b32 v23, 9
    ds_write_b32 v4, v23 offset:16
    v_mfma_f32_32x32x16_bf16 v[144:159], v[92:95], v[96:99], v[144:159]
    s_waitcnt lgkmcnt(1)
    v_readfirstlane_b32 s89, v24
    s_nop 0
    s_cmp_ge_u32 s89, 3
    s_cbranch_scc1 L_bk_202
L_sl_201:
    s_mov_b32 s100, 0
L_sp_203:
    s_sleep 1
    ds_read_b32 v24, v3 offset:4
    s_waitcnt lgkmcnt(0)
    v_readfirstlane_b32 s89, v24
    s_nop 0
    s_cmp_ge_u32 s89, 3
    s_cbranch_scc1 L_bk_202
    s_add_u32 s100, s100, 1
    s_cmp_lt_u32 s100, 8388608
    s_cbranch_scc1 L_sp_203
L_bk_202:
    v_mfma_f32_32x32x16_bf16 v[160:175], v[88:91], v[100:103], v[160:175]
    ds_read_b128 v[40:43], v32 offset:0
    ds_read_b128 v[44:47], v32 offset:4096
    v_mfma_f32_32x32x16_bf16 v[176:191], v[92:95], v[100:103], v[176:191]
    ds_read_b64_tr_b16 v[48:49], v34 offset:16384
    ds_read_b64_tr_b16 v[50:51], v34 offset:16896
    v_mfma_f32_32x32x16_bf16 v[192:207], v[104:107], v[88:91], v[192:207]
    ds_read_b64_tr_b16 v[52:53], v34 offset:20480
    ds_read_b64_tr_b16 v[54:55], v34 offset:20992
    v_mfma_f32_32x32x16_bf16 v[208:223], v[104:107], v[92:95], v[208:223]
    ds_read_b64_tr_b16 v[56:57], v34 offset:24576
    ds_read_b64_tr_b16 v[58:59], v34 offset:25088
    v_mfma_f32_32x32x16_bf16 v[224:239], v[108:111], v[88:91], v[224:239]
    ds_read_b64_tr_b16 v[60:61], v34 offset:28672
    ds_read_b64_tr_b16 v[62:63], v34 offset:29184
    v_mfma_f32_32x32x16_bf16 v[240:255], v[108:111], v[92:95], v[240:255]
    s_waitcnt lgkmcnt(0)
    v_mfma_f32_32x32x16_bf16 v[128:143], v[40:43], v[48:51], v[128:143]
    ds_read_b128 v[64:67], v33 offset:0
    ds_read_b128 v[68:71], v33 offset:4096
    v_mfma_f32_32x32x16_bf16 v[144:159], v[44:47], v[48:51], v[144:159]
    ds_read_b64_tr_b16 v[72:73], v34 offset:18432
    ds_read_b64_tr_b16 v[74:75], v34 offset:18944
    v_mfma_f32_32x32x16_bf16 v[160:175], v[40:43], v[52:55], v[160:175]
    ds_read_b64_tr_b16 v[76:77], v34 offset:22528
    ds_read_b64_tr_b16 v[78:79], v34 offset:23040
    v_mfma_f32_32x32x16_bf16 v[176:191], v[44:47], v[52:55], v[176:191]
    ds_read_b64_tr_b16 v[80:81], v34 offset:26624
    ds_read_b64_tr_b16 v[82:83], v34 offset:27136
    v_mfma_f32_32x32x16_bf16 v[192:207], v[56:59], v[40:43], v[192:207]
    ds_read_b64_tr_b16 v[84:85], v34 offset:30720
    ds_read_b64_tr_b16 v[86:87], v34 offset:31232
    v_mfma_f32_32x32x16_bf16 v[208:223], v[56:59], v[44:47], v[208:223]
    ds_read_b32 v24, v3 offset:8
    v_mfma_f32_32x32x16_bf16 v[224:239], v[60:63], v[40:43], v[224:239]
    v_mfma_f32_32x32x16_bf16 v[240:255], v[60:63], v[44:47], v[240:255]
    s_waitcnt lgkmcnt(1)
    v_mfma_f32_32x32x16_bf16 v[128:143], v[64:67], v[72:75], v[128:143]
    v_mov_b32 v23, 10
    ds_write_b32 v4, v23 offset:16
    v_mfma_f32_32x32x16_bf16 v[144:159], v[68:71], v[72:75], v[144:159]
    s_waitcnt lgkmcnt(1)
    v_readfirstlane_b32 s89, v24
    s_nop 0
    s_cmp_ge_u32 s89, 3
    s_cbranch_scc1 L_bk_205
L_sl_204:
    s_mov_b32 s100, 0
L_sp_206:
    s_sleep 1
    ds_read_b32 v24, v3 offset:8
    s_waitcnt lgkmcnt(0)
    v_readfirstlane_b32 s89, v24
    s_nop 0
    s_cmp_ge_u32 s89, 3
    s_cbranch_scc1 L_bk_205
    s_add_u32 s100, s100, 1
    s_cmp_lt_u32 s100, 8388608
    s_cbranch_scc1 L_sp_206
L_bk_205:
    v_mfma_f32_32x32x16_bf16 v[160:175], v[64:67], v[76:79], v[160:175]
    ds_read_b128 v[88:91], v30 offset:16384
    ds_read_b128 v[92:95], v30 offset:20480
    v_mfma_f32_32x32x16_bf16 v[176:191], v[68:71], v[76:79], v[176:191]
    ds_read_b64_tr_b16 v[96:97], v34 offset:32768
    ds_read_b64_tr_b16 v[98:99], v34 offset:33280
    v_mfma_f32_32x32x16_bf16 v[192:207], v[80:83], v[64:67], v[192:207]
    ds_read_b64_tr_b16 v[100:101], v34 offset:36864
    ds_read_b64_tr_b16 v[102:103], v34 offset:37376
    v_mfma_f32_32x32x16_bf16 v[208:223], v[80:83], v[68:71], v[208:223]
    ds_read_b64_tr_b16 v[104:105], v34 offset:40960
    ds_read_b64_tr_b16 v[106:107], v34 offset:41472
    v_mfma_f32_32x32x16_bf16 v[224:239], v[84:87], v[64:67], v[224:239]
    ds_read_b64_tr_b16 v[108:109], v34 offset:45056
    ds_read_b64_tr_b16 v[110:111], v34 offset:45568
    v_mfma_f32_32x32x16_bf16 v[240:255], v[84:87], v[68:71], v[240:255]
    s_waitcnt lgkmcnt(0)
    v_mfma_f32_32x32x16_bf16 v[128:143], v[88:91], v[96:99], v[128:143]
    ds_read_b128 v[40:43], v31 offset:16384
    ds_read_b128 v[44:47], v31 offset:20480
    v_mfma_f32_32x32x16_bf16 v[144:159], v[92:95], v[96:99], v[144:159]
    ds_read_b64_tr_b16 v[48:49], v34 offset:34816
    ds_read_b64_tr_b16 v[50:51], v34 offset:35328
    v_mfma_f32_32x32x16_bf16 v[160:175], v[88:91], v[100:103], v[160:175]
    ds_read_b64_tr_b16 v[52:53], v34 offset:38912
    ds_read_b64_tr_b16 v[54:55], v34 offset:39424
    v_mfma_f32_32x32x16_bf16 v[176:191], v[92:95], v[100:103], v[176:191]
    ds_read_b64_tr_b16 v[56:57], v34 offset:43008
    ds_read_b64_tr_b16 v[58:59], v34 offset:43520
    v_mfma_f32_32x32x16_bf16 v[192:207], v[104:107], v[88:91], v[192:207]
    ds_read_b64_tr_b16 v[60:61], v34 offset:47104
    ds_read_b64_tr_b16 v[62:63], v34 offset:47616
    v_mfma_f32_32x32x16_bf16 v[208:223], v[104:107], v[92:95], v[208:223]
    ds_read_b32 v24, v3 offset:12
    v_mfma_f32_32x32x16_bf16 v[224:239], v[108:111], v[88:91], v[224:239]
    v_mfma_f32_32x32x16_bf16 v[240:255], v[108:111], v[92:95], v[240:255]
    s_waitcnt lgkmcnt(1)
    v_mfma_f32_32x32x16_bf16 v[128:143], v[40:43], v[48:51], v[128:143]
    v_mov_b32 v23, 11
    ds_write_b32 v4, v23 offset:16
    v_mfma_f32_32x32x16_bf16 v[144:159], v[44:47], v[48:51], v[144:159]
    s_waitcnt lgkmcnt(1)
    v_readfirstlane_b32 s89, v24
    s_nop 0
    s_cmp_ge_u32 s89, 3
    s_cbranch_scc1 L_bk_208
L_sl_207:
    s_mov_b32 s100, 0
L_sp_209:
    s_sleep 1
    ds_read_b32 v24, v3 offset:12
    s_waitcnt lgkmcnt(0)
    v_readfirstlane_b32 s89, v24
    s_nop 0
    s_cmp_ge_u32 s89, 3
    s_cbranch_scc1 L_bk_208
    s_add_u32 s100, s100, 1
    s_cmp_lt_u32 s100, 8388608
    s_cbranch_scc1 L_sp_209
L_bk_208:
    v_mfma_f32_32x32x16_bf16 v[160:175], v[40:43], v[52:55], v[160:175]
    ds_read_b128 v[64:67], v32 offset:16384
    ds_read_b128 v[68:71], v32 offset:20480
    v_mfma_f32_32x32x16_bf16 v[176:191], v[44:47], v[52:55], v[176:191]
    ds_read_b64_tr_b16 v[72:73], v34 offset:49152
    ds_read_b64_tr_b16 v[74:75], v34 offset:49664
    v_mfma_f32_32x32x16_bf16 v[192:207], v[56:59], v[40:43], v[192:207]
    ds_read_b64_tr_b16 v[76:77], v34 offset:53248
    ds_read_b64_tr_b16 v[78:79], v34 offset:53760
    v_mfma_f32_32x32x16_bf16 v[208:223], v[56:59], v[44:47], v[208:223]
    ds_read_b64_tr_b16 v[80:81], v34 offset:57344
    ds_read_b64_tr_b16 v[82:83], v34 offset:57856
    v_mfma_f32_32x32x16_bf16 v[224:239], v[60:63], v[40:43], v[224:239]
    ds_read_b64_tr_b16 v[84:85], v34 offset:61440
    ds_read_b64_tr_b16 v[86:87], v34 offset:61952
    v_mfma_f32_32x32x16_bf16 v[240:255], v[60:63], v[44:47], v[240:255]
    s_waitcnt lgkmcnt(0)
    v_mfma_f32_32x32x16_bf16 v[128:143], v[64:67], v[72:75], v[128:143]
    ds_read_b128 v[88:91], v33 offset:16384
    ds_read_b128 v[92:95], v33 offset:20480
    v_mfma_f32_32x32x16_bf16 v[144:159], v[68:71], v[72:75], v[144:159]
    ds_read_b64_tr_b16 v[96:97], v34 offset:51200
    ds_read_b64_tr_b16 v[98:99], v34 offset:51712
    v_mfma_f32_32x32x16_bf16 v[160:175], v[64:67], v[76:79], v[160:175]
    ds_read_b64_tr_b16 v[100:101], v34 offset:55296
    ds_read_b64_tr_b16 v[102:103], v34 offset:55808
    v_mfma_f32_32x32x16_bf16 v[176:191], v[68:71], v[76:79], v[176:191]
    ds_read_b64_tr_b16 v[104:105], v34 offset:59392
    ds_read_b64_tr_b16 v[106:107], v34 offset:59904
    v_mfma_f32_32x32x16_bf16 v[192:207], v[80:83], v[64:67], v[192:207]
    ds_read_b64_tr_b16 v[108:109], v34 offset:63488
    ds_read_b64_tr_b16 v[110:111], v34 offset:64000
    v_mfma_f32_32x32x16_bf16 v[208:223], v[80:83], v[68:71], v[208:223]
    ds_read_b32 v24, v3 offset:0
    v_mfma_f32_32x32x16_bf16 v[224:239], v[84:87], v[64:67], v[224:239]
    v_mfma_f32_32x32x16_bf16 v[240:255], v[84:87], v[68:71], v[240:255]
    s_waitcnt lgkmcnt(1)
    v_mfma_f32_32x32x16_bf16 v[128:143], v[88:91], v[96:99], v[128:143]
    v_mov_b32 v23, 12
    ds_write_b32 v4, v23 offset:16
    v_mfma_f32_32x32x16_bf16 v[144:159], v[92:95], v[96:99], v[144:159]
    s_waitcnt lgkmcnt(1)
    v_readfirstlane_b32 s89, v24
    s_nop 0
    s_cmp_ge_u32 s89, 4
    s_cbranch_scc1 L_bk_211
L_sl_210:
    s_mov_b32 s100, 0
L_sp_212:
    s_sleep 1
    ds_read_b32 v24, v3 offset:0
    s_waitcnt lgkmcnt(0)
    v_readfirstlane_b32 s89, v24
    s_nop 0
    s_cmp_ge_u32 s89, 4
    s_cbranch_scc1 L_bk_211
    s_add_u32 s100, s100, 1
    s_cmp_lt_u32 s100, 8388608
    s_cbranch_scc1 L_sp_212
L_bk_211:
    v_mfma_f32_32x32x16_bf16 v[160:175], v[88:91], v[100:103], v[160:175]
    ds_read_b128 v[40:43], v30 offset:32768
    ds_read_b128 v[44:47], v30 offset:36864
    v_mfma_f32_32x32x16_bf16 v[176:191], v[92:95], v[100:103], v[176:191]
    ds_read_b64_tr_b16 v[48:49], v34 offset:0
    ds_read_b64_tr_b16 v[50:51], v34 offset:512
    v_mfma_f32_32x32x16_bf16 v[192:207], v[104:107], v[88:91], v[192:207]
    ds_read_b64_tr_b16 v[52:53], v34 offset:4096
    ds_read_b64_tr_b16 v[54:55], v34 offset:4608
    v_mfma_f32_32x32x16_bf16 v[208:223], v[104:107], v[92:95], v[208:223]
    ds_read_b64_tr_b16 v[56:57], v34 offset:8192
    ds_read_b64_tr_b16 v[58:59], v34 offset:8704
    v_mfma_f32_32x32x16_bf16 v[224:239], v[108:111], v[88:91], v[224:239]
    ds_read_b64_tr_b16 v[60:61], v34 offset:12288
    ds_read_b64_tr_b16 v[62:63], v34 offset:12800
    v_mfma_f32_32x32x16_bf16 v[240:255], v[108:111], v[92:95], v[240:255]
    s_waitcnt lgkmcnt(0)
    v_mfma_f32_32x32x16_bf16 v[128:143], v[40:43], v[48:51], v[128:143]
    ds_read_b128 v[64:67], v31 offset:32768
    ds_read_b128 v[68:71], v31 offset:36864
    v_mfma_f32_32x32x16_bf16 v[144:159], v[44:47], v[48:51], v[144:159]
    ds_read_b64_tr_b16 v[72:73], v34 offset:2048
    ds_read_b64_tr_b16 v[74:75], v34 offset:2560
    v_mfma_f32_32x32x16_bf16 v[160:175], v[40:43], v[52:55], v[160:175]
    ds_read_b64_tr_b16 v[76:77], v34 offset:6144
    ds_read_b64_tr_b16 v[78:79], v34 offset:6656
    v_mfma_f32_32x32x16_bf16 v[176:191], v[44:47], v[52:55], v[176:191]
    ds_read_b64_tr_b16 v[80:81], v34 offset:10240
    ds_read_b64_tr_b16 v[82:83], v34 offset:10752
    v_mfma_f32_32x32x16_bf16 v[192:207], v[56:59], v[40:43], v[192:207]
    ds_read_b64_tr_b16 v[84:85], v34 offset:14336
    ds_read_b64_tr_b16 v[86:87], v34 offset:14848
    v_mfma_f32_32x32x16_bf16 v[208:223], v[56:59], v[44:47], v[208:223]
    ds_read_b32 v24, v3 offset:4
    v_mfma_f32_32x32x16_bf16 v[224:239], v[60:63], v[40:43], v[224:239]
    v_mfma_f32_32x32x16_bf16 v[240:255], v[60:63], v[44:47], v[240:255]
    s_waitcnt lgkmcnt(1)
    v_mfma_f32_32x32x16_bf16 v[128:143], v[64:67], v[72:75], v[128:143]
    v_mov_b32 v23, 13
    ds_write_b32 v4, v23 offset:16
    v_mfma_f32_32x32x16_bf16 v[144:159], v[68:71], v[72:75], v[144:159]
    s_waitcnt lgkmcnt(1)
    v_readfirstlane_b32 s89, v24
    s_nop 0
    s_cmp_ge_u32 s89, 4
    s_cbranch_scc1 L_bk_214
L_sl_213:
    s_mov_b32 s100, 0
L_sp_215:
    s_sleep 1
    ds_read_b32 v24, v3 offset:4
    s_waitcnt lgkmcnt(0)
    v_readfirstlane_b32 s89, v24
    s_nop 0
    s_cmp_ge_u32 s89, 4
    s_cbranch_scc1 L_bk_214
    s_add_u32 s100, s100, 1
    s_cmp_lt_u32 s100, 8388608
    s_cbranch_scc1 L_sp_215
L_bk_214:
    v_mfma_f32_32x32x16_bf16 v[160:175], v[64:67], v[76:79], v[160:175]
    ds_read_b128 v[88:91], v32 offset:32768
    ds_read_b128 v[92:95], v32 offset:36864
    v_mfma_f32_32x32x16_bf16 v[176:191], v[68:71], v[76:79], v[176:191]
    ds_read_b64_tr_b16 v[96:97], v34 offset:16384
    ds_read_b64_tr_b16 v[98:99], v34 offset:16896
    v_mfma_f32_32x32x16_bf16 v[192:207], v[80:83], v[64:67], v[192:207]
    ds_read_b64_tr_b16 v[100:101], v34 offset:20480
    ds_read_b64_tr_b16 v[102:103], v34 offset:20992
    v_mfma_f32_32x32x16_bf16 v[208:223], v[80:83], v[68:71], v[208:223]
    ds_read_b64_tr_b16 v[104:105], v34 offset:24576
    ds_read_b64_tr_b16 v[106:107], v34 offset:25088
    v_mfma_f32_32x32x16_bf16 v[224:239], v[84:87], v[64:67], v[224:239]
    ds_read_b64_tr_b16 v[108:109], v34 offset:28672
    ds_read_b64_tr_b16 v[110:111], v34 offset:29184
    v_mfma_f32_32x32x16_bf16 v[240:255], v[84:87], v[68:71], v[240:255]
    s_waitcnt lgkmcnt(0)
    v_mfma_f32_32x32x16_bf16 v[128:143], v[88:91], v[96:99], v[128:143]
    ds_read_b128 v[40:43], v33 offset:32768
    ds_read_b128 v[44:47], v33 offset:36864
    v_mfma_f32_32x32x16_bf16 v[144:159], v[92:95], v[96:99], v[144:159]
    ds_read_b64_tr_b16 v[48:49], v34 offset:18432
    ds_read_b64_tr_b16 v[50:51], v34 offset:18944
    v_mfma_f32_32x32x16_bf16 v[160:175], v[88:91], v[100:103], v[160:175]
    ds_read_b64_tr_b16 v[52:53], v34 offset:22528
    ds_read_b64_tr_b16 v[54:55], v34 offset:23040
    v_mfma_f32_32x32x16_bf16 v[176:191], v[92:95], v[100:103], v[176:191]
    ds_read_b64_tr_b16 v[56:57], v34 offset:26624
    ds_read_b64_tr_b16 v[58:59], v34 offset:27136
    v_mfma_f32_32x32x16_bf16 v[192:207], v[104:107], v[88:91], v[192:207]
    ds_read_b64_tr_b16 v[60:61], v34 offset:30720
    ds_read_b64_tr_b16 v[62:63], v34 offset:31232
    v_mfma_f32_32x32x16_bf16 v[208:223], v[104:107], v[92:95], v[208:223]
    ds_read_b32 v24, v3 offset:8
    v_mfma_f32_32x32x16_bf16 v[224:239], v[108:111], v[88:91], v[224:239]
    v_mfma_f32_32x32x16_bf16 v[240:255], v[108:111], v[92:95], v[240:255]
    s_waitcnt lgkmcnt(1)
    v_mfma_f32_32x32x16_bf16 v[128:143], v[40:43], v[48:51], v[128:143]
    v_mov_b32 v23, 14
    ds_write_b32 v4, v23 offset:16
    v_mfma_f32_32x32x16_bf16 v[144:159], v[44:47], v[48:51], v[144:159]
    s_waitcnt lgkmcnt(1)
    v_readfirstlane_b32 s89, v24
    s_nop 0
    s_cmp_ge_u32 s89, 4
    s_cbranch_scc1 L_bk_217
L_sl_216:
    s_mov_b32 s100, 0
L_sp_218:
    s_sleep 1
    ds_read_b32 v24, v3 offset:8
    s_waitcnt lgkmcnt(0)
    v_readfirstlane_b32 s89, v24
    s_nop 0
    s_cmp_ge_u32 s89, 4
    s_cbranch_scc1 L_bk_217
    s_add_u32 s100, s100, 1
    s_cmp_lt_u32 s100, 8388608
    s_cbranch_scc1 L_sp_218
L_bk_217:
    v_mfma_f32_32x32x16_bf16 v[160:175], v[40:43], v[52:55], v[160:175]
    ds_read_b128 v[64:67], v30 offset:49152
    ds_read_b128 v[68:71], v30 offset:53248
    v_mfma_f32_32x32x16_bf16 v[176:191], v[44:47], v[52:55], v[176:191]
    ds_read_b64_tr_b16 v[72:73], v34 offset:32768
    ds_read_b64_tr_b16 v[74:75], v34 offset:33280
    v_mfma_f32_32x32x16_bf16 v[192:207], v[56:59], v[40:43], v[192:207]
    ds_read_b64_tr_b16 v[76:77], v34 offset:36864
    ds_read_b64_tr_b16 v[78:79], v34 offset:37376
    v_mfma_f32_32x32x16_bf16 v[208:223], v[56:59], v[44:47], v[208:223]
    ds_read_b64_tr_b16 v[80:81], v34 offset:40960
    ds_read_b64_tr_b16 v[82:83], v34 offset:41472
    v_mfma_f32_32x32x16_bf16 v[224:239], v[60:63], v[40:43], v[224:239]
    ds_read_b64_tr_b16 v[84:85], v34 offset:45056
    ds_read_b64_tr_b16 v[86:87], v34 offset:45568
    v_mfma_f32_32x32x16_bf16 v[240:255], v[60:63], v[44:47], v[240:255]
    s_waitcnt lgkmcnt(0)
    v_mfma_f32_32x32x16_bf16 v[128:143], v[64:67], v[72:75], v[128:143]
    ds_read_b128 v[88:91], v31 offset:49152
    ds_read_b128 v[92:95], v31 offset:53248
    v_mfma_f32_32x32x16_bf16 v[144:159], v[68:71], v[72:75], v[144:159]
    ds_read_b64_tr_b16 v[96:97], v34 offset:34816
    ds_read_b64_tr_b16 v[98:99], v34 offset:35328
    v_mfma_f32_32x32x16_bf16 v[160:175], v[64:67], v[76:79], v[160:175]
    ds_read_b64_tr_b16 v[100:101], v34 offset:38912
    ds_read_b64_tr_b16 v[102:103], v34 offset:39424
    v_mfma_f32_32x32x16_bf16 v[176:191], v[68:71], v[76:79], v[176:191]
    ds_read_b64_tr_b16 v[104:105], v34 offset:43008
    ds_read_b64_tr_b16 v[106:107], v34 offset:43520
    v_mfma_f32_32x32x16_bf16 v[192:207], v[80:83], v[64:67], v[192:207]
    ds_read_b64_tr_b16 v[108:109], v34 offset:47104
    ds_read_b64_tr_b16 v[110:111], v34 offset:47616
    v_mfma_f32_32x32x16_bf16 v[208:223], v[80:83], v[68:71], v[208:223]
    ds_read_b32 v24, v3 offset:12
    v_mfma_f32_32x32x16_bf16 v[224:239], v[84:87], v[64:67], v[224:239]
    v_mfma_f32_32x32x16_bf16 v[240:255], v[84:87], v[68:71], v[240:255]
    s_waitcnt lgkmcnt(1)
    v_mfma_f32_32x32x16_bf16 v[128:143], v[88:91], v[96:99], v[128:143]
    v_mov_b32 v23, 15
    ds_write_b32 v4, v23 offset:16
    v_mfma_f32_32x32x16_bf16 v[144:159], v[92:95], v[96:99], v[144:159]
    s_waitcnt lgkmcnt(1)
    v_readfirstlane_b32 s89, v24
    s_nop 0
    s_cmp_ge_u32 s89, 4
    s_cbranch_scc1 L_bk_220
L_sl_219:
    s_mov_b32 s100, 0
L_sp_221:
    s_sleep 1
    ds_read_b32 v24, v3 offset:12
    s_waitcnt lgkmcnt(0)
    v_readfirstlane_b32 s89, v24
    s_nop 0
    s_cmp_ge_u32 s89, 4
    s_cbranch_scc1 L_bk_220
    s_add_u32 s100, s100, 1
    s_cmp_lt_u32 s100, 8388608
    s_cbranch_scc1 L_sp_221
L_bk_220:
    v_mfma_f32_32x32x16_bf16 v[160:175], v[88:91], v[100:103], v[160:175]
    ds_read_b128 v[40:43], v32 offset:49152
    ds_read_b128 v[44:47], v32 offset:53248
    v_mfma_f32_32x32x16_bf16 v[176:191], v[92:95], v[100:103], v[176:191]
    ds_read_b64_tr_b16 v[48:49], v34 offset:49152
    ds_read_b64_tr_b16 v[50:51], v34 offset:49664
    v_mfma_f32_32x32x16_bf16 v[192:207], v[104:107], v[88:91], v[192:207]
    ds_read_b64_tr_b16 v[52:53], v34 offset:53248
    ds_read_b64_tr_b16 v[54:55], v34 offset:53760
    v_mfma_f32_32x32x16_bf16 v[208:223], v[104:107], v[92:95], v[208:223]
    ds_read_b64_tr_b16 v[56:57], v34 offset:57344
    ds_read_b64_tr_b16 v[58:59], v34 offset:57856
    v_mfma_f32_32x32x16_bf16 v[224:239], v[108:111], v[88:91], v[224:239]
    ds_read_b64_tr_b16 v[60:61], v34 offset:61440
    ds_read_b64_tr_b16 v[62:63], v34 offset:61952
    v_mfma_f32_32x32x16_bf16 v[240:255], v[108:111], v[92:95], v[240:255]
    s_waitcnt lgkmcnt(0)
    v_mfma_f32_32x32x16_bf16 v[128:143], v[40:43], v[48:51], v[128:143]
    ds_read_b128 v[64:67], v33 offset:49152
    ds_read_b128 v[68:71], v33 offset:53248
    v_mfma_f32_32x32x16_bf16 v[144:159], v[44:47], v[48:51], v[144:159]
    ds_read_b64_tr_b16 v[72:73], v34 offset:51200
    ds_read_b64_tr_b16 v[74:75], v34 offset:51712
    v_mfma_f32_32x32x16_bf16 v[160:175], v[40:43], v[52:55], v[160:175]
    ds_read_b64_tr_b16 v[76:77], v34 offset:55296
    ds_read_b64_tr_b16 v[78:79], v34 offset:55808
    v_mfma_f32_32x32x16_bf16 v[176:191], v[44:47], v[52:55], v[176:191]
    ds_read_b64_tr_b16 v[80:81], v34 offset:59392
    ds_read_b64_tr_b16 v[82:83], v34 offset:59904
    v_mfma_f32_32x32x16_bf16 v[192:207], v[56:59], v[40:43], v[192:207]
    ds_read_b64_tr_b16 v[84:85], v34 offset:63488
    ds_read_b64_tr_b16 v[86:87], v34 offset:64000
    v_mfma_f32_32x32x16_bf16 v[208:223], v[56:59], v[44:47], v[208:223]
    v_mfma_f32_32x32x16_bf16 v[224:239], v[60:63], v[40:43], v[224:239]
    v_mfma_f32_32x32x16_bf16 v[240:255], v[60:63], v[44:47], v[240:255]
    s_waitcnt lgkmcnt(0)
    v_mfma_f32_32x32x16_bf16 v[128:143], v[64:67], v[72:75], v[128:143]
    v_mov_b32 v23, 16
    ds_write_b32 v4, v23 offset:16
    v_mfma_f32_32x32x16_bf16 v[144:159], v[68:71], v[72:75], v[144:159]
    v_mfma_f32_32x32x16_bf16 v[160:175], v[64:67], v[76:79], v[160:175]
    v_mfma_f32_32x32x16_bf16 v[176:191], v[68:71], v[76:79], v[176:191]
    v_mfma_f32_32x32x16_bf16 v[192:207], v[80:83], v[64:67], v[192:207]
    v_mfma_f32_32x32x16_bf16 v[208:223], v[80:83], v[68:71], v[208:223]
    v_mfma_f32_32x32x16_bf16 v[224:239], v[84:87], v[64:67], v[224:239]
    v_mfma_f32_32x32x16_bf16 v[240:255], v[84:87], v[68:71], v[240:255]
    ds_read_b128 v[24:27], v3 offset:32
    s_waitcnt lgkmcnt(0)
    v_min3_u32 v24, v24, v25, v26
    v_min_u32 v24, v24, v27
    s_nop 0
    v_readfirstlane_b32 s89, v24
    s_nop 0
    s_cmp_ge_u32 s89, 2
    s_cbranch_scc1 L_bk_223
L_sl_222:
    s_mov_b32 s100, 0
L_sp_224:
    s_sleep 1
    ds_read_b128 v[24:27], v3 offset:32
    s_waitcnt lgkmcnt(0)
    v_min3_u32 v24, v24, v25, v26
    v_min_u32 v24, v24, v27
    s_nop 0
    v_readfirstlane_b32 s89, v24
    s_nop 0
    s_cmp_ge_u32 s89, 2
    s_cbranch_scc1 L_bk_223
    s_add_u32 s100, s100, 1
    s_cmp_lt_u32 s100, 8388608
    s_cbranch_scc1 L_sp_224
L_bk_223:
    v_lshrrev_b32 v9, 5, v1
    v_lshlrev_b32 v10, 4, v9
    s_lshl_b32 s76, s72, 8
    s_add_u32 s76, s76, 160768
    v_add_u32 v10, s76, v10
    ds_read_b128 v[40:43], v10 offset:0
    ds_read_b128 v[44:47], v10 offset:32
    ds_read_b128 v[48:51], v10 offset:64
    ds_read_b128 v[52:55], v10 offset:96
    ds_read_b128 v[56:59], v10 offset:128
    ds_read_b128 v[60:63], v10 offset:160
    ds_read_b128 v[64:67], v10 offset:192
    ds_read_b128 v[68:71], v10 offset:224
    v_and_b32 v8, 31, v1
    v_lshlrev_b32 v11, 7, v8
    v_and_b32 v8, 7, v8
    v_lshl_add_u32 v11, v8, 4, v11
    v_lshl_add_u32 v11, v9, 3, v11
    s_add_u32 s76, s84, 131072
    v_add_u32 v11, s76, v11
    v_lshrrev_b32 v8, 3, v1
    v_and_b32 v9, 7, v1
    v_xor_b32 v12, v8, v9
    v_lshlrev_b32 v12, 4, v12
    v_lshl_add_u32 v12, v8, 7, v12
    v_add_u32 v12, s76, v12
    v_lshlrev_b32 v13, 12, v8
    v_lshl_add_u32 v13, v9, 4, v13
    s_lshl_b32 s76, s70, 19
    s_lshl_b32 s77, s73, 17
    s_add_u32 s76, s76, s77
    s_lshl_b32 s77, s69, 8
    s_add_u32 s76, s76, s77
    s_lshl_b32 s77, s72, 7
    s_add_u32 s76, s76, s77
    s_add_u32 s76, s76, 9437184
    s_waitcnt lgkmcnt(0)
    v_pk_mul_f32 v[128:129], v[128:129], v[40:41]
    v_pk_mul_f32 v[130:131], v[130:131], v[42:43]
    v_cvt_pk_bf16_f32 v128, v128, v129
    v_cvt_pk_bf16_f32 v129, v130, v131
    v_pk_mul_f32 v[132:133], v[132:133], v[44:45]
    v_pk_mul_f32 v[134:135], v[134:135], v[46:47]
    v_cvt_pk_bf16_f32 v132, v132, v133
    v_cvt_pk_bf16_f32 v133, v134, v135
    v_pk_mul_f32 v[136:137], v[136:137], v[48:49]
    v_pk_mul_f32 v[138:139], v[138:139], v[50:51]
    v_cvt_pk_bf16_f32 v136, v136, v137
    v_cvt_pk_bf16_f32 v137, v138, v139
    v_pk_mul_f32 v[140:141], v[140:141], v[52:53]
    v_pk_mul_f32 v[142:143], v[142:143], v[54:55]
    v_cvt_pk_bf16_f32 v140, v140, v141
    v_cvt_pk_bf16_f32 v141, v142, v143
    v_pk_mul_f32 v[144:145], v[144:145], v[56:57]
    v_pk_mul_f32 v[146:147], v[146:147], v[58:59]
    v_cvt_pk_bf16_f32 v144, v144, v145
    v_cvt_pk_bf16_f32 v145, v146, v147
    v_pk_mul_f32 v[148:149], v[148:149], v[60:61]
    v_pk_mul_f32 v[150:151], v[150:151], v[62:63]
    v_cvt_pk_bf16_f32 v148, v148, v149
    v_cvt_pk_bf16_f32 v149, v150, v151
    v_pk_mul_f32 v[152:153], v[152:153], v[64:65]
    v_pk_mul_f32 v[154:155], v[154:155], v[66:67]
    v_cvt_pk_bf16_f32 v152, v152, v153
    v_cvt_pk_bf16_f32 v153, v154, v155
    v_pk_mul_f32 v[156:157], v[156:157], v[68:69]
    v_pk_mul_f32 v[158:159], v[158:159], v[70:71]
    v_cvt_pk_bf16_f32 v156, v156, v157
    v_cvt_pk_bf16_f32 v157, v158, v159
    v_xor_b32 v8, 0, v11
    ds_write_b64 v8, v[128:129]
    v_xor_b32 v9, 16, v11
    ds_write_b64 v9, v[132:133]
    v_xor_b32 v8, 32, v11
    ds_write_b64 v8, v[136:137]
    v_xor_b32 v9, 48, v11
    ds_write_b64 v9, v[140:141]
    v_xor_b32 v8, 64, v11
    ds_write_b64 v8, v[144:145]
    v_xor_b32 v9, 80, v11
    ds_write_b64 v9, v[148:149]
    v_xor_b32 v8, 96, v11
    ds_write_b64 v8, v[152:153]
    v_xor_b32 v9, 112, v11
    ds_write_b64 v9, v[156:157]
    s_waitcnt lgkmcnt(0)
    ds_read_b128 v[72:75], v12 offset:0
    ds_read_b128 v[76:79], v12 offset:1024
    ds_read_b128 v[80:83], v12 offset:2048
    ds_read_b128 v[84:87], v12 offset:3072
    v_pk_mul_f32 v[160:161], v[160:161], v[40:41]
    v_pk_mul_f32 v[162:163], v[162:163], v[42:43]
    v_cvt_pk_bf16_f32 v160, v160, v161
    v_cvt_pk_bf16_f32 v161, v162, v163
    v_pk_mul_f32 v[164:165], v[164:165], v[44:45]
    v_pk_mul_f32 v[166:167], v[166:167], v[46:47]
    v_cvt_pk_bf16_f32 v164, v164, v165
    v_cvt_pk_bf16_f32 v165, v166, v167
    v_pk_mul_f32 v[168:169], v[168:169], v[48:49]
    v_pk_mul_f32 v[170:171], v[170:171], v[50:51]
    v_cvt_pk_bf16_f32 v168, v168, v169
    v_cvt_pk_bf16_f32 v169, v170, v171
    v_pk_mul_f32 v[172:173], v[172:173], v[52:53]
    v_pk_mul_f32 v[174:175], v[174:175], v[54:55]
    v_cvt_pk_bf16_f32 v172, v172, v173
    v_cvt_pk_bf16_f32 v173, v174, v175
    v_pk_mul_f32 v[176:177], v[176:177], v[56:57]
    v_pk_mul_f32 v[178:179], v[178:179], v[58:59]
    v_cvt_pk_bf16_f32 v176, v176, v177
    v_cvt_pk_bf16_f32 v177, v178, v179
    v_pk_mul_f32 v[180:181], v[180:181], v[60:61]
    v_pk_mul_f32 v[182:183], v[182:183], v[62:63]
    v_cvt_pk_bf16_f32 v180, v180, v181
    v_cvt_pk_bf16_f32 v181, v182, v183
    v_pk_mul_f32 v[184:185], v[184:185], v[64:65]
    v_pk_mul_f32 v[186:187], v[186:187], v[66:67]
    v_cvt_pk_bf16_f32 v184, v184, v185
    v_cvt_pk_bf16_f32 v185, v186, v187
    v_pk_mul_f32 v[188:189], v[188:189], v[68:69]
    v_pk_mul_f32 v[190:191], v[190:191], v[70:71]
    v_cvt_pk_bf16_f32 v188, v188, v189
    v_cvt_pk_bf16_f32 v189, v190, v191
    s_waitcnt lgkmcnt(3)
    s_add_u32 s77, s76, 0
    buffer_store_dwordx4 v[72:75], v13, s[12:15], s77 offen sc1
    s_waitcnt lgkmcnt(2)
    s_add_u32 s77, s76, 32768
    buffer_store_dwordx4 v[76:79], v13, s[12:15], s77 offen sc1
    s_waitcnt lgkmcnt(1)
    s_add_u32 s77, s76, 65536
    buffer_store_dwordx4 v[80:83], v13, s[12:15], s77 offen sc1
    s_waitcnt lgkmcnt(0)
    s_add_u32 s77, s76, 98304
    buffer_store_dwordx4 v[84:87], v13, s[12:15], s77 offen sc1
    v_xor_b32 v8, 0, v11
    ds_write_b64 v8, v[160:161]
    v_xor_b32 v9, 16, v11
    ds_write_b64 v9, v[164:165]
    v_xor_b32 v8, 32, v11
    ds_write_b64 v8, v[168:169]
    v_xor_b32 v9, 48, v11
    ds_write_b64 v9, v[172:173]
    v_xor_b32 v8, 64, v11
    ds_write_b64 v8, v[176:177]
    v_xor_b32 v9, 80, v11
    ds_write_b64 v9, v[180:181]
    v_xor_b32 v8, 96, v11
    ds_write_b64 v8, v[184:185]
    v_xor_b32 v9, 112, v11
    ds_write_b64 v9, v[188:189]
    s_waitcnt lgkmcnt(0)
    ds_read_b128 v[88:91], v12 offset:0
    ds_read_b128 v[92:95], v12 offset:1024
    ds_read_b128 v[96:99], v12 offset:2048
    ds_read_b128 v[100:103], v12 offset:3072
    s_waitcnt lgkmcnt(3)
    s_add_u32 s77, s76, 262144
    buffer_store_dwordx4 v[88:91], v13, s[12:15], s77 offen sc1
    s_waitcnt lgkmcnt(2)
    s_add_u32 s77, s76, 294912
    buffer_store_dwordx4 v[92:95], v13, s[12:15], s77 offen sc1
    s_waitcnt lgkmcnt(1)
    s_add_u32 s77, s76, 327680
    buffer_store_dwordx4 v[96:99], v13, s[12:15], s77 offen sc1
    s_waitcnt lgkmcnt(0)
    s_add_u32 s77, s76, 360448
    buffer_store_dwordx4 v[100:103], v13, s[12:15], s77 offen sc1
    v_and_b32 v8, 31, v1
    v_lshlrev_b32 v8, 3, v8
    s_lshl_b32 s76, s72, 9
    s_add_u32 s76, s76, 159744
    v_add_u32 v8, s76, v8
    ds_read_b64 v[20:21], v8
    ds_read_b64 v[22:23], v8 offset:256
    s_waitcnt lgkmcnt(0)
    v_sub_f32 v12, 0, v20
    v_sub_f32 v13, 0, v20
    v_mul_f32 v14, v21, v21
    v_mul_f32 v15, v21, v21
    v_sub_f32 v16, 0, v22
    v_sub_f32 v17, 0, v22
    v_mul_f32 v18, v23, v23
    v_mul_f32 v19, v23, v23
    v_lshrrev_b32 v9, 5, v1
    v_lshlrev_b32 v9, 4, v9
    s_lshl_b32 s76, s73, 7
    s_add_u32 s76, s76, 162304
    v_add_u32 v9, s76, v9
    ds_read_b128 v[40:43], v9 offset:0
    ds_read_b128 v[44:47], v9 offset:32
    ds_read_b128 v[48:51], v9 offset:64
    ds_read_b128 v[52:55], v9 offset:96
    ds_read_b128 v[56:59], v9 offset:256
    ds_read_b128 v[60:63], v9 offset:288
    ds_read_b128 v[64:67], v9 offset:320
    ds_read_b128 v[68:71], v9 offset:352
    s_lshl_b32 s76, s69, 2
    s_lshl_b32 s77, s72, 1
    s_add_u32 s76, s76, s77
    s_mul_i32 s76, s76, 56
    s_lshl_b32 s77, s86, 1
    s_add_u32 s76, s76, s77
    s_add_u32 s76, s76, s73
    s_lshl_b32 s76, s76, 11
    s_add_u32 s76, s76, 1048576
    s_add_u32 s77, s76, 114688
    s_waitcnt lgkmcnt(0)
    v_pk_fma_f32 v[192:193], v[12:13], v[40:41], v[192:193]
    v_pk_fma_f32 v[194:195], v[12:13], v[42:43], v[194:195]
    v_pk_fma_f32 v[196:197], v[12:13], v[44:45], v[196:197]
    v_pk_fma_f32 v[198:199], v[12:13], v[46:47], v[198:199]
    v_pk_fma_f32 v[224:225], v[12:13], v[56:57], v[224:225]
    v_pk_fma_f32 v[226:227], v[12:13], v[58:59], v[226:227]
    v_pk_fma_f32 v[228:229], v[12:13], v[60:61], v[228:229]
    v_pk_fma_f32 v[230:231], v[12:13], v[62:63], v[230:231]
    v_max_f32 v192, 0, v192
    v_max_f32 v193, 0, v193
    v_max_f32 v194, 0, v194
    v_max_f32 v195, 0, v195
    v_max_f32 v196, 0, v196
    v_max_f32 v197, 0, v197
    v_max_f32 v198, 0, v198
    v_max_f32 v199, 0, v199
    v_pk_mul_f32 v[224:225], v[224:225], v[14:15]
    v_pk_mul_f32 v[226:227], v[226:227], v[14:15]
    v_pk_mul_f32 v[228:229], v[228:229], v[14:15]
    v_pk_mul_f32 v[230:231], v[230:231], v[14:15]
    v_pk_mul_f32 v[192:193], v[192:193], v[224:225]
    v_pk_mul_f32 v[194:195], v[194:195], v[226:227]
    v_pk_mul_f32 v[196:197], v[196:197], v[228:229]
    v_pk_mul_f32 v[198:199], v[198:199], v[230:231]
    v_cvt_pk_bf16_f32 v128, v192, v193
    v_cvt_pk_bf16_f32 v129, v194, v195
    v_cvt_pk_bf16_f32 v130, v196, v197
    v_cvt_pk_bf16_f32 v131, v198, v199
    buffer_store_dwordx4 v[128:131], v2, s[12:15], s76 offen offset:0 sc1
    v_pk_fma_f32 v[200:201], v[12:13], v[48:49], v[200:201]
    v_pk_fma_f32 v[202:203], v[12:13], v[50:51], v[202:203]
    v_pk_fma_f32 v[204:205], v[12:13], v[52:53], v[204:205]
    v_pk_fma_f32 v[206:207], v[12:13], v[54:55], v[206:207]
    v_pk_fma_f32 v[232:233], v[12:13], v[64:65], v[232:233]
    v_pk_fma_f32 v[234:235], v[12:13], v[66:67], v[234:235]
    v_pk_fma_f32 v[236:237], v[12:13], v[68:69], v[236:237]
    v_pk_fma_f32 v[238:239], v[12:13], v[70:71], v[238:239]
    v_max_f32 v200, 0, v200
    v_max_f32 v201, 0, v201
    v_max_f32 v202, 0, v202
    v_max_f32 v203, 0, v203
    v_max_f32 v204, 0, v204
    v_max_f32 v205, 0, v205
    v_max_f32 v206, 0, v206
    v_max_f32 v207, 0, v207
    v_pk_mul_f32 v[232:233], v[232:233], v[14:15]
    v_pk_mul_f32 v[234:235], v[234:235], v[14:15]
    v_pk_mul_f32 v[236:237], v[236:237], v[14:15]
    v_pk_mul_f32 v[238:239], v[238:239], v[14:15]
    v_pk_mul_f32 v[200:201], v[200:201], v[232:233]
    v_pk_mul_f32 v[202:203], v[202:203], v[234:235]
    v_pk_mul_f32 v[204:205], v[204:205], v[236:237]
    v_pk_mul_f32 v[206:207], v[206:207], v[238:239]
    v_cvt_pk_bf16_f32 v132, v200, v201
    v_cvt_pk_bf16_f32 v133, v202, v203
    v_cvt_pk_bf16_f32 v134, v204, v205
    v_cvt_pk_bf16_f32 v135, v206, v207
    buffer_store_dwordx4 v[132:135], v2, s[12:15], s76 offen offset:1024 sc1
    v_pk_fma_f32 v[208:209], v[16:17], v[40:41], v[208:209]
    v_pk_fma_f32 v[210:211], v[16:17], v[42:43], v[210:211]
    v_pk_fma_f32 v[212:213], v[16:17], v[44:45], v[212:213]
    v_pk_fma_f32 v[214:215], v[16:17], v[46:47], v[214:215]
    v_pk_fma_f32 v[240:241], v[16:17], v[56:57], v[240:241]
    v_pk_fma_f32 v[242:243], v[16:17], v[58:59], v[242:243]
    v_pk_fma_f32 v[244:245], v[16:17], v[60:61], v[244:245]
    v_pk_fma_f32 v[246:247], v[16:17], v[62:63], v[246:247]
    v_max_f32 v208, 0, v208
    v_max_f32 v209, 0, v209
    v_max_f32 v210, 0, v210
    v_max_f32 v211, 0, v211
    v_max_f32 v212, 0, v212
    v_max_f32 v213, 0, v213
    v_max_f32 v214, 0, v214
    v_max_f32 v215, 0, v215
    v_pk_mul_f32 v[240:241], v[240:241], v[18:19]
    v_pk_mul_f32 v[242:243], v[242:243], v[18:19]
    v_pk_mul_f32 v[244:245], v[244:245], v[18:19]
    v_pk_mul_f32 v[246:247], v[246:247], v[18:19]
    v_pk_mul_f32 v[208:209], v[208:209], v[240:241]
    v_pk_mul_f32 v[210:211], v[210:211], v[242:243]
    v_pk_mul_f32 v[212:213], v[212:213], v[244:245]
    v_pk_mul_f32 v[214:215], v[214:215], v[246:247]
    v_cvt_pk_bf16_f32 v136, v208, v209
    v_cvt_pk_bf16_f32 v137, v210, v211
    v_cvt_pk_bf16_f32 v138, v212, v213
    v_cvt_pk_bf16_f32 v139, v214, v215
    buffer_store_dwordx4 v[136:139], v2, s[12:15], s77 offen offset:0 sc1
    v_pk_fma_f32 v[216:217], v[16:17], v[48:49], v[216:217]
    v_pk_fma_f32 v[218:219], v[16:17], v[50:51], v[218:219]
    v_pk_fma_f32 v[220:221], v[16:17], v[52:53], v[220:221]
    v_pk_fma_f32 v[222:223], v[16:17], v[54:55], v[222:223]
    v_pk_fma_f32 v[248:249], v[16:17], v[64:65], v[248:249]
    v_pk_fma_f32 v[250:251], v[16:17], v[66:67], v[250:251]
    v_pk_fma_f32 v[252:253], v[16:17], v[68:69], v[252:253]
    v_pk_fma_f32 v[254:255], v[16:17], v[70:71], v[254:255]
    v_max_f32 v216, 0, v216
    v_max_f32 v217, 0, v217
    v_max_f32 v218, 0, v218
    v_max_f32 v219, 0, v219
    v_max_f32 v220, 0, v220
    v_max_f32 v221, 0, v221
    v_max_f32 v222, 0, v222
    v_max_f32 v223, 0, v223
    v_pk_mul_f32 v[248:249], v[248:249], v[18:19]
    v_pk_mul_f32 v[250:251], v[250:251], v[18:19]
    v_pk_mul_f32 v[252:253], v[252:253], v[18:19]
    v_pk_mul_f32 v[254:255], v[254:255], v[18:19]
    v_pk_mul_f32 v[216:217], v[216:217], v[248:249]
    v_pk_mul_f32 v[218:219], v[218:219], v[250:251]
    v_pk_mul_f32 v[220:221], v[220:221], v[252:253]
    v_pk_mul_f32 v[222:223], v[222:223], v[254:255]
    v_cvt_pk_bf16_f32 v140, v216, v217
    v_cvt_pk_bf16_f32 v141, v218, v219
    v_cvt_pk_bf16_f32 v142, v220, v221
    v_cvt_pk_bf16_f32 v143, v222, v223
    buffer_store_dwordx4 v[140:143], v2, s[12:15], s77 offen offset:1024 sc1
    s_waitcnt lgkmcnt(0)
    v_mov_b32 v27, 17
    ds_write_b32 v4, v27 offset:16
    s_waitcnt vmcnt(4)
    s_lshl_b32 s77, s69, 4
    s_add_u32 s77, s77, s70
    v_mov_b32 v24, 1
    s_mov_b64 exec, 1
    ds_add_rtn_u32 v25, v3, v24 offset:64
    s_mov_b64 exec, -1
    s_waitcnt lgkmcnt(0)
    v_readfirstlane_b32 s78, v25
    s_nop 0
    s_cmp_lg_u32 s78, 3
    s_cbranch_scc1 L_nl_225
    s_lshl_b32 s78, s77, 7
    s_add_u32 s78, s78, 393216
    v_mov_b32 v28, s68
    v_mov_b32 v29, 0
    s_mov_b64 exec, 1
    buffer_store_dword v28, v29, s[12:15], s78 offen sc1
    s_mov_b64 exec, -1
L_nl_225:
L_c_join:
    s_waitcnt lgkmcnt(0)
    v_lshrrev_b32 v8, 3, v1
    v_and_b32 v9, 7, v1
    v_lshrrev_b32 v10, 2, v1
    v_and_b32 v10, 4, v10
    v_xor_b32 v10, v10, v9
    v_lshlrev_b32 v10, 4, v10
    v_mul_u32_u24 v11, 1024, v8
    v_add_u32 v30, v10, v11
    v_mul_u32_u24 v11, 4096, v8
    v_add_u32 v31, v10, v11
    s_mul_i32 s36, s87, 229376
    s_add_u32 s36, s36, 1048576
    s_lshl_b32 s37, s88, 7
    s_lshl_b32 s38, s71, 19
    s_lshl_b32 s76, s87, 7
    s_add_u32 s38, s38, s76
    s_add_u32 s38, s38, 11534336
    s_lshl_b32 s39, s88, 16
    s_lshl_b32 s76, s71, 14
    s_add_u32 s39, s39, s76
    s_add_u32 s39, s39, 0
    s_lshl_b32 s37, s88, 7
    s_lshl_b32 s90, s71, 15
    s_add_u32 s91, s90, 16384
    s_and_b32 s100, s87, 3
    s_lshl_b32 s100, s100, 2
    s_lshr_b32 s100, 0x5320, s100
    s_and_b32 s100, s100, 15
    s_add_u32 s100, s100, s88
    s_mul_i32 s76, s100, 43
    s_lshr_b32 s76, s76, 8
    s_mul_i32 s76, s76, 6
    s_sub_u32 s44, s100, s76
    s_mul_i32 s47, s71, 6
    v_lshrrev_b32 v8, 2, v1
    v_and_b32 v8, 3, v8
    v_lshrrev_b32 v9, 5, v1
    v_lshlrev_b32 v9, 2, v9
    v_add_u32 v9, v9, v8
    v_lshlrev_b32 v9, 7, v9
    v_lshrrev_b32 v8, 1, v8
    v_lshl_add_u32 v9, v8, 6, v9
    v_and_b32 v8, 16, v1
    v_lshl_add_u32 v9, v8, 1, v9
    v_and_b32 v8, 3, v1
    v_lshl_add_u32 v9, v8, 3, v9
    v_add_u32 v32, s90, v9
    v_lshrrev_b32 v8, 2, v1
    v_and_b32 v8, 3, v8
    v_lshrrev_b32 v9, 5, v1
    v_lshlrev_b32 v9, 2, v9
    v_add_u32 v9, v9, v8
    v_lshlrev_b32 v9, 7, v9
    v_lshrrev_b32 v8, 1, v8
    v_xor_b32 v8, 1, v8
    v_lshl_add_u32 v9, v8, 6, v9
    v_and_b32 v8, 16, v1
    v_lshl_add_u32 v9, v8, 1, v9
    v_and_b32 v8, 3, v1
    v_lshl_add_u32 v9, v8, 3, v9
    v_add_u32 v33, s90, v9
    v_lshrrev_b32 v8, 2, v1
    v_and_b32 v8, 3, v8
    v_lshrrev_b32 v9, 5, v1
    v_lshlrev_b32 v9, 3, v9
    v_add_u32 v9, v9, v8
    v_lshlrev_b32 v9, 7, v9
    v_lshrrev_b32 v8, 1, v8
    v_lshl_add_u32 v9, v8, 6, v9
    v_and_b32 v8, 16, v1
    v_lshl_add_u32 v9, v8, 1, v9
    v_and_b32 v8, 3, v1
    v_lshl_add_u32 v9, v8, 3, v9
    v_add_u32 v36, s90, v9
    v_lshrrev_b32 v8, 2, v1
    v_and_b32 v8, 3, v8
    v_lshrrev_b32 v9, 5, v1
    v_lshlrev_b32 v9, 3, v9
    v_add_u32 v9, v9, v8
    v_lshlrev_b32 v9, 7, v9
    v_lshrrev_b32 v8, 1, v8
    v_xor_b32 v8, 1, v8
    v_lshl_add_u32 v9, v8, 6, v9
    v_and_b32 v8, 16, v1
    v_lshl_add_u32 v9, v8, 1, v9
    v_and_b32 v8, 3, v1
    v_lshl_add_u32 v9, v8, 3, v9
    v_add_u32 v37, s90, v9
    s_sub_u32 s76, s91, s90
    v_add_u32 v34, s76, v32
    v_add_u32 v38, s76, v36
    v_add_u32 v35, s76, v33
    v_add_u32 v39, s76, v37
    s_waitcnt vmcnt(0)
    s_lshl_b32 s77, s69, 4
    s_add_u32 s77, s77, s70
    v_mov_b32 v24, 1
    s_mov_b64 exec, 1
    ds_add_rtn_u32 v25, v3, v24 offset:68
    s_mov_b64 exec, -1
    s_waitcnt lgkmcnt(0)
    v_readfirstlane_b32 s78, v25
    s_nop 0
    s_cmp_lg_u32 s78, 3
    s_cbranch_scc1 L_nl_226
    s_lshl_b32 s78, s77, 7
    s_add_u32 s78, s78, 425984
    v_mov_b32 v28, s68
    v_mov_b32 v29, 0
    s_mov_b64 exec, 1
    buffer_store_dword v28, v29, s[12:15], s78 offen sc1
    s_mov_b64 exec, -1
L_nl_226:
    ds_read_b128 v[24:27], v3 offset:16
    s_waitcnt lgkmcnt(0)
    v_min3_u32 v24, v24, v25, v26
    v_min_u32 v24, v24, v27
    s_nop 0
    v_readfirstlane_b32 s89, v24
    s_nop 0
    s_cmp_ge_u32 s89, 17
    s_cbranch_scc1 L_bk_228
L_sl_227:
    s_mov_b32 s100, 0
L_sp_229:
    s_sleep 1
    ds_read_b128 v[24:27], v3 offset:16
    s_waitcnt lgkmcnt(0)
    v_min3_u32 v24, v24, v25, v26
    v_min_u32 v24, v24, v27
    s_nop 0
    v_readfirstlane_b32 s89, v24
    s_nop 0
    s_cmp_ge_u32 s89, 17
    s_cbranch_scc1 L_bk_228
    s_add_u32 s100, s100, 1
    s_cmp_lt_u32 s100, 8388608
    s_cbranch_scc1 L_sp_229
L_bk_228:
    s_add_u32 s76, s44, 1
    s_sub_u32 s80, s76, 6
    s_cmp_ge_u32 s76, 6
    s_cselect_b32 s76, s80, s76
    s_add_u32 s76, s76, s47
    s_lshl_b32 s76, s76, 16
    s_add_u32 s76, s76, s37
    s_add_u32 m0, s90, 8192
    s_add_u32 s77, s76, 0
    buffer_load_dwordx4 v30, s[24:27], s77 offen lds
    s_add_u32 m0, s90, 9216
    s_add_u32 s77, s76, 8192
    buffer_load_dwordx4 v30, s[24:27], s77 offen lds
    s_add_u32 m0, s90, 10240
    s_add_u32 s77, s76, 16384
    buffer_load_dwordx4 v30, s[24:27], s77 offen lds
    s_add_u32 m0, s90, 11264
    s_add_u32 s77, s76, 24576
    buffer_load_dwordx4 v30, s[24:27], s77 offen lds
    s_add_u32 m0, s90, 12288
    s_add_u32 s77, s76, 32768
    buffer_load_dwordx4 v30, s[24:27], s77 offen lds
    s_add_u32 m0, s90, 13312
    s_add_u32 s77, s76, 40960
    buffer_load_dwordx4 v30, s[24:27], s77 offen lds
    s_add_u32 m0, s90, 14336
    s_add_u32 s77, s76, 49152
    buffer_load_dwordx4 v30, s[24:27], s77 offen lds
    s_add_u32 m0, s90, 15360
    s_add_u32 s77, s76, 57344
    buffer_load_dwordx4 v30, s[24:27], s77 offen lds
    s_add_u32 s76, s44, 2
    s_sub_u32 s80, s76, 6
    s_cmp_ge_u32 s76, 6
    s_cselect_b32 s76, s80, s76
    s_add_u32 s76, s76, s47
    s_lshl_b32 s76, s76, 16
    s_add_u32 s76, s76, s37
    s_add_u32 m0, s91, 0
    s_add_u32 s77, s76, 0
    buffer_load_dwordx4 v30, s[24:27], s77 offen lds
    s_add_u32 m0, s91, 1024
    s_add_u32 s77, s76, 8192
    buffer_load_dwordx4 v30, s[24:27], s77 offen lds
    s_add_u32 m0, s91, 2048
    s_add_u32 s77, s76, 16384
    buffer_load_dwordx4 v30, s[24:27], s77 offen lds
    s_add_u32 m0, s91, 3072
    s_add_u32 s77, s76, 24576
    buffer_load_dwordx4 v30, s[24:27], s77 offen lds
    s_add_u32 m0, s91, 4096
    s_add_u32 s77, s76, 32768
    buffer_load_dwordx4 v30, s[24:27], s77 offen lds
    s_add_u32 m0, s91, 5120
    s_add_u32 s77, s76, 40960
    buffer_load_dwordx4 v30, s[24:27], s77 offen lds
    s_add_u32 m0, s91, 6144
    s_add_u32 s77, s76, 49152
    buffer_load_dwordx4 v30, s[24:27], s77 offen lds
    s_add_u32 m0, s91, 7168
    s_add_u32 s77, s76, 57344
    buffer_load_dwordx4 v30, s[24:27], s77 offen lds
    s_add_u32 s76, s44, 3
    s_sub_u32 s80, s76, 6
    s_cmp_ge_u32 s76, 6
    s_cselect_b32 s76, s80, s76
    s_add_u32 s76, s76, s47
    s_lshl_b32 s76, s76, 16
    s_add_u32 s76, s76, s37
    s_add_u32 m0, s91, 8192
    s_add_u32 s77, s76, 0
    buffer_load_dwordx4 v30, s[24:27], s77 offen lds
    s_add_u32 m0, s91, 9216
    s_add_u32 s77, s76, 8192
    buffer_load_dwordx4 v30, s[24:27], s77 offen lds
    s_add_u32 m0, s91, 10240
    s_add_u32 s77, s76, 16384
    buffer_load_dwordx4 v30, s[24:27], s77 offen lds
    s_add_u32 m0, s91, 11264
    s_add_u32 s77, s76, 24576
    buffer_load_dwordx4 v30, s[24:27], s77 offen lds
    s_add_u32 m0, s91, 12288
    s_add_u32 s77, s76, 32768
    buffer_load_dwordx4 v30, s[24:27], s77 offen lds
    s_add_u32 m0, s91, 13312
    s_add_u32 s77, s76, 40960
    buffer_load_dwordx4 v30, s[24:27], s77 offen lds
    s_add_u32 m0, s91, 14336
    s_add_u32 s77, s76, 49152
    buffer_load_dwordx4 v30, s[24:27], s77 offen lds
    s_add_u32 m0, s91, 15360
    s_add_u32 s77, s76, 57344
    buffer_load_dwordx4 v30, s[24:27], s77 offen lds
    ds_read_b32 v24, v4 offset:80
    s_waitcnt lgkmcnt(0)
    v_readfirstlane_b32 s89, v24
    s_nop 0
    s_cmp_ge_u32 s89, 1
    s_cbranch_scc1 L_bk_231
L_sl_230:
    s_mov_b32 s100, 0
L_sp_232:
    s_sleep 1
    ds_read_b32 v24, v4 offset:80
    s_waitcnt lgkmcnt(0)
    v_readfirstlane_b32 s89, v24
    s_nop 0
    s_cmp_ge_u32 s89, 1
    s_cbranch_scc1 L_bk_231
    s_add_u32 s100, s100, 1
    s_cmp_lt_u32 s100, 8388608
    s_cbranch_scc1 L_sp_232
L_bk_231:
    ds_read_b64_tr_b16 v[40:41], v32 offset:0
    ds_read_b64_tr_b16 v[42:43], v32 offset:1024
    ds_read_b64_tr_b16 v[44:45], v33 offset:0
    ds_read_b64_tr_b16 v[46:47], v33 offset:1024
    ds_read_b64_tr_b16 v[48:49], v32 offset:2048
    ds_read_b64_tr_b16 v[50:51], v32 offset:3072
    ds_read_b64_tr_b16 v[52:53], v33 offset:2048
    ds_read_b64_tr_b16 v[54:55], v33 offset:3072
    ds_read_b64_tr_b16 v[56:57], v32 offset:4096
    ds_read_b64_tr_b16 v[58:59], v32 offset:5120
    ds_read_b64_tr_b16 v[60:61], v33 offset:4096
    ds_read_b64_tr_b16 v[62:63], v33 offset:5120
    ds_read_b64_tr_b16 v[64:65], v32 offset:6144
    ds_read_b64_tr_b16 v[66:67], v32 offset:7168
    ds_read_b64_tr_b16 v[68:69], v33 offset:6144
    ds_read_b64_tr_b16 v[70:71], v33 offset:7168
    s_waitcnt lgkmcnt(0)
    s_add_u32 s76, s44, 4
    s_sub_u32 s80, s76, 6
    s_cmp_ge_u32 s76, 6
    s_cselect_b32 s76, s80, s76
    s_add_u32 s76, s76, s47
    s_lshl_b32 s76, s76, 16
    s_add_u32 s76, s76, s37
    s_add_u32 m0, s90, 0
    s_add_u32 s77, s76, 0
    buffer_load_dwordx4 v30, s[24:27], s77 offen lds
    s_add_u32 m0, s90, 1024
    s_add_u32 s77, s76, 8192
    buffer_load_dwordx4 v30, s[24:27], s77 offen lds
    s_add_u32 m0, s90, 2048
    s_add_u32 s77, s76, 16384
    buffer_load_dwordx4 v30, s[24:27], s77 offen lds
    s_add_u32 m0, s90, 3072
    s_add_u32 s77, s76, 24576
    buffer_load_dwordx4 v30, s[24:27], s77 offen lds
    s_add_u32 m0, s90, 4096
    s_add_u32 s77, s76, 32768
    buffer_load_dwordx4 v30, s[24:27], s77 offen lds
    s_add_u32 m0, s90, 5120
    s_add_u32 s77, s76, 40960
    buffer_load_dwordx4 v30, s[24:27], s77 offen lds
    s_add_u32 m0, s90, 6144
    s_add_u32 s77, s76, 49152
    buffer_load_dwordx4 v30, s[24:27], s77 offen lds
    s_add_u32 m0, s90, 7168
    s_add_u32 s77, s76, 57344
    buffer_load_dwordx4 v30, s[24:27], s77 offen lds
    s_waitcnt vmcnt(24)
    ds_read_b64_tr_b16 v[72:73], v32 offset:8192
    ds_read_b64_tr_b16 v[74:75], v32 offset:9216
    ds_read_b64_tr_b16 v[76:77], v33 offset:8192
    ds_read_b64_tr_b16 v[78:79], v33 offset:9216
    ds_read_b64_tr_b16 v[80:81], v32 offset:10240
    ds_read_b64_tr_b16 v[82:83], v32 offset:11264
    ds_read_b64_tr_b16 v[84:85], v33 offset:10240
    ds_read_b64_tr_b16 v[86:87], v33 offset:11264
    ds_read_b64_tr_b16 v[88:89], v32 offset:12288
    ds_read_b64_tr_b16 v[90:91], v32 offset:13312
    ds_read_b64_tr_b16 v[92:93], v33 offset:12288
    ds_read_b64_tr_b16 v[94:95], v33 offset:13312
    ds_read_b64_tr_b16 v[96:97], v32 offset:14336
    ds_read_b64_tr_b16 v[98:99], v32 offset:15360
    ds_read_b64_tr_b16 v[100:101], v33 offset:14336
    ds_read_b64_tr_b16 v[102:103], v33 offset:15360
    s_waitcnt lgkmcnt(0)
    s_add_u32 s76, s44, 5
    s_sub_u32 s80, s76, 6
    s_cmp_ge_u32 s76, 6
    s_cselect_b32 s76, s80, s76
    s_add_u32 s76, s76, s47
    s_lshl_b32 s76, s76, 16
    s_add_u32 s76, s76, s37
    s_add_u32 m0, s90, 8192
    s_add_u32 s77, s76, 0
    buffer_load_dwordx4 v30, s[24:27], s77 offen lds
    s_add_u32 m0, s90, 9216
    s_add_u32 s77, s76, 8192
    buffer_load_dwordx4 v30, s[24:27], s77 offen lds
    s_add_u32 m0, s90, 10240
    s_add_u32 s77, s76, 16384
    buffer_load_dwordx4 v30, s[24:27], s77 offen lds
    s_add_u32 m0, s90, 11264
    s_add_u32 s77, s76, 24576
    buffer_load_dwordx4 v30, s[24:27], s77 offen lds
    s_add_u32 m0, s90, 12288
    s_add_u32 s77, s76, 32768
    buffer_load_dwordx4 v30, s[24:27], s77 offen lds
    s_add_u32 m0, s90, 13312
    s_add_u32 s77, s76, 40960
    buffer_load_dwordx4 v30, s[24:27], s77 offen lds
    s_add_u32 m0, s90, 14336
    s_add_u32 s77, s76, 49152
    buffer_load_dwordx4 v30, s[24:27], s77 offen lds
    s_add_u32 m0, s90, 15360
    s_add_u32 s77, s76, 57344
    buffer_load_dwordx4 v30, s[24:27], s77 offen lds
    s_waitcnt vmcnt(24)
    ds_read_b64_tr_b16 v[104:105], v34 offset:0
    ds_read_b64_tr_b16 v[106:107], v34 offset:1024
    ds_read_b64_tr_b16 v[108:109], v35 offset:0
    ds_read_b64_tr_b16 v[110:111], v35 offset:1024
    ds_read_b64_tr_b16 v[112:113], v34 offset:2048
    ds_read_b64_tr_b16 v[114:115], v34 offset:3072
    ds_read_b64_tr_b16 v[116:117], v35 offset:2048
    ds_read_b64_tr_b16 v[118:119], v35 offset:3072
    ds_read_b64_tr_b16 v[120:121], v34 offset:4096
    ds_read_b64_tr_b16 v[122:123], v34 offset:5120
    ds_read_b64_tr_b16 v[124:125], v35 offset:4096
    ds_read_b64_tr_b16 v[126:127], v35 offset:5120
    ds_read_b64_tr_b16 v[128:129], v34 offset:6144
    ds_read_b64_tr_b16 v[130:131], v34 offset:7168
    ds_read_b64_tr_b16 v[132:133], v35 offset:6144
    ds_read_b64_tr_b16 v[134:135], v35 offset:7168
    s_waitcnt lgkmcnt(0)
    s_add_u32 s76, s71, 24
    s_lshl_b32 s76, s76, 16
    s_add_u32 s76, s76, s37
    s_add_u32 m0, s91, 0
    s_add_u32 s77, s76, 0
    buffer_load_dwordx4 v30, s[24:27], s77 offen lds
    s_add_u32 m0, s91, 1024
    s_add_u32 s77, s76, 8192
    buffer_load_dwordx4 v30, s[24:27], s77 offen lds
    s_add_u32 m0, s91, 2048
    s_add_u32 s77, s76, 16384
    buffer_load_dwordx4 v30, s[24:27], s77 offen lds
    s_add_u32 m0, s91, 3072
    s_add_u32 s77, s76, 24576
    buffer_load_dwordx4 v30, s[24:27], s77 offen lds
    s_add_u32 m0, s91, 4096
    s_add_u32 s77, s76, 32768
    buffer_load_dwordx4 v30, s[24:27], s77 offen lds
    s_add_u32 m0, s91, 5120
    s_add_u32 s77, s76, 40960
    buffer_load_dwordx4 v30, s[24:27], s77 offen lds
    s_add_u32 m0, s91, 6144
    s_add_u32 s77, s76, 49152
    buffer_load_dwordx4 v30, s[24:27], s77 offen lds
    s_add_u32 m0, s91, 7168
    s_add_u32 s77, s76, 57344
    buffer_load_dwordx4 v30, s[24:27], s77 offen lds
    v_and_b32 v8, 3, v1
    v_min_u32 v8, 2, v8
    v_lshlrev_b32 v8, 7, v8
    s_lshr_b32 s35, s87, 1
    s_lshl_b32 s35, s35, 11
    s_add_u32 s35, s35, 425984
    s_mul_i32 s76, s71, 384
    s_add_u32 s76, s76, s35
    s_add_u32 s76, s76, 512
    v_add_u32 v6, s76, v8
    buffer_load_dword v7, v6, s[12:15], 0 offen sc1
    s_waitcnt vmcnt(0)
    v_cmp_ne_u32 vcc, s68, v7
    s_nop 4
    s_cbranch_vccz L_back_234
L_slow_233:
    s_mov_b32 s89, 0
L_spin_235:
    s_sleep 6
    buffer_load_dword v7, v6, s[12:15], 0 offen sc1
    s_waitcnt vmcnt(0)
    v_cmp_ne_u32 vcc, s68, v7
    s_nop 4
    s_cbranch_vccz L_back_234
    s_add_u32 s89, s89, 1
    s_cmp_lt_u32 s89, 1048576
    s_cbranch_scc1 L_spin_235
L_back_234:
    s_add_u32 s32, s44, 0
    s_sub_u32 s80, s32, 6
    s_cmp_ge_u32 s32, 6
    s_cselect_b32 s32, s80, s32
    s_add_u32 s32, s32, s47
    s_lshl_b32 s32, s32, 12
    s_add_u32 s32, s32, s36
    s_add_u32 s33, s32, 114688
    buffer_load_dwordx4 v[136:139], v2, s[12:15], s32 offen offset:0 sc1
    buffer_load_dwordx4 v[140:143], v2, s[12:15], s33 offen offset:0 sc1
    buffer_load_dwordx4 v[144:147], v2, s[12:15], s32 offen offset:1024 sc1
    buffer_load_dwordx4 v[148:151], v2, s[12:15], s33 offen offset:1024 sc1
    buffer_load_dwordx4 v[152:155], v2, s[12:15], s32 offen offset:2048 sc1
    buffer_load_dwordx4 v[156:159], v2, s[12:15], s33 offen offset:2048 sc1
    buffer_load_dwordx4 v[160:163], v2, s[12:15], s32 offen offset:3072 sc1
    buffer_load_dwordx4 v[164:167], v2, s[12:15], s33 offen offset:3072 sc1
    s_add_u32 s32, s44, 1
    s_sub_u32 s80, s32, 6
    s_cmp_ge_u32 s32, 6
    s_cselect_b32 s32, s80, s32
    s_add_u32 s32, s32, s47
    s_lshl_b32 s32, s32, 12
    s_add_u32 s32, s32, s36
    s_add_u32 s33, s32, 114688
    buffer_load_dwordx4 v[168:171], v2, s[12:15], s32 offen offset:0 sc1
    buffer_load_dwordx4 v[172:175], v2, s[12:15], s33 offen offset:0 sc1
    s_waitcnt vmcnt(8)
    v_mfma_f32_32x32x16_bf16 v[192:207], v[40:43], v[136:139], 0
    v_mfma_f32_32x32x16_bf16 v[208:223], v[40:43], v[140:143], 0
    v_mfma_f32_32x32x16_bf16 v[224:239], v[44:47], v[136:139], 0
    v_mfma_f32_32x32x16_bf16 v[240:255], v[44:47], v[140:143], 0
    buffer_load_dwordx4 v[176:179], v2, s[12:15], s32 offen offset:1024 sc1
    buffer_load_dwordx4 v[180:183], v2, s[12:15], s33 offen offset:1024 sc1
    s_waitcnt vmcnt(8)
    v_mfma_f32_32x32x16_bf16 v[192:207], v[48:51], v[144:147], v[192:207]
    v_mfma_f32_32x32x16_bf16 v[208:223], v[48:51], v[148:151], v[208:223]
    v_mfma_f32_32x32x16_bf16 v[224:239], v[52:55], v[144:147], v[224:239]
    v_mfma_f32_32x32x16_bf16 v[240:255], v[52:55], v[148:151], v[240:255]
    buffer_load_dwordx4 v[184:187], v2, s[12:15], s32 offen offset:2048 sc1
    buffer_load_dwordx4 v[188:191], v2, s[12:15], s33 offen offset:2048 sc1
    s_waitcnt vmcnt(8)
    v_mfma_f32_32x32x16_bf16 v[192:207], v[56:59], v[152:155], v[192:207]
    v_mfma_f32_32x32x16_bf16 v[208:223], v[56:59], v[156:159], v[208:223]
    v_mfma_f32_32x32x16_bf16 v[224:239], v[60:63], v[152:155], v[224:239]
    v_mfma_f32_32x32x16_bf16 v[240:255], v[60:63], v[156:159], v[240:255]
    buffer_load_dwordx4 v[136:139], v2, s[12:15], s32 offen offset:3072 sc1
    buffer_load_dwordx4 v[140:143], v2, s[12:15], s33 offen offset:3072 sc1
    s_waitcnt vmcnt(8)
    v_mfma_f32_32x32x16_bf16 v[192:207], v[64:67], v[160:163], v[192:207]
    v_mfma_f32_32x32x16_bf16 v[208:223], v[64:67], v[164:167], v[208:223]
    v_mfma_f32_32x32x16_bf16 v[224:239], v[68:71], v[160:163], v[224:239]
    v_mfma_f32_32x32x16_bf16 v[240:255], v[68:71], v[164:167], v[240:255]
    s_add_u32 s32, s44, 2
    s_sub_u32 s80, s32, 6
    s_cmp_ge_u32 s32, 6
    s_cselect_b32 s32, s80, s32
    s_add_u32 s32, s32, s47
    s_lshl_b32 s32, s32, 12
    s_add_u32 s32, s32, s36
    s_add_u32 s33, s32, 114688
    buffer_load_dwordx4 v[144:147], v2, s[12:15], s32 offen offset:0 sc1
    buffer_load_dwordx4 v[148:151], v2, s[12:15], s33 offen offset:0 sc1
    s_waitcnt vmcnt(8)
    v_mfma_f32_32x32x16_bf16 v[192:207], v[72:75], v[168:171], v[192:207]
    v_mfma_f32_32x32x16_bf16 v[208:223], v[72:75], v[172:175], v[208:223]
    v_mfma_f32_32x32x16_bf16 v[224:239], v[76:79], v[168:171], v[224:239]
    v_mfma_f32_32x32x16_bf16 v[240:255], v[76:79], v[172:175], v[240:255]
    buffer_load_dwordx4 v[152:155], v2, s[12:15], s32 offen offset:1024 sc1
    buffer_load_dwordx4 v[156:159], v2, s[12:15], s33 offen offset:1024 sc1
    s_waitcnt vmcnt(8)
    v_mfma_f32_32x32x16_bf16 v[192:207], v[80:83], v[176:179], v[192:207]
    v_mfma_f32_32x32x16_bf16 v[208:223], v[80:83], v[180:183], v[208:223]
    v_mfma_f32_32x32x16_bf16 v[224:239], v[84:87], v[176:179], v[224:239]
    v_mfma_f32_32x32x16_bf16 v[240:255], v[84:87], v[180:183], v[240:255]
    buffer_load_dwordx4 v[160:163], v2, s[12:15], s32 offen offset:2048 sc1
    buffer_load_dwordx4 v[164:167], v2, s[12:15], s33 offen offset:2048 sc1
    s_waitcnt vmcnt(8)
    v_mfma_f32_32x32x16_bf16 v[192:207], v[88:91], v[184:187], v[192:207]
    v_mfma_f32_32x32x16_bf16 v[208:223], v[88:91], v[188:191], v[208:223]
    v_mfma_f32_32x32x16_bf16 v[224:239], v[92:95], v[184:187], v[224:239]
    v_mfma_f32_32x32x16_bf16 v[240:255], v[92:95], v[188:191], v[240:255]
    buffer_load_dwordx4 v[168:171], v2, s[12:15], s32 offen offset:3072 sc1
    buffer_load_dwordx4 v[172:175], v2, s[12:15], s33 offen offset:3072 sc1
    s_waitcnt vmcnt(8)
    v_mfma_f32_32x32x16_bf16 v[192:207], v[96:99], v[136:139], v[192:207]
    v_mfma_f32_32x32x16_bf16 v[208:223], v[96:99], v[140:143], v[208:223]
    v_mfma_f32_32x32x16_bf16 v[224:239], v[100:103], v[136:139], v[224:239]
    v_mfma_f32_32x32x16_bf16 v[240:255], v[100:103], v[140:143], v[240:255]
    s_lshl_b32 s76, s71, 7
    s_add_u32 s76, s76, s35
    v_mov_b32 v6, s76
    buffer_load_dword v7, v6, s[12:15], 0 offen sc1
    s_add_u32 s32, s44, 3
    s_sub_u32 s80, s32, 6
    s_cmp_ge_u32 s32, 6
    s_cselect_b32 s32, s80, s32
    s_add_u32 s32, s32, s47
    s_lshl_b32 s32, s32, 12
    s_add_u32 s32, s32, s36
    s_add_u32 s33, s32, 114688
    buffer_load_dwordx4 v[176:179], v2, s[12:15], s32 offen offset:0 sc1
    buffer_load_dwordx4 v[180:183], v2, s[12:15], s33 offen offset:0 sc1
    s_waitcnt vmcnt(9)
    v_mfma_f32_32x32x16_bf16 v[192:207], v[104:107], v[144:147], v[192:207]
    v_mfma_f32_32x32x16_bf16 v[208:223], v[104:107], v[148:151], v[208:223]
    v_mfma_f32_32x32x16_bf16 v[224:239], v[108:111], v[144:147], v[224:239]
    v_mfma_f32_32x32x16_bf16 v[240:255], v[108:111], v[148:151], v[240:255]
    buffer_load_dwordx4 v[184:187], v2, s[12:15], s32 offen offset:1024 sc1
    buffer_load_dwordx4 v[188:191], v2, s[12:15], s33 offen offset:1024 sc1
    s_waitcnt vmcnt(9)
    v_mfma_f32_32x32x16_bf16 v[192:207], v[112:115], v[152:155], v[192:207]
    v_mfma_f32_32x32x16_bf16 v[208:223], v[112:115], v[156:159], v[208:223]
    v_mfma_f32_32x32x16_bf16 v[224:239], v[116:119], v[152:155], v[224:239]
    v_mfma_f32_32x32x16_bf16 v[240:255], v[116:119], v[156:159], v[240:255]
    buffer_load_dwordx4 v[136:139], v2, s[12:15], s32 offen offset:2048 sc1
    buffer_load_dwordx4 v[140:143], v2, s[12:15], s33 offen offset:2048 sc1
    s_waitcnt vmcnt(9)
    v_mfma_f32_32x32x16_bf16 v[192:207], v[120:123], v[160:163], v[192:207]
    v_mfma_f32_32x32x16_bf16 v[208:223], v[120:123], v[164:167], v[208:223]
    v_mfma_f32_32x32x16_bf16 v[224:239], v[124:127], v[160:163], v[224:239]
    v_mfma_f32_32x32x16_bf16 v[240:255], v[124:127], v[164:167], v[240:255]
    s_waitcnt vmcnt(6)
    v_cmp_ne_u32 vcc, s68, v7
    s_nop 4
    s_cbranch_vccz L_back_237
L_slow_236:
    s_mov_b32 s89, 0
L_spin_238:
    s_sleep 6
    buffer_load_dword v7, v6, s[12:15], 0 offen sc1
    s_waitcnt vmcnt(0)
    v_cmp_ne_u32 vcc, s68, v7
    s_nop 4
    s_cbranch_vccz L_back_237
    s_add_u32 s89, s89, 1
    s_cmp_lt_u32 s89, 1048576
    s_cbranch_scc1 L_spin_238
L_back_237:
    buffer_load_dwordx4 v[144:147], v2, s[12:15], s32 offen offset:3072 sc1
    buffer_load_dwordx4 v[148:151], v2, s[12:15], s33 offen offset:3072 sc1
    ds_read_b64_tr_b16 v[8:9], v34 offset:8192
    ds_read_b64_tr_b16 v[10:11], v34 offset:9216
    ds_read_b64_tr_b16 v[12:13], v35 offset:8192
    ds_read_b64_tr_b16 v[14:15], v35 offset:9216
    v_mfma_f32_32x32x16_bf16 v[192:207], v[128:131], v[168:171], v[192:207]
    v_mfma_f32_32x32x16_bf16 v[208:223], v[128:131], v[172:175], v[208:223]
    v_mfma_f32_32x32x16_bf16 v[224:239], v[132:135], v[168:171], v[224:239]
    v_mfma_f32_32x32x16_bf16 v[240:255], v[132:135], v[172:175], v[240:255]
    s_add_u32 s32, s44, 4
    s_sub_u32 s80, s32, 6
    s_cmp_ge_u32 s32, 6
    s_cselect_b32 s32, s80, s32
    s_add_u32 s32, s32, s47
    s_lshl_b32 s32, s32, 12
    s_add_u32 s32, s32, s36
    s_add_u32 s33, s32, 114688
    buffer_load_dwordx4 v[152:155], v2, s[12:15], s32 offen offset:0 sc1
    buffer_load_dwordx4 v[156:159], v2, s[12:15], s33 offen offset:0 sc1
    ds_read_b64_tr_b16 v[16:17], v34 offset:10240
    ds_read_b64_tr_b16 v[18:19], v34 offset:11264
    ds_read_b64_tr_b16 v[20:21], v35 offset:10240
    ds_read_b64_tr_b16 v[22:23], v35 offset:11264
    v_and_b32 v118, 31, v1
    s_lshl_b32 s76, s88, 6
    v_add_u32 v118, s76, v118
    v_lshrrev_b32 v119, 5, v1
    v_lshlrev_b32 v119, 2, v119
    s_lshl_b32 s76, s71, 6
    v_add_u32 v119, s76, v119
    v_cvt_f32_u32 v119, v119
    v_mov_b32 v120, 0x3b000000
    v_cvt_f32_u32 v114, v118
    v_mul_f32 v114, v114, v120
    v_mul_f32 v116, 4.0, v114
    v_mul_f32 v112, v114, v119
    v_fract_f32 v112, v112
    v_add_u32 v118, 32, v118
    v_cvt_f32_u32 v115, v118
    v_mul_f32 v115, v115, v120
    v_mul_f32 v117, 4.0, v115
    v_mul_f32 v113, v115, v119
    v_fract_f32 v113, v113
    s_lshl_b32 s76, s71, 13
    s_add_u32 s76, s76, 491520
    v_lshlrev_b32 v6, 7, v1
    v_add_u32 v6, s76, v6
    s_waitcnt vmcnt(8)
    s_waitcnt lgkmcnt(4)
    v_mfma_f32_32x32x16_bf16 v[192:207], v[8:11], v[176:179], v[192:207]
    v_add_f32 v112, v112, v114
    v_add_f32 v113, v113, v115
    v_fract_f32 v112, v112
    v_fract_f32 v113, v113
    v_cos_f32 v118, v112
    v_sin_f32 v119, v112
    v_mfma_f32_32x32x16_bf16 v[208:223], v[8:11], v[180:183], v[208:223]
    v_cos_f32 v120, v113
    v_sin_f32 v121, v113
    v_cvt_pk_bf16_f32 v40, v118, -v119
    v_cvt_pk_bf16_f32 v44, v120, -v121
    v_add_f32 v112, v112, v114
    v_add_f32 v113, v113, v115
    v_mfma_f32_32x32x16_bf16 v[224:239], v[12:15], v[176:179], v[224:239]
    v_fract_f32 v112, v112
    v_fract_f32 v113, v113
    v_cos_f32 v118, v112
    v_sin_f32 v119, v112
    v_cos_f32 v120, v113
    v_sin_f32 v121, v113
    v_mfma_f32_32x32x16_bf16 v[240:255], v[12:15], v[180:183], v[240:255]
    v_cvt_pk_bf16_f32 v41, v118, -v119
    v_cvt_pk_bf16_f32 v45, v120, -v121
    v_add_f32 v112, v112, v114
    v_add_f32 v113, v113, v115
    v_fract_f32 v112, v112
    v_fract_f32 v113, v113
    buffer_load_dwordx4 v[160:163], v2, s[12:15], s32 offen offset:1024 sc1
    buffer_load_dwordx4 v[164:167], v2, s[12:15], s33 offen offset:1024 sc1
    ds_read_b64_tr_b16 v[8:9], v34 offset:12288
    ds_read_b64_tr_b16 v[10:11], v34 offset:13312
    ds_read_b64_tr_b16 v[12:13], v35 offset:12288
    ds_read_b64_tr_b16 v[14:15], v35 offset:13312
    s_waitcnt vmcnt(8)
    s_waitcnt lgkmcnt(4)
    v_mfma_f32_32x32x16_bf16 v[192:207], v[16:19], v[184:187], v[192:207]
    v_cos_f32 v118, v112
    v_sin_f32 v119, v112
    v_cos_f32 v120, v113
    v_sin_f32 v121, v113
    v_cvt_pk_bf16_f32 v42, v118, -v119
    v_cvt_pk_bf16_f32 v46, v120, -v121
    v_mfma_f32_32x32x16_bf16 v[208:223], v[16:19], v[188:191], v[208:223]
    v_add_f32 v112, v112, v114
    v_add_f32 v113, v113, v115
    v_fract_f32 v112, v112
    v_fract_f32 v113, v113
    v_cos_f32 v118, v112
    v_sin_f32 v119, v112
    v_mfma_f32_32x32x16_bf16 v[224:239], v[20:23], v[184:187], v[224:239]
    v_cos_f32 v120, v113
    v_sin_f32 v121, v113
    v_cvt_pk_bf16_f32 v43, v118, -v119
    v_cvt_pk_bf16_f32 v47, v120, -v121
    v_add_f32 v112, v112, v116
    v_add_f32 v113, v113, v117
    v_mfma_f32_32x32x16_bf16 v[240:255], v[20:23], v[188:191], v[240:255]
    v_add_f32 v112, v112, v114
    v_add_f32 v113, v113, v115
    v_fract_f32 v112, v112
    v_fract_f32 v113, v113
    v_cos_f32 v118, v112
    v_sin_f32 v119, v112
    buffer_load_dwordx4 v[168:171], v2, s[12:15], s32 offen offset:2048 sc1
    buffer_load_dwordx4 v[172:175], v2, s[12:15], s33 offen offset:2048 sc1
    ds_read_b64_tr_b16 v[16:17], v34 offset:14336
    ds_read_b64_tr_b16 v[18:19], v34 offset:15360
    ds_read_b64_tr_b16 v[20:21], v35 offset:14336
    ds_read_b64_tr_b16 v[22:23], v35 offset:15360
    s_waitcnt vmcnt(8)
    s_waitcnt lgkmcnt(4)
    v_mfma_f32_32x32x16_bf16 v[192:207], v[8:11], v[136:139], v[192:207]
    v_cos_f32 v120, v113
    v_sin_f32 v121, v113
    v_cvt_pk_bf16_f32 v48, v118, -v119
    v_cvt_pk_bf16_f32 v52, v120, -v121
    v_add_f32 v112, v112, v114
    v_add_f32 v113, v113, v115
    v_mfma_f32_32x32x16_bf16 v[208:223], v[8:11], v[140:143], v[208:223]
    v_fract_f32 v112, v112
    v_fract_f32 v113, v113
    v_cos_f32 v118, v112
    v_sin_f32 v119, v112
    v_cos_f32 v120, v113
    v_sin_f32 v121, v113
    v_mfma_f32_32x32x16_bf16 v[224:239], v[12:15], v[136:139], v[224:239]
    v_cvt_pk_bf16_f32 v49, v118, -v119
    v_cvt_pk_bf16_f32 v53, v120, -v121
    v_add_f32 v112, v112, v114
    v_add_f32 v113, v113, v115
    v_fract_f32 v112, v112
    v_fract_f32 v113, v113
    v_mfma_f32_32x32x16_bf16 v[240:255], v[12:15], v[140:143], v[240:255]
    v_cos_f32 v118, v112
    v_sin_f32 v119, v112
    v_cos_f32 v120, v113
    v_sin_f32 v121, v113
    v_cvt_pk_bf16_f32 v50, v118, -v119
    v_cvt_pk_bf16_f32 v54, v120, -v121
    buffer_load_dwordx4 v[176:179], v2, s[12:15], s32 offen offset:3072 sc1
    buffer_load_dwordx4 v[180:183], v2, s[12:15], s33 offen offset:3072 sc1
    ds_read_b64_tr_b16 v[8:9], v32 offset:0
    ds_read_b64_tr_b16 v[10:11], v32 offset:1024
    ds_read_b64_tr_b16 v[12:13], v33 offset:0
    ds_read_b64_tr_b16 v[14:15], v33 offset:1024
    s_waitcnt vmcnt(8)
    s_waitcnt lgkmcnt(4)
    v_mfma_f32_32x32x16_bf16 v[192:207], v[16:19], v[144:147], v[192:207]
    v_add_f32 v112, v112, v114
    v_add_f32 v113, v113, v115
    v_fract_f32 v112, v112
    v_fract_f32 v113, v113
    v_cos_f32 v118, v112
    v_sin_f32 v119, v112
    v_mfma_f32_32x32x16_bf16 v[208:223], v[16:19], v[148:151], v[208:223]
    v_cos_f32 v120, v113
    v_sin_f32 v121, v113
    v_cvt_pk_bf16_f32 v51, v118, -v119
    v_cvt_pk_bf16_f32 v55, v120, -v121
    v_add_f32 v112, v112, v116
    v_add_f32 v113, v113, v117
    v_mfma_f32_32x32x16_bf16 v[224:239], v[20:23], v[144:147], v[224:239]
    v_add_f32 v112, v112, v114
    v_add_f32 v113, v113, v115
    v_fract_f32 v112, v112
    v_fract_f32 v113, v113
    v_cos_f32 v118, v112
    v_sin_f32 v119, v112
    v_mfma_f32_32x32x16_bf16 v[240:255], v[20:23], v[148:151], v[240:255]
    v_cos_f32 v120, v113
    v_sin_f32 v121, v113
    v_cvt_pk_bf16_f32 v56, v118, -v119
    v_cvt_pk_bf16_f32 v60, v120, -v121
    v_add_f32 v112, v112, v114
    v_add_f32 v113, v113, v115
    s_add_u32 s32, s44, 5
    s_sub_u32 s80, s32, 6
    s_cmp_ge_u32 s32, 6
    s_cselect_b32 s32, s80, s32
    s_add_u32 s32, s32, s47
    s_lshl_b32 s32, s32, 12
    s_add_u32 s32, s32, s36
    s_add_u32 s33, s32, 114688
    buffer_load_dwordx4 v[184:187], v2, s[12:15], s32 offen offset:0 sc1
    buffer_load_dwordx4 v[188:191], v2, s[12:15], s33 offen offset:0 sc1
    ds_read_b64_tr_b16 v[16:17], v32 offset:2048
    ds_read_b64_tr_b16 v[18:19], v32 offset:3072
    ds_read_b64_tr_b16 v[20:21], v33 offset:2048
    ds_read_b64_tr_b16 v[22:23], v33 offset:3072
    s_waitcnt vmcnt(8)
    s_waitcnt lgkmcnt(4)
    v_mfma_f32_32x32x16_bf16 v[192:207], v[8:11], v[152:155], v[192:207]
    v_fract_f32 v112, v112
    v_fract_f32 v113, v113
    v_cos_f32 v118, v112
    v_sin_f32 v119, v112
    v_cos_f32 v120, v113
    v_sin_f32 v121, v113
    v_mfma_f32_32x32x16_bf16 v[208:223], v[8:11], v[156:159], v[208:223]
    v_cvt_pk_bf16_f32 v57, v118, -v119
    v_cvt_pk_bf16_f32 v61, v120, -v121
    v_add_f32 v112, v112, v114
    v_add_f32 v113, v113, v115
    v_fract_f32 v112, v112
    v_fract_f32 v113, v113
    v_mfma_f32_32x32x16_bf16 v[224:239], v[12:15], v[152:155], v[224:239]
    v_cos_f32 v118, v112
    v_sin_f32 v119, v112
    v_cos_f32 v120, v113
    v_sin_f32 v121, v113
    v_cvt_pk_bf16_f32 v58, v118, -v119
    v_cvt_pk_bf16_f32 v62, v120, -v121
    v_mfma_f32_32x32x16_bf16 v[240:255], v[12:15], v[156:159], v[240:255]
    v_add_f32 v112, v112, v114
    v_add_f32 v113, v113, v115
    v_fract_f32 v112, v112
    v_fract_f32 v113, v113
    v_cos_f32 v118, v112
    v_sin_f32 v119, v112
    buffer_load_dwordx4 v[136:139], v2, s[12:15], s32 offen offset:1024 sc1
    buffer_load_dwordx4 v[140:143], v2, s[12:15], s33 offen offset:1024 sc1
    ds_read_b64_tr_b16 v[8:9], v32 offset:4096
    ds_read_b64_tr_b16 v[10:11], v32 offset:5120
    ds_read_b64_tr_b16 v[12:13], v33 offset:4096
    ds_read_b64_tr_b16 v[14:15], v33 offset:5120
    s_waitcnt vmcnt(8)
    s_waitcnt lgkmcnt(4)
    v_mfma_f32_32x32x16_bf16 v[192:207], v[16:19], v[160:163], v[192:207]
    v_cos_f32 v120, v113
    v_sin_f32 v121, v113
    v_cvt_pk_bf16_f32 v59, v118, -v119
    v_cvt_pk_bf16_f32 v63, v120, -v121
    v_add_f32 v112, v112, v116
    v_add_f32 v113, v113, v117
    v_mfma_f32_32x32x16_bf16 v[208:223], v[16:19], v[164:167], v[208:223]
    v_add_f32 v112, v112, v114
    v_add_f32 v113, v113, v115
    v_fract_f32 v112, v112
    v_fract_f32 v113, v113
    v_cos_f32 v118, v112
    v_sin_f32 v119, v112
    v_mfma_f32_32x32x16_bf16 v[224:239], v[20:23], v[160:163], v[224:239]
    v_cos_f32 v120, v113
    v_sin_f32 v121, v113
    v_cvt_pk_bf16_f32 v64, v118, -v119
    v_cvt_pk_bf16_f32 v68, v120, -v121
    v_add_f32 v112, v112, v114
    v_add_f32 v113, v113, v115
    v_mfma_f32_32x32x16_bf16 v[240:255], v[20:23], v[164:167], v[240:255]
    v_fract_f32 v112, v112
    v_fract_f32 v113, v113
    v_cos_f32 v118, v112
    v_sin_f32 v119, v112
    v_cos_f32 v120, v113
    v_sin_f32 v121, v113
    buffer_load_dwordx4 v[144:147], v2, s[12:15], s32 offen offset:2048 sc1
    buffer_load_dwordx4 v[148:151], v2, s[12:15], s33 offen offset:2048 sc1
    ds_read_b64_tr_b16 v[16:17], v32 offset:6144
    ds_read_b64_tr_b16 v[18:19], v32 offset:7168
    ds_read_b64_tr_b16 v[20:21], v33 offset:6144
    ds_read_b64_tr_b16 v[22:23], v33 offset:7168
    s_waitcnt vmcnt(8)
    s_waitcnt lgkmcnt(4)
    v_mfma_f32_32x32x16_bf16 v[192:207], v[8:11], v[168:171], v[192:207]
    v_cvt_pk_bf16_f32 v65, v118, -v119
    v_cvt_pk_bf16_f32 v69, v120, -v121
    v_add_f32 v112, v112, v114
    v_add_f32 v113, v113, v115
    v_fract_f32 v112, v112
    v_fract_f32 v113, v113
    v_mfma_f32_32x32x16_bf16 v[208:223], v[8:11], v[172:175], v[208:223]
    v_cos_f32 v118, v112
    v_sin_f32 v119, v112
    v_cos_f32 v120, v113
    v_sin_f32 v121, v113
    v_cvt_pk_bf16_f32 v66, v118, -v119
    v_cvt_pk_bf16_f32 v70, v120, -v121
    v_mfma_f32_32x32x16_bf16 v[224:239], v[12:15], v[168:171], v[224:239]
    v_add_f32 v112, v112, v114
    v_add_f32 v113, v113, v115
    v_fract_f32 v112, v112
    v_fract_f32 v113, v113
    v_cos_f32 v118, v112
    v_sin_f32 v119, v112
    v_mfma_f32_32x32x16_bf16 v[240:255], v[12:15], v[172:175], v[240:255]
    v_cos_f32 v120, v113
    v_sin_f32 v121, v113
    v_cvt_pk_bf16_f32 v67, v118, -v119
    v_cvt_pk_bf16_f32 v71, v120, -v121
    v_add_f32 v112, v112, v116
    v_add_f32 v113, v113, v117
    buffer_load_dwordx4 v[152:155], v2, s[12:15], s32 offen offset:3072 sc1
    buffer_load_dwordx4 v[156:159], v2, s[12:15], s33 offen offset:3072 sc1
    ds_read_b64_tr_b16 v[8:9], v32 offset:8192
    ds_read_b64_tr_b16 v[10:11], v32 offset:9216
    ds_read_b64_tr_b16 v[12:13], v33 offset:8192
    ds_read_b64_tr_b16 v[14:15], v33 offset:9216
    s_waitcnt vmcnt(8)
    s_waitcnt lgkmcnt(4)
    v_mfma_f32_32x32x16_bf16 v[192:207], v[16:19], v[176:179], v[192:207]
    v_add_f32 v112, v112, v114
    v_add_f32 v113, v113, v115
    v_fract_f32 v112, v112
    v_fract_f32 v113, v113
    v_cos_f32 v118, v112
    v_sin_f32 v119, v112
    v_mfma_f32_32x32x16_bf16 v[208:223], v[16:19], v[180:183], v[208:223]
    v_cos_f32 v120, v113
    v_sin_f32 v121, v113
    v_cvt_pk_bf16_f32 v72, v118, -v119
    v_cvt_pk_bf16_f32 v76, v120, -v121
    v_add_f32 v112, v112, v114
    v_add_f32 v113, v113, v115
    v_mfma_f32_32x32x16_bf16 v[224:239], v[20:23], v[176:179], v[224:239]
    v_fract_f32 v112, v112
    v_fract_f32 v113, v113
    v_cos_f32 v118, v112
    v_sin_f32 v119, v112
    v_cos_f32 v120, v113
    v_sin_f32 v121, v113
    v_mfma_f32_32x32x16_bf16 v[240:255], v[20:23], v[180:183], v[240:255]
    v_cvt_pk_bf16_f32 v73, v118, -v119
    v_cvt_pk_bf16_f32 v77, v120, -v121
    v_add_f32 v112, v112, v114
    v_add_f32 v113, v113, v115
    v_fract_f32 v112, v112
    v_fract_f32 v113, v113
    s_add_u32 s32, s71, 24
    s_lshl_b32 s32, s32, 12
    s_add_u32 s32, s32, s36
    s_add_u32 s33, s32, 114688
    buffer_load_dwordx4 v[160:163], v2, s[12:15], s32 offen offset:0 sc1
    buffer_load_dwordx4 v[164:167], v2, s[12:15], s33 offen offset:0 sc1
    ds_read_b64_tr_b16 v[16:17], v32 offset:10240
    ds_read_b64_tr_b16 v[18:19], v32 offset:11264
    ds_read_b64_tr_b16 v[20:21], v33 offset:10240
    ds_read_b64_tr_b16 v[22:23], v33 offset:11264
    s_waitcnt vmcnt(8)
    s_waitcnt lgkmcnt(4)
    v_mfma_f32_32x32x16_bf16 v[192:207], v[8:11], v[184:187], v[192:207]
    v_cos_f32 v118, v112
    v_sin_f32 v119, v112
    v_cos_f32 v120, v113
    v_sin_f32 v121, v113
    v_cvt_pk_bf16_f32 v74, v118, -v119
    v_cvt_pk_bf16_f32 v78, v120, -v121
    v_mfma_f32_32x32x16_bf16 v[208:223], v[8:11], v[188:191], v[208:223]
    v_add_f32 v112, v112, v114
    v_add_f32 v113, v113, v115
    v_fract_f32 v112, v112
    v_fract_f32 v113, v113
    v_cos_f32 v118, v112
    v_sin_f32 v119, v112
    v_mfma_f32_32x32x16_bf16 v[224:239], v[12:15], v[184:187], v[224:239]
    v_cos_f32 v120, v113
    v_sin_f32 v121, v113
    v_cvt_pk_bf16_f32 v75, v118, -v119
    v_cvt_pk_bf16_f32 v79, v120, -v121
    v_add_f32 v112, v112, v116
    v_add_f32 v113, v113, v117
    v_mfma_f32_32x32x16_bf16 v[240:255], v[12:15], v[188:191], v[240:255]
    v_add_f32 v112, v112, v114
    v_add_f32 v113, v113, v115
    v_fract_f32 v112, v112
    v_fract_f32 v113, v113
    v_cos_f32 v118, v112
    v_sin_f32 v119, v112
    buffer_load_dwordx4 v[168:171], v2, s[12:15], s32 offen offset:1024 sc1
    buffer_load_dwordx4 v[172:175], v2, s[12:15], s33 offen offset:1024 sc1
    ds_read_b64_tr_b16 v[8:9], v32 offset:12288
    ds_read_b64_tr_b16 v[10:11], v32 offset:13312
    ds_read_b64_tr_b16 v[12:13], v33 offset:12288
    ds_read_b64_tr_b16 v[14:15], v33 offset:13312
    s_waitcnt vmcnt(8)
    s_waitcnt lgkmcnt(4)
    v_mfma_f32_32x32x16_bf16 v[192:207], v[16:19], v[136:139], v[192:207]
    v_cos_f32 v120, v113
    v_sin_f32 v121, v113
    v_cvt_pk_bf16_f32 v80, v118, -v119
    v_cvt_pk_bf16_f32 v84, v120, -v121
    v_add_f32 v112, v112, v114
    v_add_f32 v113, v113, v115
    v_mfma_f32_32x32x16_bf16 v[208:223], v[16:19], v[140:143], v[208:223]
    v_fract_f32 v112, v112
    v_fract_f32 v113, v113
    v_cos_f32 v118, v112
    v_sin_f32 v119, v112
    v_cos_f32 v120, v113
    v_sin_f32 v121, v113
    v_mfma_f32_32x32x16_bf16 v[224:239], v[20:23], v[136:139], v[224:239]
    v_cvt_pk_bf16_f32 v81, v118, -v119
    v_cvt_pk_bf16_f32 v85, v120, -v121
    v_add_f32 v112, v112, v114
    v_add_f32 v113, v113, v115
    v_fract_f32 v112, v112
    v_fract_f32 v113, v113
    v_mfma_f32_32x32x16_bf16 v[240:255], v[20:23], v[140:143], v[240:255]
    v_cos_f32 v118, v112
    v_sin_f32 v119, v112
    v_cos_f32 v120, v113
    v_sin_f32 v121, v113
    v_cvt_pk_bf16_f32 v82, v118, -v119
    v_cvt_pk_bf16_f32 v86, v120, -v121
    buffer_load_dwordx4 v[176:179], v2, s[12:15], s32 offen offset:2048 sc1
    buffer_load_dwordx4 v[180:183], v2, s[12:15], s33 offen offset:2048 sc1
    ds_read_b64_tr_b16 v[16:17], v32 offset:14336
    ds_read_b64_tr_b16 v[18:19], v32 offset:15360
    ds_read_b64_tr_b16 v[20:21], v33 offset:14336
    ds_read_b64_tr_b16 v[22:23], v33 offset:15360
    s_waitcnt vmcnt(8)
    s_waitcnt lgkmcnt(4)
    v_mfma_f32_32x32x16_bf16 v[192:207], v[8:11], v[144:147], v[192:207]
    v_add_f32 v112, v112, v114
    v_add_f32 v113, v113, v115
    v_fract_f32 v112, v112
    v_fract_f32 v113, v113
    v_cos_f32 v118, v112
    v_sin_f32 v119, v112
    v_mfma_f32_32x32x16_bf16 v[208:223], v[8:11], v[148:151], v[208:223]
    v_cos_f32 v120, v113
    v_sin_f32 v121, v113
    v_cvt_pk_bf16_f32 v83, v118, -v119
    v_cvt_pk_bf16_f32 v87, v120, -v121
    v_add_f32 v112, v112, v116
    v_add_f32 v113, v113, v117
    v_mfma_f32_32x32x16_bf16 v[224:239], v[12:15], v[144:147], v[224:239]
    v_add_f32 v112, v112, v114
    v_add_f32 v113, v113, v115
    v_fract_f32 v112, v112
    v_fract_f32 v113, v113
    v_cos_f32 v118, v112
    v_sin_f32 v119, v112
    v_mfma_f32_32x32x16_bf16 v[240:255], v[12:15], v[148:151], v[240:255]
    v_cos_f32 v120, v113
    v_sin_f32 v121, v113
    v_cvt_pk_bf16_f32 v88, v118, -v119
    v_cvt_pk_bf16_f32 v92, v120, -v121
    v_add_f32 v112, v112, v114
    v_add_f32 v113, v113, v115
    buffer_load_dwordx4 v[184:187], v2, s[12:15], s32 offen offset:3072 sc1
    buffer_load_dwordx4 v[188:191], v2, s[12:15], s33 offen offset:3072 sc1
    ds_read_b64_tr_b16 v[8:9], v34 offset:0
    ds_read_b64_tr_b16 v[10:11], v34 offset:1024
    ds_read_b64_tr_b16 v[12:13], v35 offset:0
    ds_read_b64_tr_b16 v[14:15], v35 offset:1024
    s_waitcnt vmcnt(8)
    s_waitcnt lgkmcnt(4)
    v_mfma_f32_32x32x16_bf16 v[192:207], v[16:19], v[152:155], v[192:207]
    v_fract_f32 v112, v112
    v_fract_f32 v113, v113
    v_cos_f32 v118, v112
    v_sin_f32 v119, v112
    v_cos_f32 v120, v113
    v_sin_f32 v121, v113
    v_mfma_f32_32x32x16_bf16 v[208:223], v[16:19], v[156:159], v[208:223]
    v_cvt_pk_bf16_f32 v89, v118, -v119
    v_cvt_pk_bf16_f32 v93, v120, -v121
    v_add_f32 v112, v112, v114
    v_add_f32 v113, v113, v115
    v_fract_f32 v112, v112
    v_fract_f32 v113, v113
    v_mfma_f32_32x32x16_bf16 v[224:239], v[20:23], v[152:155], v[224:239]
    v_cos_f32 v118, v112
    v_sin_f32 v119, v112
    v_cos_f32 v120, v113
    v_sin_f32 v121, v113
    v_cvt_pk_bf16_f32 v90, v118, -v119
    v_cvt_pk_bf16_f32 v94, v120, -v121
    v_mfma_f32_32x32x16_bf16 v[240:255], v[20:23], v[156:159], v[240:255]
    v_add_f32 v112, v112, v114
    v_add_f32 v113, v113, v115
    v_fract_f32 v112, v112
    v_fract_f32 v113, v113
    v_cos_f32 v118, v112
    v_sin_f32 v119, v112
    ds_read_b64_tr_b16 v[16:17], v34 offset:2048
    ds_read_b64_tr_b16 v[18:19], v34 offset:3072
    ds_read_b64_tr_b16 v[20:21], v35 offset:2048
    ds_read_b64_tr_b16 v[22:23], v35 offset:3072
    buffer_load_dword v7, v6, s[12:15], 0 offen sc1
    s_waitcnt vmcnt(7)
    s_waitcnt lgkmcnt(4)
    v_mfma_f32_32x32x16_bf16 v[192:207], v[8:11], v[160:163], v[192:207]
    v_cos_f32 v120, v113
    v_sin_f32 v121, v113
    v_cvt_pk_bf16_f32 v91, v118, -v119
    v_cvt_pk_bf16_f32 v95, v120, -v121
    v_add_f32 v112, v112, v116
    v_add_f32 v113, v113, v117
    v_mfma_f32_32x32x16_bf16 v[208:223], v[8:11], v[164:167], v[208:223]
    v_add_f32 v112, v112, v114
    v_add_f32 v113, v113, v115
    v_fract_f32 v112, v112
    v_fract_f32 v113, v113
    v_cos_f32 v118, v112
    v_sin_f32 v119, v112
    v_mfma_f32_32x32x16_bf16 v[224:239], v[12:15], v[160:163], v[224:239]
    v_cos_f32 v120, v113
    v_sin_f32 v121, v113
    v_cvt_pk_bf16_f32 v96, v118, -v119
    v_cvt_pk_bf16_f32 v100, v120, -v121
    v_add_f32 v112, v112, v114
    v_add_f32 v113, v113, v115
    v_mfma_f32_32x32x16_bf16 v[240:255], v[12:15], v[164:167], v[240:255]
    v_fract_f32 v112, v112
    v_fract_f32 v113, v113
    v_cos_f32 v118, v112
    v_sin_f32 v119, v112
    v_cos_f32 v120, v113
    v_sin_f32 v121, v113
    ds_read_b64_tr_b16 v[8:9], v34 offset:4096
    ds_read_b64_tr_b16 v[10:11], v34 offset:5120
    ds_read_b64_tr_b16 v[12:13], v35 offset:4096
    ds_read_b64_tr_b16 v[14:15], v35 offset:5120
    s_waitcnt vmcnt(5)
    s_waitcnt lgkmcnt(4)
    v_mfma_f32_32x32x16_bf16 v[192:207], v[16:19], v[168:171], v[192:207]
    v_cvt_pk_bf16_f32 v97, v118, -v119
    v_cvt_pk_bf16_f32 v101, v120, -v121
    v_add_f32 v112, v112, v114
    v_add_f32 v113, v113, v115
    v_fract_f32 v112, v112
    v_fract_f32 v113, v113
    v_mfma_f32_32x32x16_bf16 v[208:223], v[16:19], v[172:175], v[208:223]
    v_cos_f32 v118, v112
    v_sin_f32 v119, v112
    v_cos_f32 v120, v113
    v_sin_f32 v121, v113
    v_cvt_pk_bf16_f32 v98, v118, -v119
    v_cvt_pk_bf16_f32 v102, v120, -v121
    v_mfma_f32_32x32x16_bf16 v[224:239], v[20:23], v[168:171], v[224:239]
    v_add_f32 v112, v112, v114
    v_add_f32 v113, v113, v115
    v_fract_f32 v112, v112
    v_fract_f32 v113, v113
    v_cos_f32 v118, v112
    v_sin_f32 v119, v112
    v_mfma_f32_32x32x16_bf16 v[240:255], v[20:23], v[172:175], v[240:255]
    v_cos_f32 v120, v113
    v_sin_f32 v121, v113
    v_cvt_pk_bf16_f32 v99, v118, -v119
    v_cvt_pk_bf16_f32 v103, v120, -v121
    v_add_f32 v112, v112, v116
    v_add_f32 v113, v113, v117
    ds_read_b64_tr_b16 v[16:17], v34 offset:6144
    ds_read_b64_tr_b16 v[18:19], v34 offset:7168
    ds_read_b64_tr_b16 v[20:21], v35 offset:6144
    ds_read_b64_tr_b16 v[22:23], v35 offset:7168
    s_waitcnt vmcnt(3)
    s_waitcnt lgkmcnt(4)
    v_mfma_f32_32x32x16_bf16 v[192:207], v[8:11], v[176:179], v[192:207]
    v_mfma_f32_32x32x16_bf16 v[208:223], v[8:11], v[180:183], v[208:223]
    v_mfma_f32_32x32x16_bf16 v[224:239], v[12:15], v[176:179], v[224:239]
    v_mfma_f32_32x32x16_bf16 v[240:255], v[12:15], v[180:183], v[240:255]
    s_waitcnt vmcnt(0)
    v_cmp_ne_u32 vcc, s68, v7
    s_nop 4
    s_cbranch_vccz L_back_240
L_slow_239:
    s_mov_b32 s89, 0
L_spin_241:
    s_sleep 6
    buffer_load_dword v7, v6, s[12:15], 0 offen sc1
    s_waitcnt vmcnt(0)
    v_cmp_ne_u32 vcc, s68, v7
    s_nop 4
    s_cbranch_vccz L_back_240
    s_add_u32 s89, s89, 1
    s_cmp_lt_u32 s89, 1048576
    s_cbranch_scc1 L_spin_241
L_back_240:
    s_add_u32 m0, s91, 8192
    s_add_u32 s77, s38, 0
    buffer_load_dwordx4 v31, s[12:15], s77 offen sc1 lds
    s_add_u32 m0, s91, 9216
    s_add_u32 s77, s38, 32768
    buffer_load_dwordx4 v31, s[12:15], s77 offen sc1 lds
    s_add_u32 m0, s91, 10240
    s_add_u32 s77, s38, 65536
    buffer_load_dwordx4 v31, s[12:15], s77 offen sc1 lds
    s_add_u32 m0, s91, 11264
    s_add_u32 s77, s38, 98304
    buffer_load_dwordx4 v31, s[12:15], s77 offen sc1 lds
    s_add_u32 m0, s91, 12288
    s_add_u32 s77, s38, 131072
    buffer_load_dwordx4 v31, s[12:15], s77 offen sc1 lds
    s_add_u32 m0, s91, 13312
    s_add_u32 s77, s38, 163840
    buffer_load_dwordx4 v31, s[12:15], s77 offen sc1 lds
    s_add_u32 m0, s91, 14336
    s_add_u32 s77, s38, 196608
    buffer_load_dwordx4 v31, s[12:15], s77 offen sc1 lds
    s_add_u32 m0, s91, 15360
    s_add_u32 s77, s38, 229376
    buffer_load_dwordx4 v31, s[12:15], s77 offen sc1 lds
    s_add_u32 m0, s90, 0
    s_add_u32 s77, s38, 262144
    buffer_load_dwordx4 v31, s[12:15], s77 offen sc1 lds
    s_add_u32 m0, s90, 1024
    s_add_u32 s77, s38, 294912
    buffer_load_dwordx4 v31, s[12:15], s77 offen sc1 lds
    s_add_u32 m0, s90, 2048
    s_add_u32 s77, s38, 327680
    buffer_load_dwordx4 v31, s[12:15], s77 offen sc1 lds
    s_add_u32 m0, s90, 3072
    s_add_u32 s77, s38, 360448
    buffer_load_dwordx4 v31, s[12:15], s77 offen sc1 lds
    s_add_u32 m0, s90, 4096
    s_add_u32 s77, s38, 393216
    buffer_load_dwordx4 v31, s[12:15], s77 offen sc1 lds
    s_add_u32 m0, s90, 5120
    s_add_u32 s77, s38, 425984
    buffer_load_dwordx4 v31, s[12:15], s77 offen sc1 lds
    s_add_u32 m0, s90, 6144
    s_add_u32 s77, s38, 458752
    buffer_load_dwordx4 v31, s[12:15], s77 offen sc1 lds
    s_add_u32 m0, s90, 7168
    s_add_u32 s77, s38, 491520
    buffer_load_dwordx4 v31, s[12:15], s77 offen sc1 lds
    s_waitcnt lgkmcnt(0)
    v_mfma_f32_32x32x16_bf16 v[192:207], v[16:19], v[184:187], v[192:207]
    v_mfma_f32_32x32x16_bf16 v[208:223], v[16:19], v[188:191], v[208:223]
    v_mfma_f32_32x32x16_bf16 v[224:239], v[20:23], v[184:187], v[224:239]
    v_mfma_f32_32x32x16_bf16 v[240:255], v[20:23], v[188:191], v[240:255]
    s_lshr_b32 s76, s87, 1
    s_and_b32 s34, s76, 7
    s_lshl_b32 s34, s34, 8
    s_lshr_b32 s76, s76, 3
    s_lshl_b32 s76, s76, 4
    s_add_u32 s34, s34, s76
    s_and_b32 s76, s87, 1
    s_lshl_b32 s76, s76, 3
    s_add_u32 s34, s34, s76
    s_lshl_b32 s76, s71, 1
    s_add_u32 s34, s34, s76
    s_lshl_b32 s34, s34, 10
    s_add_u32 s34, s34, s37
    v_lshrrev_b32 v109, 3, v1
    v_and_b32 v110, 7, v1
    v_lshlrev_b32 v111, 15, v109
    v_lshl_add_u32 v111, v110, 4, v111
    buffer_load_dwordx4 v[136:139], v111, s[8:11], s34 offen offset:0
    buffer_load_dwordx4 v[140:143], v111, s[8:11], s34 offen offset:1024
    s_waitcnt vmcnt(10)
    ds_read_b64_tr_b16 v[8:9], v38 offset:8192
    ds_read_b64_tr_b16 v[10:11], v38 offset:8704
    ds_read_b64_tr_b16 v[12:13], v39 offset:8192
    ds_read_b64_tr_b16 v[14:15], v39 offset:8704
    ds_read_b64_tr_b16 v[16:17], v38 offset:10240
    ds_read_b64_tr_b16 v[18:19], v38 offset:10752
    ds_read_b64_tr_b16 v[20:21], v39 offset:10240
    ds_read_b64_tr_b16 v[22:23], v39 offset:10752
    s_waitcnt lgkmcnt(4)
    v_mfma_f32_32x32x16_bf16 v[192:207], v[40:43], v[8:11], v[192:207]
    v_mfma_f32_32x32x16_bf16 v[208:223], v[40:43], v[12:15], v[208:223]
    v_mfma_f32_32x32x16_bf16 v[224:239], v[44:47], v[8:11], v[224:239]
    v_mfma_f32_32x32x16_bf16 v[240:255], v[44:47], v[12:15], v[240:255]
    ds_read_b64_tr_b16 v[8:9], v38 offset:12288
    ds_read_b64_tr_b16 v[10:11], v38 offset:12800
    ds_read_b64_tr_b16 v[12:13], v39 offset:12288
    ds_read_b64_tr_b16 v[14:15], v39 offset:12800
    s_waitcnt lgkmcnt(4)
    v_mfma_f32_32x32x16_bf16 v[192:207], v[48:51], v[16:19], v[192:207]
    v_mfma_f32_32x32x16_bf16 v[208:223], v[48:51], v[20:23], v[208:223]
    v_mfma_f32_32x32x16_bf16 v[224:239], v[52:55], v[16:19], v[224:239]
    v_mfma_f32_32x32x16_bf16 v[240:255], v[52:55], v[20:23], v[240:255]
    ds_read_b64_tr_b16 v[16:17], v38 offset:14336
    ds_read_b64_tr_b16 v[18:19], v38 offset:14848
    ds_read_b64_tr_b16 v[20:21], v39 offset:14336
    ds_read_b64_tr_b16 v[22:23], v39 offset:14848
    s_waitcnt lgkmcnt(4)
    v_mfma_f32_32x32x16_bf16 v[192:207], v[56:59], v[8:11], v[192:207]
    v_mfma_f32_32x32x16_bf16 v[208:223], v[56:59], v[12:15], v[208:223]
    v_mfma_f32_32x32x16_bf16 v[224:239], v[60:63], v[8:11], v[224:239]
    v_mfma_f32_32x32x16_bf16 v[240:255], v[60:63], v[12:15], v[240:255]
    s_waitcnt vmcnt(2)
    ds_read_b64_tr_b16 v[8:9], v36 offset:0
    ds_read_b64_tr_b16 v[10:11], v36 offset:512
    ds_read_b64_tr_b16 v[12:13], v37 offset:0
    ds_read_b64_tr_b16 v[14:15], v37 offset:512
    s_waitcnt lgkmcnt(4)
    v_mfma_f32_32x32x16_bf16 v[192:207], v[64:67], v[16:19], v[192:207]
    v_mfma_f32_32x32x16_bf16 v[208:223], v[64:67], v[20:23], v[208:223]
    v_mfma_f32_32x32x16_bf16 v[224:239], v[68:71], v[16:19], v[224:239]
    v_mfma_f32_32x32x16_bf16 v[240:255], v[68:71], v[20:23], v[240:255]
    ds_read_b64_tr_b16 v[16:17], v36 offset:2048
    ds_read_b64_tr_b16 v[18:19], v36 offset:2560
    ds_read_b64_tr_b16 v[20:21], v37 offset:2048
    ds_read_b64_tr_b16 v[22:23], v37 offset:2560
    s_waitcnt lgkmcnt(4)
    v_mfma_f32_32x32x16_bf16 v[192:207], v[72:75], v[8:11], v[192:207]
    v_mfma_f32_32x32x16_bf16 v[208:223], v[72:75], v[12:15], v[208:223]
    v_mfma_f32_32x32x16_bf16 v[224:239], v[76:79], v[8:11], v[224:239]
    v_mfma_f32_32x32x16_bf16 v[240:255], v[76:79], v[12:15], v[240:255]
    ds_read_b64_tr_b16 v[8:9], v36 offset:4096
    ds_read_b64_tr_b16 v[10:11], v36 offset:4608
    ds_read_b64_tr_b16 v[12:13], v37 offset:4096
    ds_read_b64_tr_b16 v[14:15], v37 offset:4608
    s_waitcnt lgkmcnt(4)
    v_mfma_f32_32x32x16_bf16 v[192:207], v[80:83], v[16:19], v[192:207]
    v_mfma_f32_32x32x16_bf16 v[208:223], v[80:83], v[20:23], v[208:223]
    v_mfma_f32_32x32x16_bf16 v[224:239], v[84:87], v[16:19], v[224:239]
    v_mfma_f32_32x32x16_bf16 v[240:255], v[84:87], v[20:23], v[240:255]
    ds_read_b64_tr_b16 v[16:17], v36 offset:6144
    ds_read_b64_tr_b16 v[18:19], v36 offset:6656
    ds_read_b64_tr_b16 v[20:21], v37 offset:6144
    ds_read_b64_tr_b16 v[22:23], v37 offset:6656
    s_waitcnt lgkmcnt(4)
    v_mfma_f32_32x32x16_bf16 v[192:207], v[88:91], v[8:11], v[192:207]
    v_mfma_f32_32x32x16_bf16 v[208:223], v[88:91], v[12:15], v[208:223]
    v_mfma_f32_32x32x16_bf16 v[224:239], v[92:95], v[8:11], v[224:239]
    v_mfma_f32_32x32x16_bf16 v[240:255], v[92:95], v[12:15], v[240:255]
    s_waitcnt lgkmcnt(0)
    v_mfma_f32_32x32x16_bf16 v[192:207], v[96:99], v[16:19], v[192:207]
    v_mfma_f32_32x32x16_bf16 v[208:223], v[96:99], v[20:23], v[208:223]
    v_mfma_f32_32x32x16_bf16 v[224:239], v[100:103], v[16:19], v[224:239]
    v_mfma_f32_32x32x16_bf16 v[240:255], v[100:103], v[20:23], v[240:255]
    v_and_b32 v105, 31, v1
    v_lshrrev_b32 v106, 5, v1
    v_and_b32 v107, 15, v1
    v_xor_b32 v107, v107, v106
    v_lshlrev_b32 v105, 8, v105
    s_add_u32 s76, s90, 8192
    v_add_u32 v105, s76, v105
    v_xor_b32 v8, 0, v107
    v_lshl_add_u32 v8, v8, 4, v105
    ds_write_b128 v8, v[192:195] offset:0
    ds_write_b128 v8, v[208:211] offset:8192
    v_xor_b32 v9, 2, v107
    v_lshl_add_u32 v9, v9, 4, v105
    ds_write_b128 v9, v[196:199] offset:0
    ds_write_b128 v9, v[212:215] offset:8192
    v_xor_b32 v8, 4, v107
    v_lshl_add_u32 v8, v8, 4, v105
    ds_write_b128 v8, v[200:203] offset:0
    ds_write_b128 v8, v[216:219] offset:8192
    v_xor_b32 v9, 6, v107
    v_lshl_add_u32 v9, v9, 4, v105
    ds_write_b128 v9, v[204:207] offset:0
    ds_write_b128 v9, v[220:223] offset:8192
    v_xor_b32 v8, 8, v107
    v_lshl_add_u32 v8, v8, 4, v105
    ds_write_b128 v8, v[224:227] offset:0
    ds_write_b128 v8, v[240:243] offset:8192
    v_xor_b32 v9, 10, v107
    v_lshl_add_u32 v9, v9, 4, v105
    ds_write_b128 v9, v[228:231] offset:0
    ds_write_b128 v9, v[244:247] offset:8192
    v_xor_b32 v8, 12, v107
    v_lshl_add_u32 v8, v8, 4, v105
    ds_write_b128 v8, v[232:235] offset:0
    ds_write_b128 v8, v[248:251] offset:8192
    v_xor_b32 v9, 14, v107
    v_lshl_add_u32 v9, v9, 4, v105
    ds_write_b128 v9, v[236:239] offset:0
    ds_write_b128 v9, v[252:255] offset:8192
    s_lshl_b32 s76, s71, 12
    s_add_u32 s76, s76, 8192
    v_lshlrev_b32 v16, 8, v109
    v_add_u32 v16, s76, v16
    v_lshlrev_b32 v17, 1, v110
    v_xor_b32 v17, v17, v109
    v_xor_b32 v112, 0, v17
    v_lshl_add_u32 v112, v112, 4, v16
    v_add_u32 v113, 0x10000, v112
    v_xor_b32 v114, 1, v17
    v_lshl_add_u32 v114, v114, 4, v16
    v_add_u32 v115, 0x10000, v114
    v_xor_b32 v116, 8, v17
    v_lshl_add_u32 v116, v116, 4, v16
    v_add_u32 v117, 0x10000, v116
    v_xor_b32 v118, 9, v17
    v_lshl_add_u32 v118, v118, 4, v16
    v_add_u32 v119, 0x10000, v118
    s_waitcnt lgkmcnt(0)
    v_mov_b32 v27, 18
    ds_write_b32 v4, v27 offset:16
    ds_read_b128 v[24:27], v3 offset:16
    s_waitcnt lgkmcnt(0)
    v_min3_u32 v24, v24, v25, v26
    v_min_u32 v24, v24, v27
    s_nop 0
    v_readfirstlane_b32 s89, v24
    s_nop 0
    s_cmp_ge_u32 s89, 18
    s_cbranch_scc1 L_bk_243
L_sl_242:
    s_mov_b32 s100, 0
L_sp_244:
    s_sleep 1
    ds_read_b128 v[24:27], v3 offset:16
    s_waitcnt lgkmcnt(0)
    v_min3_u32 v24, v24, v25, v26
    v_min_u32 v24, v24, v27
    s_nop 0
    v_readfirstlane_b32 s89, v24
    s_nop 0
    s_cmp_ge_u32 s89, 18
    s_cbranch_scc1 L_bk_243
    s_add_u32 s100, s100, 1
    s_cmp_lt_u32 s100, 8388608
    s_cbranch_scc1 L_sp_244
L_bk_243:
    ds_read_b128 v[40:43], v112 offset:0
    ds_read_b128 v[44:47], v112 offset:32768
    ds_read_b128 v[48:51], v113 offset:0
    ds_read_b128 v[52:55], v113 offset:32768
    ds_read_b128 v[56:59], v114 offset:0
    ds_read_b128 v[60:63], v114 offset:32768
    ds_read_b128 v[64:67], v115 offset:0
    ds_read_b128 v[68:71], v115 offset:32768
    ds_read_b128 v[72:75], v116 offset:2048
    ds_read_b128 v[76:79], v116 offset:34816
    ds_read_b128 v[80:83], v117 offset:2048
    ds_read_b128 v[84:87], v117 offset:34816
    ds_read_b128 v[88:91], v118 offset:2048
    ds_read_b128 v[92:95], v118 offset:34816
    ds_read_b128 v[96:99], v119 offset:2048
    ds_read_b128 v[100:103], v119 offset:34816
    s_waitcnt vmcnt(0)
    s_waitcnt lgkmcnt(8)
    v_pk_add_f32 v[40:41], v[40:41], v[44:45]
    v_pk_add_f32 v[48:49], v[48:49], v[52:53]
    v_pk_add_f32 v[40:41], v[40:41], v[48:49]
    v_pk_add_f32 v[42:43], v[42:43], v[46:47]
    v_pk_add_f32 v[50:51], v[50:51], v[54:55]
    v_pk_add_f32 v[42:43], v[42:43], v[50:51]
    v_lshlrev_b32 v18, 16, v136
    v_and_b32 v19, 0xffff0000, v136
    v_pk_add_f32 v[40:41], v[40:41], v[18:19]
    v_cvt_pk_bf16_f32 v144, v40, v41
    v_lshlrev_b32 v18, 16, v137
    v_and_b32 v19, 0xffff0000, v137
    v_pk_add_f32 v[42:43], v[42:43], v[18:19]
    v_cvt_pk_bf16_f32 v145, v42, v43
    v_pk_add_f32 v[56:57], v[56:57], v[60:61]
    v_pk_add_f32 v[64:65], v[64:65], v[68:69]
    v_pk_add_f32 v[56:57], v[56:57], v[64:65]
    v_pk_add_f32 v[58:59], v[58:59], v[62:63]
    v_pk_add_f32 v[66:67], v[66:67], v[70:71]
    v_pk_add_f32 v[58:59], v[58:59], v[66:67]
    v_lshlrev_b32 v18, 16, v138
    v_and_b32 v19, 0xffff0000, v138
    v_pk_add_f32 v[56:57], v[56:57], v[18:19]
    v_cvt_pk_bf16_f32 v146, v56, v57
    v_lshlrev_b32 v18, 16, v139
    v_and_b32 v19, 0xffff0000, v139
    v_pk_add_f32 v[58:59], v[58:59], v[18:19]
    v_cvt_pk_bf16_f32 v147, v58, v59
    buffer_store_dwordx4 v[144:147], v111, s[28:31], s34 offen offset:0
    s_waitcnt lgkmcnt(0)
    v_pk_add_f32 v[72:73], v[72:73], v[76:77]
    v_pk_add_f32 v[80:81], v[80:81], v[84:85]
    v_pk_add_f32 v[72:73], v[72:73], v[80:81]
    v_pk_add_f32 v[74:75], v[74:75], v[78:79]
    v_pk_add_f32 v[82:83], v[82:83], v[86:87]
    v_pk_add_f32 v[74:75], v[74:75], v[82:83]
    v_lshlrev_b32 v18, 16, v140
    v_and_b32 v19, 0xffff0000, v140
    v_pk_add_f32 v[72:73], v[72:73], v[18:19]
    v_cvt_pk_bf16_f32 v148, v72, v73
    v_lshlrev_b32 v18, 16, v141
    v_and_b32 v19, 0xffff0000, v141
    v_pk_add_f32 v[74:75], v[74:75], v[18:19]
    v_cvt_pk_bf16_f32 v149, v74, v75
    v_pk_add_f32 v[88:89], v[88:89], v[92:93]
    v_pk_add_f32 v[96:97], v[96:97], v[100:101]
    v_pk_add_f32 v[88:89], v[88:89], v[96:97]
    v_pk_add_f32 v[90:91], v[90:91], v[94:95]
    v_pk_add_f32 v[98:99], v[98:99], v[102:103]
    v_pk_add_f32 v[90:91], v[90:91], v[98:99]
    v_lshlrev_b32 v18, 16, v142
    v_and_b32 v19, 0xffff0000, v142
    v_pk_add_f32 v[88:89], v[88:89], v[18:19]
    v_cvt_pk_bf16_f32 v150, v88, v89
    v_lshlrev_b32 v18, 16, v143
    v_and_b32 v19, 0xffff0000, v143
    v_pk_add_f32 v[90:91], v[90:91], v[18:19]
    v_cvt_pk_bf16_f32 v151, v90, v91
    buffer_store_dwordx4 v[148:151], v111, s[28:31], s34 offen offset:1024
    s_cmp_lg_u32 s2, 0
    s_cbranch_scc1 L_end
    s_cmp_lg_u32 s71, 0
    s_cbranch_scc1 L_end
    s_mov_b32 s79, 0
    s_lshl_b32 s80, s79, 7
    s_add_u32 s80, s80, 0
    v_mov_b32 v28, s68
    v_mov_b32 v29, 0
    s_mov_b64 exec, 1
    buffer_store_dword v28, v29, s[12:15], s80 offen sc1
    s_mov_b64 exec, -1
L_end:
    s_endpgm
L_codeend:
.section .rodata,"a"
.p2align 6
.amdhsa_kernel parallel_sum__spectral_gfnet__glu_gated_reglu__prompt_kernel
  .amdhsa_next_free_vgpr 256
  .amdhsa_next_free_sgpr 102
  .amdhsa_accum_offset 256
  .amdhsa_group_segment_fixed_size 0
  .amdhsa_kernarg_size 80
  .amdhsa_user_sgpr_count 2
  .amdhsa_user_sgpr_kernarg_segment_ptr 1
  .amdhsa_system_sgpr_workgroup_id_x 1
.end_amdhsa_kernel
```
